```python
import torch

def _softmax(x, axis=-1):
    return torch.softmax(x, dim=axis)
def _gelu(x):
    return torch.nn.functional.gelu(x, approximate="tanh")
def _silu(x):
    return torch.nn.functional.silu(x)
def _sigmoid(x):
    return torch.sigmoid(x)
def _layernorm(x, axis=-1, eps=1e-5):
    m = x.mean(dim=axis, keepdim=True)
    v = x.var(dim=axis, keepdim=True, unbiased=False)
    return (x - m) / torch.sqrt(v + eps)
def _scatter_add(tgt, idx, src, axis=0):
    return tgt.clone().index_add_(axis, idx, src)
def _segment_sum(src, seg, n):
    out = torch.zeros((n,) + src.shape[1:], dtype=src.dtype)
    return out.index_add_(0, seg, src)
def _pad(x, pw):
    flat = tuple(v for pair in reversed(pw) for v in pair)
    return torch.nn.functional.pad(x, flat)

kernel_name = 'gated_mix__sliding_local_dilated__glu_gated_glu__prompt'

def setup_inputs():

    _w = (lambda a: (lambda t: t.to(torch.bfloat16) if t.is_floating_point() else t)(torch.as_tensor(a)))
    def _A_setup():
        B, S, D = 1, 2048, 512
        return {
            "x": _w((lambda *s: torch.randn(*s, dtype=torch.bfloat16) * 0.05)(B, S, D)),
            "wqkv": _w((lambda *s: torch.randn(*s, dtype=torch.bfloat16) * 0.8)(D, 3 * D)),
            "wo": _w((lambda *s: torch.randn(*s, dtype=torch.bfloat16) * 0.05)(D, D)),
        }
    _A_in = _A_setup()

    def _B_setup():
        B, S, D, F = 1, 2048, 512, 1792
        return {
            "x": _w((lambda *s: torch.randn(*s, dtype=torch.bfloat16) * 0.05)(B, S, D)),
            "w_gate": _w((lambda *s: torch.randn(*s, dtype=torch.bfloat16) * 3.2)(D, F)),
            "w_up": _w((lambda *s: torch.randn(*s, dtype=torch.bfloat16) * 0.1)(D, F)),
            "w_down": _w((lambda *s: torch.randn(*s, dtype=torch.bfloat16) * 0.1)(F, D)),
        }
    _B_in = _B_setup()

    return {
        "A_x": _A_in["x"],
        "A_wqkv": _A_in["wqkv"],
        "A_wo": _A_in["wo"],
        "B_x": _B_in["x"],
        "B_w_gate": _B_in["w_gate"],
        "B_w_up": _B_in["w_up"],
        "B_w_down": _B_in["w_down"],
        "gate_w": _w((lambda *s: torch.randn(*s, dtype=torch.bfloat16) * 0.05)(512) * 16.0),
    }

def reference(A_x, A_wqkv, A_wo, B_x, B_w_gate, B_w_up, B_w_down, gate_w):
    def _A_ref(x, wqkv, wo):
        B, S, D = x.shape
        H = 32; Dh = D // H
        W, dil = 8, 2
        qkv = (lambda x, *d: x.permute(*d))((x @ wqkv).reshape(B, S, 3, H, Dh), 2, 0, 3, 1, 4)
        q, k, v = qkv[0], qkv[1], qkv[2]
        scale = Dh ** -0.5
        pos = torch.arange(S)
        off = torch.arange(W) * dil
        idx = pos[:, None] - off[None, :]
        mask = idx >= 0
        idx_c = torch.where(mask, idx, 0).reshape(-1)
        kg = k[:, :, idx_c, :].reshape(B, H, S, W, Dh)
        vg = v[:, :, idx_c, :].reshape(B, H, S, W, Dh)
        logits = torch.einsum("bhsd,bhswd->bhsw", q, kg) * scale
        logits = torch.where(mask[None, None, :, :], logits, -1e9)
        attn = _softmax(logits, axis=-1)
        o = torch.einsum("bhsw,bhswd->bhsd", attn, vg)
        return (lambda x, *d: x.permute(*d))(o, 0, 2, 1, 3).reshape(B, S, D) @ wo

    def _B_ref(x, w_gate, w_up, w_down):
        g = torch.einsum("bsd,df->bsf", x, w_gate)
        u = torch.einsum("bsd,df->bsf", x, w_up)
        h = _sigmoid(g) * u
        return torch.einsum("bsf,fd->bsd", h, w_down)

    x = A_x
    g = _sigmoid((x * gate_w).sum(-1, keepdims=True))
    a = _A_ref(x, A_wqkv, A_wo)
    b = _B_ref(x, B_w_gate, B_w_up, B_w_down)
    return g * a + (1 - g) * b
```

```asm
; @launch grid=(256,1,1) block=(256,1,1) lds=163840
.amdgcn_target "amdgcn-amd-amdhsa--gfx950"
.text
.globl gated_mix__sliding_local_dilated__glu_gated_glu__prompt_kernel
.p2align 8
.type gated_mix__sliding_local_dilated__glu_gated_glu__prompt_kernel,@function
gated_mix__sliding_local_dilated__glu_gated_glu__prompt_kernel:
s_cmp_ge_u32 s2, 256
s_cbranch_scc1 L_exit
s_load_dwordx8 s[4:11], s[0:1], 0
s_load_dwordx8 s[12:19], s[0:1], 32
s_load_dwordx4 s[20:23], s[0:1], 64
s_load_dwordx2 s[24:25], s[0:1], 80
s_getpc_b64 s[26:27]
v_lshrrev_b32 v62, 4, v0
v_add_u32 v63, v62, v0
v_and_b32 v63, 15, v63
s_lshr_b32 s3, s2, 3
s_lshl_b32 s3, s3, 11
v_lshl_add_u32 v63, v63, 7, s3
s_mov_b64 exec, 15
global_load_dword v63, v63, s[26:27]
s_mov_b64 exec, -1
v_lshrrev_b32 v2, 6, v0
v_and_b32 v1, 63, v0
v_readfirstlane_b32 s60, v2
s_and_b32 s63, s2, 7
s_lshr_b32 s64, s2, 3
s_nop 1
s_and_b32 s89, s63, 1
s_and_b32 s90, s63, 6
s_mul_i32 s91, s89, 6
s_add_u32 s91, s91, s64
s_add_u32 s89, s89, s64
s_cmp_ge_u32 s89, 6
s_cselect_b32 s89, 6, 0
s_addc_u32 s90, s90, 0
s_sub_u32 s91, s91, s89
s_lshr_b32 s88, s63, 1
s_mul_i32 s88, s88, 21
s_add_u32 s88, s88, s64
s_sub_u32 s88, s88, 11
s_mul_i32 s62, s88, 171
s_lshr_b32 s62, s62, 10
s_and_b32 s89, s63, 1
s_sub_u32 s89, s62, s89
s_mul_i32 s89, s89, 6
s_sub_u32 s88, s88, s89
s_and_b32 s99, s88, 1
s_mov_b32 s92, 0x31a86420
s_cselect_b32 s92, 0x20a97531, s92
s_mov_b32 s93, 0xf975
s_cselect_b32 s93, 0xf864, s93
s_cmp_lt_u32 s64, 11
s_cselect_b32 s62, s90, s62
s_cselect_b32 s96, s91, s88
s_cselect_b32 s92, 0x71a48260, s92
s_cselect_b32 s93, 0xb593, s93
s_cselect_b32 s88, 12, 11
s_cselect_b32 s94, 3, 4
s_cselect_b32 s87, 24, 28
s_cselect_b32 s67, 4096, 0
s_cselect_b32 s68, 12288, 0
s_cselect_b32 s95, 7, 8
s_cselect_b32 s86, 3, 1
s_cselect_b32 s3, 10, 7
s_mul_i32 s61, s96, s88
s_lshl_b32 s87, s87, 7
s_lshl_b32 s88, s63, 2
s_lshr_b32 s88, 0x4400440, s88
s_and_b32 s88, s88, 7
s_and_b32 s70, s96, 1
s_xor_b32 s70, s70, s88
s_mul_i32 s88, s60, 12
s_lshr_b64 s[92:93], s[92:93], s88
s_lshl_b32 s88, s88, 9
s_add_u32 s67, s67, s88
v_lshrrev_b32 v32, 3, v1
v_lshrrev_b32 v33, 4, v1
v_and_b32 v34, 7, v1
v_xor_b32 v35, v34, v33
v_lshlrev_b32 v35, 4, v35
v_lshl_add_u32 v36, v32, 11, v35
v_xor_b32 v37, 64, v36
v_add_u32 v40, 4096, v36
v_add_u32 v41, 19456, v37
v_add_u32 v42, 2048, v36
v_add_u32 v43, 17408, v37
s_bfe_u32 s88, s92, 0x40000
s_add_u32 s89, s88, s61
s_lshl_b32 s90, s89, 14
s_bitcmp1_b32 s89, 0
s_cselect_b32 s89, 15360, 0
s_sub_u32 s90, s90, s89
v_add_u32 v2, s90, v40
v_add_u32 v3, s90, v41
s_bfe_u32 s88, s92, 0x40004
s_add_u32 s89, s88, s61
s_lshl_b32 s90, s89, 14
s_bitcmp1_b32 s89, 0
s_cselect_b32 s89, 15360, 0
s_sub_u32 s90, s90, s89
v_add_u32 v4, s90, v42
v_add_u32 v5, s90, v43
s_bfe_u32 s88, s92, 0x40008
s_add_u32 s89, s88, s61
s_lshl_b32 s90, s89, 14
s_bitcmp1_b32 s89, 0
s_cselect_b32 s89, 15360, 0
s_sub_u32 s90, s90, s89
s_cmp_eq_u32 s88, 15
s_cselect_b32 s90, 0x40000000, s90
v_add_u32 v6, s90, v40
v_add_u32 v7, s90, v41
s_mov_b32 s30, 0x201000
s_mov_b32 s31, 0x20000
s_lshl_b32 s65, s70, 7
s_mov_b32 m0, s67
v_and_b32 v38, 1, v33
v_lshlrev_b32 v38, 1, v38
v_xor_b32 v38, v34, v38
v_lshlrev_b32 v38, 4, v38
v_mad_u32_u24 v38, v32, s87, v38
s_mul_i32 s88, s60, s94
s_lshl_b32 s95, s62, s95
s_lshl_b32 s89, s88, 10
s_add_u32 s68, s68, s89
s_lshl_b32 s94, s87, 3
s_lshl_b32 s34, s87, 9
s_mov_b32 s35, 0x20000
s_mul_i32 s66, s70, s87
s_lshl_b32 s66, s66, 6
s_and_b32 s90, s88, 3
s_mul_i32 s90, s90, s94
s_lshr_b32 s91, s88, 2
s_and_b32 s91, s91, s86
s_lshl_b32 s91, s91, s3
s_add_u32 s90, s90, s91
s_add_u32 s90, s90, s95
s_bitcmp1_b32 s88, 0
s_cselect_b32 s89, 64, 0
v_xor_b32 v39, s89, v38
v_add_u32 v9, s90, v39
s_add_u32 s88, s88, 1
s_sub_u32 s95, s95, 1024
s_and_b32 s90, s88, 3
s_mul_i32 s90, s90, s94
s_lshr_b32 s91, s88, 2
s_and_b32 s91, s91, s86
s_lshl_b32 s91, s91, s3
s_add_u32 s90, s90, s91
s_add_u32 s90, s90, s95
s_bitcmp1_b32 s88, 0
s_cselect_b32 s89, 64, 0
v_xor_b32 v39, s89, v38
v_add_u32 v10, s90, v39
s_add_u32 s88, s88, 1
s_sub_u32 s95, s95, 1024
s_waitcnt lgkmcnt(0)
s_sub_u32 s28, s4, 4096
s_subb_u32 s29, s5, 0
buffer_load_dwordx4 v2, s[28:31], s65 offen offset:0 lds
buffer_load_dwordx4 v3, s[28:31], s65 offen offset:1024 lds
buffer_load_dwordx4 v4, s[28:31], s65 offen offset:2048 lds
buffer_load_dwordx4 v5, s[28:31], s65 offen offset:3072 lds
s_add_u32 m0, s67, 4096
s_nop 0
buffer_load_dwordx4 v6, s[28:31], s65 offen offset:0 lds
buffer_load_dwordx4 v7, s[28:31], s65 offen offset:1024 lds
s_and_b32 s90, s88, 3
s_mul_i32 s90, s90, s94
s_lshr_b32 s91, s88, 2
s_and_b32 s91, s91, s86
s_lshl_b32 s91, s91, s3
s_add_u32 s90, s90, s91
s_add_u32 s90, s90, s95
s_bitcmp1_b32 s88, 0
s_cselect_b32 s89, 64, 0
v_xor_b32 v39, s89, v38
v_add_u32 v11, s90, v39
s_add_u32 s88, s88, 1
s_sub_u32 s95, s95, 1024
s_and_b32 s90, s88, 3
s_mul_i32 s90, s90, s94
s_lshr_b32 s91, s88, 2
s_and_b32 s91, s91, s86
s_lshl_b32 s91, s91, s3
s_add_u32 s90, s90, s91
s_add_u32 s90, s90, s95
s_bitcmp1_b32 s88, 0
s_cselect_b32 s89, 64, 0
v_xor_b32 v39, s89, v38
v_add_u32 v12, s90, v39
s_add_u32 m0, s68, 73728
s_cmp_lt_u32 s60, 2
s_cselect_b64 s[32:33], s[12:13], s[14:15]
s_cmp_lt_u32 s64, 11
s_cselect_b64 s[32:33], s[6:7], s[32:33]
buffer_load_dwordx4 v9, s[32:35], s66 offen offset:0 lds
buffer_load_dwordx4 v10, s[32:35], s66 offen offset:1024 lds
buffer_load_dwordx4 v11, s[32:35], s66 offen offset:2048 lds
s_cbranch_scc0 L_H
s_lshl_b32 s88, s61, 4
s_add_u32 s88, s88, s60
s_sub_u32 s88, s88, 16
s_lshl_b32 s88, s88, 10
s_add_u32 s88, s88, 4096
s_cmp_eq_u32 s61, 0
s_cselect_b32 s88, 0x40000000, s88
s_cmp_ge_u32 s60, 2
s_cselect_b32 s88, 0x40000000, s88
s_and_b32 s89, s60, 1
s_lshl_b32 s89, s89, 6
v_xor_b32 v38, s89, v36
v_add_u32 v8, s88, v38
s_lshl_b32 s69, s60, 10
v_lshlrev_b32 v39, 2, v32
s_mov_b32 s88, 0x77777777
v_lshrrev_b32 v39, v39, s88
s_and_b32 s89, s70, 7
v_and_b32 v39, s89, v39
v_xor_b32 v39, v39, v32
v_lshl_add_u32 v39, v39, 3, v34
v_lshlrev_b32 v39, 4, v39
s_mov_b32 s40, s18
s_mov_b32 s41, s19
s_mov_b32 s42, 0x400
s_mov_b32 s43, 0x20000
s_mov_b32 m0, 147456
s_nop 0
buffer_load_dwordx4 v39, s[40:43], 0 offen lds
s_add_u32 m0, s69, 0
s_nop 0
buffer_load_dwordx4 v8, s[28:31], s65 offen offset:0 lds
s_branch L_Q
L_H:
buffer_load_dwordx4 v12, s[32:35], s66 offen offset:3072 lds
s_mul_i32 s98, s96, 14
s_add_u32 s98, s98, s62
s_add_u32 s98, s98, 88
s_lshr_b32 s88, s63, 1
s_cmp_lg_u32 s88, 1
s_cbranch_scc1 H_q3
s_lshl_b32 s88, s64, 2
s_add_u32 s88, s88, s60
s_mul_i32 s88, s88, 12288
v_min_u32 v59, 11, v1
v_lshl_add_u32 v59, v59, 10, s88
s_mov_b64 exec, 0xfff
global_load_dword v59, v59, s[6:7] offset:384
s_mov_b64 exec, -1
H_q3:
v_and_b32 v40, 15, v1
v_lshrrev_b32 v41, 1, v40
v_xor_b32 v41, v41, v33
v_lshlrev_b32 v41, 4, v41
v_lshl_add_u32 v13, v40, 7, v41
v_xor_b32 v14, 64, v13
v_lshrrev_b32 v42, 2, v40
v_lshl_add_u32 v43, v33, 3, v42
v_lshrrev_b32 v44, 1, v42
v_and_b32 v45, 1, v33
v_lshl_add_u32 v44, v45, 1, v44
s_and_b32 s88, s60, 1
s_lshl_b32 s88, s88, 1
v_xor_b32 v44, s88, v44
v_lshlrev_b32 v44, 5, v44
v_lshl_add_u32 v43, v43, 7, v44
v_and_b32 v45, 3, v1
v_lshl_add_u32 v43, v45, 3, v43
s_lshr_b32 s88, s60, 1
s_lshl_b32 s88, s88, 12
v_add_u32 v15, s88, v43
v_xor_b32 v16, 32, v15
v_add_u32 v17, 0xc000, v15
v_add_u32 v18, 0xc000, v16
v_add_u32 v19, 0x18000, v15
v_add_u32 v20, 0x18000, v16
v_add_u32 v21, 0xc000, v13
v_add_u32 v22, 0xc000, v14
s_mov_b32 s36, s24
s_mov_b32 s37, s25
s_mov_b32 s38, 0x900000
s_mov_b32 s39, 0x20000
s_mov_b32 s44, s8
s_mov_b32 s45, s9
s_mov_b32 s46, 0x80000
s_mov_b32 s47, 0x20000
s_sub_u32 s48, s16, 524288
s_subb_u32 s49, s17, 0
s_mov_b32 s50, 0x240000
s_mov_b32 s51, 0x20000
s_mov_b32 s52, s20
s_mov_b32 s53, s21
s_mov_b32 s54, 0x200000
s_mov_b32 s55, 0x20000
s_mov_b32 s56, s22
s_mov_b32 s57, s23
s_mov_b32 s58, 0x100
s_mov_b32 s59, 0x20000
s_add_u32 s40, s24, 9437184
s_addc_u32 s41, s25, 0
s_mov_b32 s42, 0x4000
s_mov_b32 s43, 0x20000
s_add_u32 s20, s24, 9453568
s_addc_u32 s21, s25, 0
s_mov_b32 s22, 0x208000
s_mov_b32 s23, 0x20000
s_mov_b32 s93, s64
s_cmp_eq_u32 s64, 11
s_cselect_b32 s93, 8, s93
s_cmp_eq_u32 s64, 8
s_cselect_b32 s93, 11, s93
s_cmp_eq_u32 s64, 19
s_cselect_b32 s93, 9, s93
s_cmp_eq_u32 s64, 9
s_cselect_b32 s93, 19, s93
s_cmp_eq_u32 s64, 27
s_cselect_b32 s93, 10, s93
s_cmp_eq_u32 s64, 10
s_cselect_b32 s93, 27, s93
s_lshr_b32 s88, s63, 1
s_and_b32 s89, s63, 1
s_lshl_b32 s72, s88, 3
s_lshr_b32 s90, s93, 3
s_lshl_b32 s90, s90, 1
s_add_u32 s72, s72, s90
s_add_u32 s72, s72, s89
s_and_b32 s90, s93, 0
s_xor_b32 s72, s72, s90
s_and_b32 s73, s93, 7
s_lshl_b32 s71, s60, 11
s_lshl_b32 s89, s89, 2
s_add_u32 s89, s89, s60
s_lshl_b32 s74, s89, 12
s_mov_b32 s90, s88
s_and_b32 s90, s90, 1
s_lshl_b32 s90, s90, 11
s_add_u32 s74, s74, s90
s_xor_b32 s75, s74, 0x800
s_mul_i32 s91, s89, 14336
s_add_u32 s91, s91, 32768
s_add_u32 s92, s91, 14336
s_mul_i32 s90, s88, 4096
s_add_u32 s76, s91, s90
s_add_u32 s78, s76, 2048
s_cmp_eq_u32 s78, s92
s_cselect_b32 s78, s91, s78
s_add_u32 s79, s78, 2048
s_cmp_eq_u32 s79, s92
s_cselect_b32 s79, s91, s79
s_add_u32 s80, s79, 2048
s_cmp_eq_u32 s80, s92
s_cselect_b32 s80, s91, s80
s_add_u32 s81, s80, 2048
s_cmp_eq_u32 s81, s92
s_cselect_b32 s81, s91, s81
s_add_u32 s18, s81, 2048
s_cmp_eq_u32 s18, s92
s_cselect_b32 s18, s91, s18
s_add_u32 s19, s18, 2048
s_cmp_eq_u32 s19, s92
s_cselect_b32 s19, s91, s19
s_add_u32 s66, s66, 114688
s_add_u32 m0, s68, 90112
s_nop 0
buffer_load_dwordx4 v9, s[32:35], s66 offen offset:0 lds
buffer_load_dwordx4 v10, s[32:35], s66 offen offset:1024 lds
buffer_load_dwordx4 v11, s[32:35], s66 offen offset:2048 lds
buffer_load_dwordx4 v12, s[32:35], s66 offen offset:3072 lds
s_and_b32 s97, s70, 7
s_xor_b32 s97, s97, 1
s_mul_i32 s65, s97, 128
s_add_u32 m0, s67, 24576
s_nop 0
buffer_load_dwordx4 v2, s[28:31], s65 offen offset:0 lds
buffer_load_dwordx4 v3, s[28:31], s65 offen offset:1024 lds
buffer_load_dwordx4 v4, s[28:31], s65 offen offset:2048 lds
buffer_load_dwordx4 v5, s[28:31], s65 offen offset:3072 lds
s_add_u32 m0, s67, 28672
s_nop 0
buffer_load_dwordx4 v6, s[28:31], s65 offen offset:0 lds
buffer_load_dwordx4 v7, s[28:31], s65 offen offset:1024 lds
s_mov_b64 exec, 0
s_cmp_eq_u32 s60, 0
s_cbranch_scc1 H_T0
s_cmp_eq_u32 s60, 1
s_cbranch_scc1 H_T1
s_cmp_eq_u32 s60, 2
s_cbranch_scc1 H_T2
s_branch H_T3
H_Tret:
s_mov_b64 exec, -1
s_waitcnt vmcnt(10)
s_barrier
ds_read_b64_tr_b16 a[0:1], v17 offset:24576
ds_read_b64_tr_b16 a[2:3], v17 offset:25088
ds_read_b128 a[4:7], v13 offset:0
ds_read_b64_tr_b16 a[8:9], v18 offset:24576
ds_read_b64_tr_b16 a[10:11], v18 offset:25088
ds_read_b64_tr_b16 a[12:13], v17 offset:32768
ds_read_b64_tr_b16 a[14:15], v17 offset:33280
ds_read_b64_tr_b16 a[16:17], v18 offset:32768
ds_read_b64_tr_b16 a[18:19], v18 offset:33280
ds_read_b128 a[20:23], v13 offset:2048
ds_read_b128 a[24:27], v13 offset:4096
ds_read_b128 a[28:31], v13 offset:6144
ds_read_b128 a[32:35], v13 offset:8192
ds_read_b128 a[36:39], v13 offset:10240
ds_read_b128 a[40:43], v13 offset:12288
ds_read_b128 a[44:47], v13 offset:14336
ds_read_b128 a[48:51], v13 offset:16384
ds_read_b128 a[52:55], v13 offset:18432
ds_read_b128 a[56:59], v13 offset:20480
s_waitcnt vmcnt(6)
s_barrier
s_waitcnt lgkmcnt(15)
v_mfma_f32_16x16x32_bf16 v[64:67], a[0:3], a[4:7], 0
s_and_b32 s97, s70, 7
s_xor_b32 s97, s97, 1
s_waitcnt lgkmcnt(14)
v_mfma_f32_16x16x32_bf16 v[68:71], a[8:11], a[4:7], 0
s_mul_i32 s66, s97, 229376
s_add_u32 m0, s68, 106496
s_waitcnt lgkmcnt(12)
v_mfma_f32_16x16x32_bf16 v[72:75], a[12:15], a[4:7], 0
buffer_load_dwordx4 v9, s[32:35], s66 offen offset:0 lds
s_waitcnt lgkmcnt(10)
v_mfma_f32_16x16x32_bf16 v[76:79], a[16:19], a[4:7], 0
ds_read_b64_tr_b16 a[60:61], v17 offset:40960
v_lshrrev_b32 v62, 4, v1
s_waitcnt lgkmcnt(6)
v_mfma_f32_16x16x32_bf16 v[92:95], a[16:19], a[20:23], 0
ds_read_b64_tr_b16 a[62:63], v17 offset:41472
v_lshlrev_b32 v62, 1, v62
v_mfma_f32_16x16x32_bf16 v[88:91], a[12:15], a[20:23], 0
ds_read_b128 a[64:67], v14 offset:0
v_mfma_f32_16x16x32_bf16 v[84:87], a[8:11], a[20:23], 0
ds_read_b64_tr_b16 a[68:69], v18 offset:40960
v_mfma_f32_16x16x32_bf16 v[80:83], a[0:3], a[20:23], 0
buffer_load_dwordx4 v10, s[32:35], s66 offen offset:1024 lds
v_mfma_f32_16x16x32_bf16 v[96:99], a[0:3], a[24:27], 0
ds_read_b64_tr_b16 a[70:71], v18 offset:41472
v_and_b32 v0, 7, v1
v_mfma_f32_16x16x32_bf16 v[100:103], a[8:11], a[24:27], 0
ds_read_b64_tr_b16 a[72:73], v19 offset:0
v_mfma_f32_16x16x32_bf16 v[104:107], a[12:15], a[24:27], 0
ds_read_b64_tr_b16 a[74:75], v19 offset:512
v_mfma_f32_16x16x32_bf16 v[108:111], a[16:19], a[24:27], 0
ds_read_b64_tr_b16 a[76:77], v20 offset:0
v_mfma_f32_16x16x32_bf16 v[124:127], a[16:19], a[28:31], 0
buffer_load_dwordx4 v11, s[32:35], s66 offen offset:2048 lds
v_mfma_f32_16x16x32_bf16 v[120:123], a[12:15], a[28:31], 0
ds_read_b64_tr_b16 a[78:79], v20 offset:512
v_xor_b32 v62, v62, v0
v_mfma_f32_16x16x32_bf16 v[116:119], a[8:11], a[28:31], 0
ds_read_b128 a[80:83], v14 offset:2048
v_mfma_f32_16x16x32_bf16 v[112:115], a[0:3], a[28:31], 0
ds_read_b128 a[84:87], v14 offset:4096
v_mfma_f32_16x16x32_bf16 v[128:131], a[0:3], a[32:35], 0
ds_read_b128 a[88:91], v14 offset:6144
v_mfma_f32_16x16x32_bf16 v[132:135], a[8:11], a[32:35], 0
buffer_load_dwordx4 v12, s[32:35], s66 offen offset:3072 lds
v_mfma_f32_16x16x32_bf16 v[136:139], a[12:15], a[32:35], 0
s_add_u32 s66, s66, 114688
s_add_u32 m0, s68, 122880
v_mfma_f32_16x16x32_bf16 v[140:143], a[16:19], a[32:35], 0
ds_read_b128 a[92:95], v14 offset:8192
v_lshlrev_b32 v62, 4, v62
v_mfma_f32_16x16x32_bf16 v[156:159], a[16:19], a[36:39], 0
ds_read_b128 a[96:99], v14 offset:10240
v_mfma_f32_16x16x32_bf16 v[152:155], a[12:15], a[36:39], 0
ds_read_b128 a[100:103], v14 offset:12288
v_mfma_f32_16x16x32_bf16 v[148:151], a[8:11], a[36:39], 0
ds_read_b128 a[104:107], v14 offset:14336
v_lshrrev_b32 v0, 3, v1
v_mfma_f32_16x16x32_bf16 v[144:147], a[0:3], a[36:39], 0
buffer_load_dwordx4 v9, s[32:35], s66 offen offset:0 lds
s_waitcnt lgkmcnt(4)
v_mfma_f32_16x16x32_bf16 v[160:163], a[0:3], a[40:43], 0
ds_read_b128 a[108:111], v14 offset:16384
v_mfma_f32_16x16x32_bf16 v[164:167], a[8:11], a[40:43], 0
ds_read_b128 a[112:115], v14 offset:18432
v_mfma_f32_16x16x32_bf16 v[168:171], a[12:15], a[40:43], 0
ds_read_b128 a[116:119], v14 offset:20480
v_lshl_add_u32 v62, v0, 10, v62
v_mfma_f32_16x16x32_bf16 v[172:175], a[16:19], a[40:43], 0
v_mfma_f32_16x16x32_bf16 v[188:191], a[16:19], a[44:47], 0
buffer_load_dwordx4 v10, s[32:35], s66 offen offset:1024 lds
v_mfma_f32_16x16x32_bf16 v[184:187], a[12:15], a[44:47], 0
v_mfma_f32_16x16x32_bf16 v[180:183], a[8:11], a[44:47], 0
s_lshl_b32 s4, s73, 7
v_mfma_f32_16x16x32_bf16 v[176:179], a[0:3], a[44:47], 0
v_mfma_f32_16x16x32_bf16 v[192:195], a[0:3], a[48:51], 0
v_mfma_f32_16x16x32_bf16 v[196:199], a[8:11], a[48:51], 0
buffer_load_dwordx4 v11, s[32:35], s66 offen offset:2048 lds
v_mfma_f32_16x16x32_bf16 v[200:203], a[12:15], a[48:51], 0
v_mfma_f32_16x16x32_bf16 v[204:207], a[16:19], a[48:51], 0
v_add_u32 v62, s4, v62
v_mfma_f32_16x16x32_bf16 v[220:223], a[16:19], a[52:55], 0
v_mfma_f32_16x16x32_bf16 v[216:219], a[12:15], a[52:55], 0
v_mfma_f32_16x16x32_bf16 v[212:215], a[8:11], a[52:55], 0
buffer_load_dwordx4 v12, s[32:35], s66 offen offset:3072 lds
v_mfma_f32_16x16x32_bf16 v[208:211], a[0:3], a[52:55], 0
v_add_u32 v0, 7168, v62
v_mfma_f32_16x16x32_bf16 v[224:227], a[0:3], a[56:59], 0
v_mfma_f32_16x16x32_bf16 v[228:231], a[8:11], a[56:59], 0
v_mfma_f32_16x16x32_bf16 v[232:235], a[12:15], a[56:59], 0
v_mfma_f32_16x16x32_bf16 v[236:239], a[16:19], a[56:59], 0
s_waitcnt vmcnt(4) lgkmcnt(0)
s_barrier
v_mfma_f32_16x16x32_bf16 v[64:67], a[60:63], a[64:67], v[64:67]
s_and_b32 s97, s70, 7
s_xor_b32 s97, s97, 2
v_mfma_f32_16x16x32_bf16 v[68:71], a[68:71], a[64:67], v[68:71]
s_mul_i32 s65, s97, 128
s_add_u32 m0, s67, 49152
v_mfma_f32_16x16x32_bf16 v[72:75], a[72:75], a[64:67], v[72:75]
buffer_load_dwordx4 v2, s[28:31], s65 offen offset:0 lds
v_mfma_f32_16x16x32_bf16 v[76:79], a[76:79], a[64:67], v[76:79]
ds_read_b64_tr_b16 a[120:121], v19 offset:8192
v_lshrrev_b32 v33, 2, v1
v_mfma_f32_16x16x32_bf16 v[92:95], a[76:79], a[80:83], v[92:95]
ds_read_b64_tr_b16 a[122:123], v19 offset:8704
v_lshrrev_b32 v34, 3, v1
v_mfma_f32_16x16x32_bf16 v[88:91], a[72:75], a[80:83], v[88:91]
ds_read_b128 a[124:127], v13 offset:24576
v_and_b32 v34, 3, v34
v_mfma_f32_16x16x32_bf16 v[84:87], a[68:71], a[80:83], v[84:87]
ds_read_b64_tr_b16 a[192:193], v20 offset:8192
v_lshlrev_b32 v34, 5, v34
v_mfma_f32_16x16x32_bf16 v[80:83], a[60:63], a[80:83], v[80:83]
buffer_load_dwordx4 v3, s[28:31], s65 offen offset:1024 lds
v_mfma_f32_16x16x32_bf16 v[96:99], a[60:63], a[84:87], v[96:99]
ds_read_b64_tr_b16 a[194:195], v20 offset:8704
v_mfma_f32_16x16x32_bf16 v[100:103], a[68:71], a[84:87], v[100:103]
ds_read_b64_tr_b16 a[196:197], v19 offset:16384
v_lshl_add_u32 v33, v33, 7, v34
v_mfma_f32_16x16x32_bf16 v[104:107], a[72:75], a[84:87], v[104:107]
ds_read_b64_tr_b16 a[198:199], v19 offset:16896
v_mfma_f32_16x16x32_bf16 v[108:111], a[76:79], a[84:87], v[108:111]
ds_read_b64_tr_b16 a[200:201], v20 offset:16384
v_and_b32 v34, 3, v1
v_mfma_f32_16x16x32_bf16 v[124:127], a[76:79], a[88:91], v[124:127]
buffer_load_dwordx4 v4, s[28:31], s65 offen offset:2048 lds
v_mfma_f32_16x16x32_bf16 v[120:123], a[72:75], a[88:91], v[120:123]
ds_read_b64_tr_b16 a[202:203], v20 offset:16896
v_lshl_add_u32 v33, v34, 3, v33
v_mfma_f32_16x16x32_bf16 v[116:119], a[68:71], a[88:91], v[116:119]
ds_read_b128 a[204:207], v13 offset:26624
v_mfma_f32_16x16x32_bf16 v[112:115], a[60:63], a[88:91], v[112:115]
ds_read_b128 a[208:211], v13 offset:28672
v_mfma_f32_16x16x32_bf16 v[128:131], a[60:63], a[92:95], v[128:131]
ds_read_b128 a[212:215], v13 offset:30720
v_add_u32 v32, s71, v33
v_mfma_f32_16x16x32_bf16 v[132:135], a[68:71], a[92:95], v[132:135]
buffer_load_dwordx4 v5, s[28:31], s65 offen offset:3072 lds
v_mfma_f32_16x16x32_bf16 v[136:139], a[72:75], a[92:95], v[136:139]
s_add_u32 m0, s67, 53248
ds_read_b128 a[216:219], v13 offset:32768
v_mfma_f32_16x16x32_bf16 v[140:143], a[76:79], a[92:95], v[140:143]
ds_read_b128 a[220:223], v13 offset:34816
v_xor_b32 v33, 32, v32
v_mfma_f32_16x16x32_bf16 v[156:159], a[76:79], a[96:99], v[156:159]
ds_read_b128 a[224:227], v13 offset:36864
v_xor_b32 v34, 64, v32
v_mfma_f32_16x16x32_bf16 v[152:155], a[72:75], a[96:99], v[152:155]
ds_read_b128 a[228:231], v13 offset:38912
v_mfma_f32_16x16x32_bf16 v[148:151], a[68:71], a[96:99], v[148:151]
ds_read_b128 a[232:235], v13 offset:40960
v_mfma_f32_16x16x32_bf16 v[144:147], a[60:63], a[96:99], v[144:147]
buffer_load_dwordx4 v6, s[28:31], s65 offen offset:0 lds
v_mfma_f32_16x16x32_bf16 v[160:163], a[60:63], a[100:103], v[160:163]
ds_read_b128 a[236:239], v13 offset:43008
v_xor_b32 v35, 96, v32
v_mfma_f32_16x16x32_bf16 v[164:167], a[68:71], a[100:103], v[164:167]
H_T0:
s_cbranch_execz H_T4
ds_read_b128 a[240:243], v13 offset:45056
v_add_u32 v36, 0x10000, v32
v_mfma_f32_16x16x32_bf16 v[168:171], a[72:75], a[100:103], v[168:171]
v_mfma_f32_16x16x32_bf16 v[172:175], a[76:79], a[100:103], v[172:175]
v_add_u32 v37, 0x20000, v32
v_mfma_f32_16x16x32_bf16 v[188:191], a[76:79], a[104:107], v[188:191]
buffer_load_dwordx4 v7, s[28:31], s65 offen offset:1024 lds
v_mfma_f32_16x16x32_bf16 v[184:187], a[72:75], a[104:107], v[184:187]
s_and_b32 s97, s70, 7
s_xor_b32 s97, s97, 2
v_mfma_f32_16x16x32_bf16 v[180:183], a[68:71], a[104:107], v[180:183]
s_mul_i32 s66, s97, 229376
s_add_u32 m0, s68, 73728
v_mfma_f32_16x16x32_bf16 v[176:179], a[60:63], a[104:107], v[176:179]
v_add_u32 v38, 0x10000, v33
v_mfma_f32_16x16x32_bf16 v[192:195], a[60:63], a[108:111], v[192:195]
v_add_u32 v39, 0x20000, v33
v_mfma_f32_16x16x32_bf16 v[196:199], a[68:71], a[108:111], v[196:199]
buffer_load_dwordx4 v9, s[32:35], s66 offen offset:0 lds
v_mfma_f32_16x16x32_bf16 v[200:203], a[72:75], a[108:111], v[200:203]
v_add_u32 v40, 0x10000, v34
v_mfma_f32_16x16x32_bf16 v[204:207], a[76:79], a[108:111], v[204:207]
v_mfma_f32_16x16x32_bf16 v[220:223], a[76:79], a[112:115], v[220:223]
v_mfma_f32_16x16x32_bf16 v[216:219], a[72:75], a[112:115], v[216:219]
v_add_u32 v41, 0x20000, v34
v_mfma_f32_16x16x32_bf16 v[212:215], a[68:71], a[112:115], v[212:215]
buffer_load_dwordx4 v10, s[32:35], s66 offen offset:1024 lds
v_mfma_f32_16x16x32_bf16 v[208:211], a[60:63], a[112:115], v[208:211]
v_add_u32 v42, 0x10000, v35
v_mfma_f32_16x16x32_bf16 v[224:227], a[60:63], a[116:119], v[224:227]
v_mfma_f32_16x16x32_bf16 v[228:231], a[68:71], a[116:119], v[228:231]
v_add_u32 v43, 0x20000, v35
v_mfma_f32_16x16x32_bf16 v[232:235], a[72:75], a[116:119], v[232:235]
v_mfma_f32_16x16x32_bf16 v[236:239], a[76:79], a[116:119], v[236:239]
s_waitcnt vmcnt(8) lgkmcnt(0)
s_barrier
v_mfma_f32_16x16x32_bf16 v[64:67], a[120:123], a[124:127], v[64:67]
buffer_load_dwordx4 v11, s[32:35], s66 offen offset:2048 lds
v_mfma_f32_16x16x32_bf16 v[68:71], a[192:195], a[124:127], v[68:71]
ds_read_b64_tr_b16 a[244:245], v19 offset:24576
s_and_b32 s7, s72, 30
v_mfma_f32_16x16x32_bf16 v[72:75], a[196:199], a[124:127], v[72:75]
ds_read_b64_tr_b16 a[246:247], v19 offset:25088
s_mul_i32 s4, s7, 684
v_mfma_f32_16x16x32_bf16 v[76:79], a[200:203], a[124:127], v[76:79]
ds_read_b128 a[248:251], v14 offset:24576
s_add_u32 s5, s4, 1197
v_mfma_f32_16x16x32_bf16 v[92:95], a[200:203], a[204:207], v[92:95]
ds_read_b64_tr_b16 a[252:253], v20 offset:24576
s_lshr_b32 s4, s4, 11
v_mfma_f32_16x16x32_bf16 v[88:91], a[196:199], a[204:207], v[88:91]
buffer_load_dwordx4 v12, s[32:35], s66 offen offset:3072 lds
v_mfma_f32_16x16x32_bf16 v[84:87], a[192:195], a[204:207], v[84:87]
s_add_u32 s66, s66, 114688
s_add_u32 m0, s68, 90112
v_mfma_f32_16x16x32_bf16 v[80:83], a[120:123], a[204:207], v[80:83]
ds_read_b64_tr_b16 a[254:255], v20 offset:25088
s_lshr_b32 s5, s5, 11
v_mfma_f32_16x16x32_bf16 v[96:99], a[120:123], a[208:211], v[96:99]
ds_read_b64_tr_b16 a[4:5], v19 offset:32768
s_and_b32 s27, s63, 1
v_mfma_f32_16x16x32_bf16 v[100:103], a[192:195], a[208:211], v[100:103]
ds_read_b64_tr_b16 a[6:7], v19 offset:33280
s_lshl_b32 s27, s27, 2
v_mfma_f32_16x16x32_bf16 v[104:107], a[196:199], a[208:211], v[104:107]
ds_read_b64_tr_b16 a[20:21], v20 offset:32768
s_add_u32 s27, s27, s60
v_mfma_f32_16x16x32_bf16 v[108:111], a[200:203], a[208:211], v[108:111]
buffer_load_dwordx4 v9, s[32:35], s66 offen offset:0 lds
v_mfma_f32_16x16x32_bf16 v[124:127], a[200:203], a[212:215], v[124:127]
ds_read_b64_tr_b16 a[22:23], v20 offset:33280
s_lshl_b32 s27, 1, s27
v_mfma_f32_16x16x32_bf16 v[120:123], a[196:199], a[212:215], v[120:123]
ds_read_b128 a[24:27], v14 offset:26624
s_or_b32 s27, s27, 7
v_mfma_f32_16x16x32_bf16 v[116:119], a[192:195], a[212:215], v[116:119]
ds_read_b128 a[28:31], v14 offset:28672
v_mfma_f32_16x16x32_bf16 v[112:115], a[120:123], a[212:215], v[112:115]
ds_read_b128 a[32:35], v14 offset:30720
v_mfma_f32_16x16x32_bf16 v[128:131], a[120:123], a[216:219], v[128:131]
buffer_load_dwordx4 v10, s[32:35], s66 offen offset:1024 lds
v_mfma_f32_16x16x32_bf16 v[132:135], a[192:195], a[216:219], v[132:135]
ds_read_b128 a[36:39], v14 offset:32768
v_mfma_f32_16x16x32_bf16 v[136:139], a[196:199], a[216:219], v[136:139]
ds_read_b128 a[40:43], v14 offset:34816
v_mfma_f32_16x16x32_bf16 v[140:143], a[200:203], a[216:219], v[140:143]
ds_read_b128 a[44:47], v14 offset:36864
s_cmp_lg_u32 s4, s5
s_cselect_b32 s6, 0x101, 1
s_mul_i32 s27, s27, s6
s_lshl_b32 s4, s4, 3
v_mfma_f32_16x16x32_bf16 v[156:159], a[200:203], a[220:223], v[156:159]
ds_read_b128 a[48:51], v14 offset:38912
s_lshl_b32 s5, s5, 3
v_mfma_f32_16x16x32_bf16 v[152:155], a[196:199], a[220:223], v[152:155]
ds_read_b128 a[52:55], v14 offset:40960
v_and_b32 v50, 7, v1
v_mfma_f32_16x16x32_bf16 v[148:151], a[192:195], a[220:223], v[148:151]
buffer_load_dwordx4 v11, s[32:35], s66 offen offset:2048 lds
v_mfma_f32_16x16x32_bf16 v[144:147], a[120:123], a[220:223], v[144:147]
ds_read_b128 a[0:3], v14 offset:43008
v_and_b32 v53, 8, v1
v_mfma_f32_16x16x32_bf16 v[160:163], a[120:123], a[224:227], v[160:163]
ds_read_b128 a[8:11], v14 offset:45056
v_add_u32 v51, s4, v50
v_mfma_f32_16x16x32_bf16 v[164:167], a[192:195], a[224:227], v[164:167]
v_add_u32 v52, s5, v50
v_cmp_eq_u32 vcc, 0, v53
v_mfma_f32_16x16x32_bf16 v[168:171], a[196:199], a[224:227], v[168:171]
s_mul_i32 s4, s7, 748
s_add_u32 s5, s4, 1309
v_mfma_f32_16x16x32_bf16 v[172:175], a[200:203], a[224:227], v[172:175]
buffer_load_dwordx4 v12, s[32:35], s66 offen offset:3072 lds
v_mfma_f32_16x16x32_bf16 v[188:191], a[200:203], a[228:231], v[188:191]
s_and_b32 s97, s70, 7
s_xor_b32 s97, s97, 3
v_mfma_f32_16x16x32_bf16 v[184:187], a[196:199], a[228:231], v[184:187]
s_mul_i32 s65, s97, 128
s_add_u32 m0, s67, 0
v_mfma_f32_16x16x32_bf16 v[180:183], a[192:195], a[228:231], v[180:183]
s_and_b32 s17, s63, 1
s_lshl_b32 s17, s17, 5
v_mfma_f32_16x16x32_bf16 v[176:179], a[120:123], a[228:231], v[176:179]
s_add_u32 s17, s17, s64
s_lshl_b32 s16, s17, 2
v_mfma_f32_16x16x32_bf16 v[192:195], a[120:123], a[232:235], v[192:195]
s_add_u32 s16, s16, s60
v_mfma_f32_16x16x32_bf16 v[196:199], a[192:195], a[232:235], v[196:199]
buffer_load_dwordx4 v2, s[28:31], s65 offen offset:0 lds
v_mfma_f32_16x16x32_bf16 v[200:203], a[196:199], a[232:235], v[200:203]
s_mul_i32 s17, s16, 7168
s_add_u32 s17, s17, 524288
v_mfma_f32_16x16x32_bf16 v[204:207], a[200:203], a[232:235], v[204:207]
s_lshl_b32 s16, s16, 11
v_mfma_f32_16x16x32_bf16 v[220:223], a[200:203], a[236:239], v[220:223]
v_min_u32 v58, 6, v1
v_mfma_f32_16x16x32_bf16 v[216:219], a[196:199], a[236:239], v[216:219]
v_lshl_add_u32 v58, v58, 10, s17
v_mfma_f32_16x16x32_bf16 v[212:215], a[192:195], a[236:239], v[212:215]
buffer_load_dwordx4 v3, s[28:31], s65 offen offset:1024 lds
v_mfma_f32_16x16x32_bf16 v[208:211], a[120:123], a[236:239], v[208:211]
v_and_b32 v57, 1, v1
v_mfma_f32_16x16x32_bf16 v[224:227], a[120:123], a[240:243], v[224:227]
v_lshl_add_u32 v57, v57, 10, s16
v_mfma_f32_16x16x32_bf16 v[228:231], a[192:195], a[240:243], v[228:231]
s_mov_b64 exec, 0x7f
buffer_load_dword v58, v58, s[48:51], 0 offen offset:384
s_mov_b64 exec, -1
v_mfma_f32_16x16x32_bf16 v[232:235], a[196:199], a[240:243], v[232:235]
s_mov_b64 exec, 0x3
buffer_load_dword v57, v57, s[44:47], 0 offen offset:384
s_mov_b64 exec, -1
v_mfma_f32_16x16x32_bf16 v[236:239], a[200:203], a[240:243], v[236:239]
s_waitcnt vmcnt(8) lgkmcnt(0)
s_barrier
v_mfma_f32_16x16x32_bf16 v[64:67], a[244:247], a[248:251], v[64:67]
buffer_load_dwordx4 v4, s[28:31], s65 offen offset:2048 lds
v_mfma_f32_16x16x32_bf16 v[68:71], a[252:255], a[248:251], v[68:71]
ds_read_b64_tr_b16 a[12:13], v17 offset:24576
v_cndmask_b32 v51, v52, v51, vcc
v_mfma_f32_16x16x32_bf16 v[72:75], a[4:7], a[248:251], v[72:75]
ds_read_b64_tr_b16 a[14:15], v17 offset:25088
s_lshr_b32 s4, s4, 11
v_mfma_f32_16x16x32_bf16 v[76:79], a[20:23], a[248:251], v[76:79]
ds_read_b128 a[16:19], v21 offset:0
s_lshr_b32 s5, s5, 11
v_mfma_f32_16x16x32_bf16 v[92:95], a[20:23], a[24:27], v[92:95]
ds_read_b64_tr_b16 a[56:57], v18 offset:24576
s_lshl_b32 s7, s60, 3
v_mfma_f32_16x16x32_bf16 v[88:91], a[4:7], a[24:27], v[88:91]
buffer_load_dwordx4 v5, s[28:31], s65 offen offset:3072 lds
v_mfma_f32_16x16x32_bf16 v[84:87], a[252:255], a[24:27], v[84:87]
s_add_u32 m0, s67, 4096
ds_read_b64_tr_b16 a[58:59], v18 offset:25088
v_mfma_f32_16x16x32_bf16 v[80:83], a[244:247], a[24:27], v[80:83]
ds_read_b64_tr_b16 a[64:65], v17 offset:32768
s_lshr_b32 s7, 0x60380e03, s7
v_mfma_f32_16x16x32_bf16 v[96:99], a[244:247], a[28:31], v[96:99]
ds_read_b64_tr_b16 a[66:67], v17 offset:33280
s_and_b32 s7, s7, 0xff
v_mfma_f32_16x16x32_bf16 v[100:103], a[252:255], a[28:31], v[100:103]
ds_read_b64_tr_b16 a[80:81], v18 offset:32768
v_mfma_f32_16x16x32_bf16 v[104:107], a[4:7], a[28:31], v[104:107]
ds_read_b64_tr_b16 a[82:83], v18 offset:33280
v_mfma_f32_16x16x32_bf16 v[108:111], a[20:23], a[28:31], v[108:111]
buffer_load_dwordx4 v6, s[28:31], s65 offen offset:0 lds
v_mfma_f32_16x16x32_bf16 v[124:127], a[20:23], a[32:35], v[124:127]
ds_read_b128 a[84:87], v21 offset:2048
v_mfma_f32_16x16x32_bf16 v[120:123], a[4:7], a[32:35], v[120:123]
ds_read_b128 a[88:91], v21 offset:4096
s_cmp_lg_u32 s4, s5
s_cselect_b32 s6, 0x101, 1
s_mul_i32 s7, s7, s6
s_lshl_b32 s7, s7, 16
v_mfma_f32_16x16x32_bf16 v[116:119], a[252:255], a[32:35], v[116:119]
ds_read_b128 a[92:95], v21 offset:6144
s_or_b32 s27, s27, s7
v_mfma_f32_16x16x32_bf16 v[112:115], a[244:247], a[32:35], v[112:115]
ds_read_b128 a[96:99], v21 offset:8192
s_mul_i32 s4, s4, 14
v_mfma_f32_16x16x32_bf16 v[128:131], a[244:247], a[36:39], v[128:131]
buffer_load_dwordx4 v7, s[28:31], s65 offen offset:1024 lds
v_mfma_f32_16x16x32_bf16 v[132:135], a[252:255], a[36:39], v[132:135]
s_and_b32 s97, s70, 7
s_xor_b32 s97, s97, 3
s_mul_i32 s5, s5, 14
v_mfma_f32_16x16x32_bf16 v[136:139], a[4:7], a[36:39], v[136:139]
s_mul_i32 s66, s97, 229376
s_add_u32 m0, s68, 106496
s_and_b32 s6, s63, 1
v_mfma_f32_16x16x32_bf16 v[140:143], a[20:23], a[36:39], v[140:143]
ds_read_b128 a[100:103], v21 offset:10240
s_mul_i32 s6, s6, 7
v_mfma_f32_16x16x32_bf16 v[156:159], a[20:23], a[40:43], v[156:159]
ds_read_b128 a[104:107], v21 offset:12288
s_add_u32 s6, s6, 88
v_mfma_f32_16x16x32_bf16 v[152:155], a[4:7], a[40:43], v[152:155]
ds_read_b128 a[108:111], v21 offset:14336
s_add_u32 s4, s4, s6
v_mfma_f32_16x16x32_bf16 v[148:151], a[252:255], a[40:43], v[148:151]
buffer_load_dwordx4 v9, s[32:35], s66 offen offset:0 lds
v_mfma_f32_16x16x32_bf16 v[144:147], a[244:247], a[40:43], v[144:147]
ds_read_b128 a[112:115], v21 offset:16384
s_add_u32 s5, s5, s6
v_mfma_f32_16x16x32_bf16 v[160:163], a[244:247], a[44:47], v[160:163]
ds_read_b128 a[60:63], v21 offset:18432
v_min_u32 v50, 6, v50
v_mfma_f32_16x16x32_bf16 v[164:167], a[252:255], a[44:47], v[164:167]
ds_read_b128 a[68:71], v21 offset:20480
v_add_u32 v52, s4, v50
v_mfma_f32_16x16x32_bf16 v[168:171], a[4:7], a[44:47], v[168:171]
v_add_u32 v53, s5, v50
v_cndmask_b32 v52, v53, v52, vcc
v_mfma_f32_16x16x32_bf16 v[172:175], a[20:23], a[44:47], v[172:175]
buffer_load_dwordx4 v10, s[32:35], s66 offen offset:1024 lds
v_mfma_f32_16x16x32_bf16 v[188:191], a[20:23], a[48:51], v[188:191]
v_cmp_gt_u32 vcc, 16, v1
s_add_u32 s4, s98, 84
v_mfma_f32_16x16x32_bf16 v[184:187], a[4:7], a[48:51], v[184:187]
s_sub_u32 s5, s98, 84
v_mfma_f32_16x16x32_bf16 v[180:183], a[252:255], a[48:51], v[180:183]
s_bitcmp1_b32 s63, 0
s_cselect_b32 s4, s5, s4
v_mfma_f32_16x16x32_bf16 v[176:179], a[244:247], a[48:51], v[176:179]
v_cndmask_b32 v51, v52, v51, vcc
v_mfma_f32_16x16x32_bf16 v[192:195], a[244:247], a[52:55], v[192:195]
v_mov_b32 v50, s98
v_mfma_f32_16x16x32_bf16 v[196:199], a[252:255], a[52:55], v[196:199]
buffer_load_dwordx4 v11, s[32:35], s66 offen offset:2048 lds
v_mfma_f32_16x16x32_bf16 v[200:203], a[4:7], a[52:55], v[200:203]
v_mov_b32 v53, s4
v_cmp_gt_u32 vcc, 48, v1
v_mfma_f32_16x16x32_bf16 v[204:207], a[20:23], a[52:55], v[204:207]
s_nop 0
v_cndmask_b32 v50, v50, v53, vcc
v_mfma_f32_16x16x32_bf16 v[220:223], a[20:23], a[0:3], v[220:223]
v_mfma_f32_16x16x32_bf16 v[216:219], a[4:7], a[0:3], v[216:219]
v_cmp_gt_u32 vcc, 32, v1
v_mfma_f32_16x16x32_bf16 v[212:215], a[252:255], a[0:3], v[212:215]
buffer_load_dwordx4 v12, s[32:35], s66 offen offset:3072 lds
v_mfma_f32_16x16x32_bf16 v[208:211], a[244:247], a[0:3], v[208:211]
v_cndmask_b32 v50, v50, v51, vcc
v_lshlrev_b32 v30, 7, v50
v_mfma_f32_16x16x32_bf16 v[224:227], a[244:247], a[8:11], v[224:227]
v_and_b32 v48, 31, v50
v_mfma_f32_16x16x32_bf16 v[228:231], a[252:255], a[8:11], v[228:231]
v_lshrrev_b32 v50, 5, v50
v_mfma_f32_16x16x32_bf16 v[232:235], a[4:7], a[8:11], v[232:235]
v_lshlrev_b32 v49, 3, v50
v_mfma_f32_16x16x32_bf16 v[236:239], a[20:23], a[8:11], v[236:239]
s_waitcnt vmcnt(12) lgkmcnt(0)
s_barrier
v_mfma_f32_16x16x32_bf16 v[64:67], a[12:15], a[16:19], v[64:67]
s_add_u32 s66, s66, 114688
s_add_u32 m0, s68, 122880
v_mfma_f32_16x16x32_bf16 v[68:71], a[56:59], a[16:19], v[68:71]
ds_read_b64_tr_b16 a[72:73], v17 offset:40960
s_mov_b32 s82, 0xbfb8aa3b
v_mfma_f32_16x16x32_bf16 v[72:75], a[64:67], a[16:19], v[72:75]
buffer_load_dwordx4 v9, s[32:35], s66 offen offset:0 lds
v_mfma_f32_16x16x32_bf16 v[76:79], a[80:83], a[16:19], v[76:79]
ds_read_b64_tr_b16 a[74:75], v17 offset:41472
s_mov_b32 s83, 0xbfb8aa3b
v_mfma_f32_16x16x32_bf16 v[92:95], a[80:83], a[84:87], v[92:95]
ds_read_b128 a[76:79], v22 offset:0
s_mov_b32 s84, 1.0
v_mfma_f32_16x16x32_bf16 v[88:91], a[64:67], a[84:87], v[88:91]
ds_read_b64_tr_b16 a[116:117], v18 offset:40960
s_mov_b32 s85, 1.0
v_mfma_f32_16x16x32_bf16 v[84:87], a[56:59], a[84:87], v[84:87]
buffer_load_dwordx4 v10, s[32:35], s66 offen offset:1024 lds
v_mfma_f32_16x16x32_bf16 v[80:83], a[12:15], a[84:87], v[80:83]
ds_read_b64_tr_b16 a[118:119], v18 offset:41472
s_lshl_b32 s4, s62, 2
v_mfma_f32_16x16x32_bf16 v[96:99], a[12:15], a[88:91], v[96:99]
ds_read_b64_tr_b16 a[124:125], v19 offset:0
s_add_u32 s4, s4, s60
v_mfma_f32_16x16x32_bf16 v[100:103], a[56:59], a[88:91], v[100:103]
ds_read_b64_tr_b16 a[126:127], v19 offset:512
s_add_u32 s4, s4, 16
v_mfma_f32_16x16x32_bf16 v[104:107], a[64:67], a[88:91], v[104:107]
buffer_load_dwordx4 v11, s[32:35], s66 offen offset:2048 lds
v_mfma_f32_16x16x32_bf16 v[108:111], a[80:83], a[88:91], v[108:111]
ds_read_b64_tr_b16 a[204:205], v20 offset:0
s_lshl_b32 s4, s4, 11
v_mfma_f32_16x16x32_bf16 v[124:127], a[80:83], a[92:95], v[124:127]
ds_read_b64_tr_b16 a[206:207], v20 offset:512
v_mfma_f32_16x16x32_bf16 v[120:123], a[64:67], a[92:95], v[120:123]
ds_read_b128 a[208:211], v22 offset:2048
v_lshlrev_b32 v61, 4, v1
v_mfma_f32_16x16x32_bf16 v[116:119], a[56:59], a[92:95], v[116:119]
buffer_load_dwordx4 v12, s[32:35], s66 offen offset:3072 lds
v_mfma_f32_16x16x32_bf16 v[112:115], a[12:15], a[92:95], v[112:115]
s_and_b32 s97, s70, 7
s_xor_b32 s97, s97, 4
v_mfma_f32_16x16x32_bf16 v[128:131], a[12:15], a[96:99], v[128:131]
s_mul_i32 s65, s97, 128
s_add_u32 m0, s67, 24576
v_mfma_f32_16x16x32_bf16 v[132:135], a[56:59], a[96:99], v[132:135]
ds_read_b128 a[212:215], v22 offset:4096
v_add_u32 v61, s4, v61
v_mfma_f32_16x16x32_bf16 v[136:139], a[64:67], a[96:99], v[136:139]
buffer_load_dwordx4 v2, s[28:31], s65 offen offset:0 lds
v_mfma_f32_16x16x32_bf16 v[140:143], a[80:83], a[96:99], v[140:143]
ds_read_b128 a[216:219], v22 offset:6144
s_add_u32 s6, s61, s99
v_mfma_f32_16x16x32_bf16 v[156:159], a[80:83], a[100:103], v[156:159]
ds_read_b128 a[220:223], v22 offset:8192
s_sub_u32 s7, s61, s99
v_mfma_f32_16x16x32_bf16 v[152:155], a[64:67], a[100:103], v[152:155]
ds_read_b128 a[224:227], v22 offset:10240
s_add_u32 s4, s6, 0
v_mfma_f32_16x16x32_bf16 v[148:151], a[56:59], a[100:103], v[148:151]
ds_read_b128 a[228:231], v22 offset:12288
s_lshr_b32 s5, s4, 2
v_mfma_f32_16x16x32_bf16 v[144:147], a[12:15], a[100:103], v[144:147]
buffer_load_dwordx4 v3, s[28:31], s65 offen offset:1024 lds
v_mfma_f32_16x16x32_bf16 v[160:163], a[12:15], a[104:107], v[160:163]
ds_read_b128 a[232:235], v22 offset:14336
s_mul_i32 s86, s5, 294912
v_mfma_f32_16x16x32_bf16 v[164:167], a[56:59], a[104:107], v[164:167]
ds_read_b128 a[236:239], v22 offset:16384
s_and_b32 s5, s4, 1
v_mfma_f32_16x16x32_bf16 v[168:171], a[64:67], a[104:107], v[168:171]
ds_read_b128 a[120:123], v22 offset:18432
s_mul_i32 s5, s5, 147456
v_mfma_f32_16x16x32_bf16 v[172:175], a[80:83], a[104:107], v[172:175]
buffer_load_dwordx4 v4, s[28:31], s65 offen offset:2048 lds
v_mfma_f32_16x16x32_bf16 v[188:191], a[80:83], a[108:111], v[188:191]
ds_read_b128 a[192:195], v22 offset:20480
s_add_u32 s86, s86, s5
v_mfma_f32_16x16x32_bf16 v[184:187], a[64:67], a[108:111], v[184:187]
s_and_b32 s4, s4, 2
v_mfma_f32_16x16x32_bf16 v[180:183], a[56:59], a[108:111], v[180:183]
s_lshl_b32 s4, s4, 9
v_mfma_f32_16x16x32_bf16 v[176:179], a[12:15], a[108:111], v[176:179]
buffer_load_dwordx4 v5, s[28:31], s65 offen offset:3072 lds
v_mfma_f32_16x16x32_bf16 v[192:195], a[12:15], a[112:115], v[192:195]
s_add_u32 m0, s67, 28672
s_add_u32 s86, s86, s4
v_mfma_f32_16x16x32_bf16 v[196:199], a[56:59], a[112:115], v[196:199]
v_mfma_f32_16x16x32_bf16 v[200:203], a[64:67], a[112:115], v[200:203]
s_add_u32 s4, s6, 2
v_mfma_f32_16x16x32_bf16 v[204:207], a[80:83], a[112:115], v[204:207]
buffer_load_dwordx4 v6, s[28:31], s65 offen offset:0 lds
v_mfma_f32_16x16x32_bf16 v[220:223], a[80:83], a[60:63], v[220:223]
s_lshr_b32 s5, s4, 2
v_mfma_f32_16x16x32_bf16 v[216:219], a[64:67], a[60:63], v[216:219]
s_mul_i32 s87, s5, 294912
v_mfma_f32_16x16x32_bf16 v[212:215], a[56:59], a[60:63], v[212:215]
v_mfma_f32_16x16x32_bf16 v[208:211], a[12:15], a[60:63], v[208:211]
buffer_load_dwordx4 v7, s[28:31], s65 offen offset:1024 lds
v_mfma_f32_16x16x32_bf16 v[224:227], a[12:15], a[68:71], v[224:227]
s_and_b32 s5, s4, 1
s_mul_i32 s5, s5, 147456
v_mfma_f32_16x16x32_bf16 v[228:231], a[56:59], a[68:71], v[228:231]
v_mfma_f32_16x16x32_bf16 v[232:235], a[64:67], a[68:71], v[232:235]
s_add_u32 s87, s87, s5
v_mfma_f32_16x16x32_bf16 v[236:239], a[80:83], a[68:71], v[236:239]
s_waitcnt vmcnt(10) lgkmcnt(0)
s_barrier
v_mfma_f32_16x16x32_bf16 v[64:67], a[72:75], a[76:79], v[64:67]
s_and_b32 s97, s70, 7
s_xor_b32 s97, s97, 4
v_mfma_f32_16x16x32_bf16 v[68:71], a[116:119], a[76:79], v[68:71]
s_mul_i32 s66, s97, 229376
s_add_u32 m0, s68, 73728
v_mfma_f32_16x16x32_bf16 v[72:75], a[124:127], a[76:79], v[72:75]
buffer_load_dwordx4 v9, s[32:35], s66 offen offset:0 lds
v_mfma_f32_16x16x32_bf16 v[76:79], a[204:207], a[76:79], v[76:79]
ds_read_b64_tr_b16 a[196:197], v19 offset:8192
s_and_b32 s4, s4, 2
v_mfma_f32_16x16x32_bf16 v[92:95], a[204:207], a[208:211], v[92:95]
ds_read_b64_tr_b16 a[198:199], v19 offset:8704
s_lshl_b32 s4, s4, 9
v_mfma_f32_16x16x32_bf16 v[88:91], a[124:127], a[208:211], v[88:91]
ds_read_b128 a[200:203], v13 offset:0
s_add_u32 s87, s87, s4
v_mfma_f32_16x16x32_bf16 v[84:87], a[116:119], a[208:211], v[84:87]
buffer_load_dwordx4 v10, s[32:35], s66 offen offset:1024 lds
v_mfma_f32_16x16x32_bf16 v[80:83], a[72:75], a[208:211], v[80:83]
ds_read_b64_tr_b16 a[240:241], v20 offset:8192
s_add_u32 s4, s6, 4
v_mfma_f32_16x16x32_bf16 v[96:99], a[72:75], a[212:215], v[96:99]
ds_read_b64_tr_b16 a[242:243], v20 offset:8704
s_lshr_b32 s5, s4, 2
v_mfma_f32_16x16x32_bf16 v[100:103], a[116:119], a[212:215], v[100:103]
ds_read_b64_tr_b16 a[248:249], v19 offset:16384
s_mul_i32 s88, s5, 294912
v_mfma_f32_16x16x32_bf16 v[104:107], a[124:127], a[212:215], v[104:107]
buffer_load_dwordx4 v11, s[32:35], s66 offen offset:2048 lds
v_mfma_f32_16x16x32_bf16 v[108:111], a[204:207], a[212:215], v[108:111]
ds_read_b64_tr_b16 a[250:251], v19 offset:16896
s_and_b32 s5, s4, 1
v_mfma_f32_16x16x32_bf16 v[124:127], a[204:207], a[216:219], v[124:127]
ds_read_b64_tr_b16 a[24:25], v20 offset:16384
s_mul_i32 s5, s5, 147456
v_mfma_f32_16x16x32_bf16 v[120:123], a[124:127], a[216:219], v[120:123]
ds_read_b64_tr_b16 a[26:27], v20 offset:16896
v_mfma_f32_16x16x32_bf16 v[116:119], a[116:119], a[216:219], v[116:119]
buffer_load_dwordx4 v12, s[32:35], s66 offen offset:3072 lds
v_mfma_f32_16x16x32_bf16 v[112:115], a[72:75], a[216:219], v[112:115]
s_add_u32 s66, s66, 114688
s_add_u32 m0, s68, 90112
v_mfma_f32_16x16x32_bf16 v[128:131], a[72:75], a[220:223], v[128:131]
ds_read_b128 a[28:31], v13 offset:2048
s_add_u32 s88, s88, s5
v_mfma_f32_16x16x32_bf16 v[132:135], a[116:119], a[220:223], v[132:135]
ds_read_b128 a[32:35], v13 offset:4096
s_and_b32 s4, s4, 2
v_mfma_f32_16x16x32_bf16 v[136:139], a[124:127], a[220:223], v[136:139]
buffer_load_dwordx4 v9, s[32:35], s66 offen offset:0 lds
v_mfma_f32_16x16x32_bf16 v[140:143], a[204:207], a[220:223], v[140:143]
ds_read_b128 a[36:39], v13 offset:6144
s_lshl_b32 s4, s4, 9
v_mfma_f32_16x16x32_bf16 v[156:159], a[204:207], a[224:227], v[156:159]
ds_read_b128 a[40:43], v13 offset:8192
s_add_u32 s88, s88, s4
v_mfma_f32_16x16x32_bf16 v[152:155], a[124:127], a[224:227], v[152:155]
ds_read_b128 a[44:47], v13 offset:10240
s_add_u32 s4, s6, 6
v_mfma_f32_16x16x32_bf16 v[148:151], a[116:119], a[224:227], v[148:151]
ds_read_b128 a[48:51], v13 offset:12288
s_lshr_b32 s5, s4, 2
v_mfma_f32_16x16x32_bf16 v[144:147], a[72:75], a[224:227], v[144:147]
buffer_load_dwordx4 v10, s[32:35], s66 offen offset:1024 lds
v_mfma_f32_16x16x32_bf16 v[160:163], a[72:75], a[228:231], v[160:163]
ds_read_b128 a[52:55], v13 offset:14336
s_mul_i32 s89, s5, 294912
v_mfma_f32_16x16x32_bf16 v[164:167], a[116:119], a[228:231], v[164:167]
ds_read_b128 a[0:3], v13 offset:16384
v_mfma_f32_16x16x32_bf16 v[168:171], a[124:127], a[228:231], v[168:171]
ds_read_b128 a[244:247], v13 offset:18432
s_and_b32 s5, s4, 1
v_mfma_f32_16x16x32_bf16 v[172:175], a[204:207], a[228:231], v[172:175]
buffer_load_dwordx4 v11, s[32:35], s66 offen offset:2048 lds
v_mfma_f32_16x16x32_bf16 v[188:191], a[204:207], a[232:235], v[188:191]
ds_read_b128 a[252:255], v13 offset:20480
s_mul_i32 s5, s5, 147456
v_mfma_f32_16x16x32_bf16 v[184:187], a[124:127], a[232:235], v[184:187]
s_add_u32 s89, s89, s5
v_mfma_f32_16x16x32_bf16 v[180:183], a[116:119], a[232:235], v[180:183]
v_mfma_f32_16x16x32_bf16 v[176:179], a[72:75], a[232:235], v[176:179]
buffer_load_dwordx4 v12, s[32:35], s66 offen offset:3072 lds
v_mfma_f32_16x16x32_bf16 v[192:195], a[72:75], a[236:239], v[192:195]
s_lshl_b32 s77, s74, 4
s_add_u32 m0, s71, 139264
v_mfma_f32_16x16x32_bf16 v[196:199], a[116:119], a[236:239], v[196:199]
s_and_b32 s4, s4, 2
s_lshl_b32 s4, s4, 9
v_mfma_f32_16x16x32_bf16 v[200:203], a[124:127], a[236:239], v[200:203]
v_mfma_f32_16x16x32_bf16 v[204:207], a[204:207], a[236:239], v[204:207]
buffer_load_dwordx4 v62, s[44:47], s77 offen offset:0 lds
v_mfma_f32_16x16x32_bf16 v[220:223], a[204:207], a[120:123], v[220:223]
s_add_u32 s89, s89, s4
s_add_u32 s4, s6, 8
v_mfma_f32_16x16x32_bf16 v[216:219], a[124:127], a[120:123], v[216:219]
v_mfma_f32_16x16x32_bf16 v[212:215], a[116:119], a[120:123], v[212:215]
s_lshr_b32 s5, s4, 2
v_mfma_f32_16x16x32_bf16 v[208:211], a[72:75], a[120:123], v[208:211]
buffer_load_dwordx4 v0, s[44:47], s77 offen offset:1024 lds
v_mfma_f32_16x16x32_bf16 v[224:227], a[72:75], a[192:195], v[224:227]
s_mul_i32 s90, s5, 294912
v_mfma_f32_16x16x32_bf16 v[228:231], a[116:119], a[192:195], v[228:231]
v_mfma_f32_16x16x32_bf16 v[232:235], a[124:127], a[192:195], v[232:235]
s_and_b32 s5, s4, 1
v_mfma_f32_16x16x32_bf16 v[236:239], a[204:207], a[192:195], v[236:239]
s_waitcnt vmcnt(16) lgkmcnt(0)
s_barrier
v_mfma_f32_16x16x32_bf16 v[64:67], a[196:199], a[200:203], v[64:67]
s_and_b32 s97, s70, 7
s_xor_b32 s97, s97, 5
v_mfma_f32_16x16x32_bf16 v[68:71], a[240:243], a[200:203], v[68:71]
s_mul_i32 s65, s97, 128
s_add_u32 m0, s67, 49152
v_mfma_f32_16x16x32_bf16 v[72:75], a[248:251], a[200:203], v[72:75]
buffer_load_dwordx4 v2, s[28:31], s65 offen offset:0 lds
v_mfma_f32_16x16x32_bf16 v[76:79], a[24:27], a[200:203], v[76:79]
ds_read_b64_tr_b16 a[4:5], v19 offset:24576
s_mul_i32 s5, s5, 147456
v_mfma_f32_16x16x32_bf16 v[92:95], a[24:27], a[28:31], v[92:95]
ds_read_b64_tr_b16 a[6:7], v19 offset:25088
s_add_u32 s90, s90, s5
v_mfma_f32_16x16x32_bf16 v[88:91], a[248:251], a[28:31], v[88:91]
ds_read_b128 a[20:23], v14 offset:0
s_and_b32 s4, s4, 2
v_mfma_f32_16x16x32_bf16 v[84:87], a[240:243], a[28:31], v[84:87]
buffer_load_dwordx4 v3, s[28:31], s65 offen offset:1024 lds
v_mfma_f32_16x16x32_bf16 v[80:83], a[196:199], a[28:31], v[80:83]
ds_read_b64_tr_b16 a[8:9], v20 offset:24576
s_lshl_b32 s4, s4, 9
v_mfma_f32_16x16x32_bf16 v[96:99], a[196:199], a[32:35], v[96:99]
ds_read_b64_tr_b16 a[10:11], v20 offset:25088
s_add_u32 s90, s90, s4
v_mfma_f32_16x16x32_bf16 v[100:103], a[240:243], a[32:35], v[100:103]
ds_read_b64_tr_b16 a[16:17], v19 offset:32768
s_add_u32 s4, s61, 10
v_mfma_f32_16x16x32_bf16 v[104:107], a[248:251], a[32:35], v[104:107]
buffer_load_dwordx4 v4, s[28:31], s65 offen offset:2048 lds
v_mfma_f32_16x16x32_bf16 v[108:111], a[24:27], a[32:35], v[108:111]
ds_read_b64_tr_b16 a[18:19], v19 offset:33280
s_lshr_b32 s5, s4, 2
v_mfma_f32_16x16x32_bf16 v[124:127], a[24:27], a[36:39], v[124:127]
ds_read_b64_tr_b16 a[84:85], v20 offset:32768
s_mul_i32 s91, s5, 294912
v_mfma_f32_16x16x32_bf16 v[120:123], a[248:251], a[36:39], v[120:123]
ds_read_b64_tr_b16 a[86:87], v20 offset:33280
v_mfma_f32_16x16x32_bf16 v[116:119], a[240:243], a[36:39], v[116:119]
buffer_load_dwordx4 v5, s[28:31], s65 offen offset:3072 lds
v_mfma_f32_16x16x32_bf16 v[112:115], a[196:199], a[36:39], v[112:115]
s_add_u32 m0, s67, 53248
ds_read_b128 a[88:91], v14 offset:2048
v_mfma_f32_16x16x32_bf16 v[128:131], a[196:199], a[40:43], v[128:131]
ds_read_b128 a[92:95], v14 offset:4096
s_and_b32 s5, s4, 1
v_mfma_f32_16x16x32_bf16 v[132:135], a[240:243], a[40:43], v[132:135]
ds_read_b128 a[96:99], v14 offset:6144
s_mul_i32 s5, s5, 147456
v_mfma_f32_16x16x32_bf16 v[136:139], a[248:251], a[40:43], v[136:139]
buffer_load_dwordx4 v6, s[28:31], s65 offen offset:0 lds
v_mfma_f32_16x16x32_bf16 v[140:143], a[24:27], a[40:43], v[140:143]
ds_read_b128 a[100:103], v14 offset:8192
s_add_u32 s91, s91, s5
v_mfma_f32_16x16x32_bf16 v[156:159], a[24:27], a[44:47], v[156:159]
ds_read_b128 a[104:107], v14 offset:10240
s_and_b32 s4, s4, 2
v_mfma_f32_16x16x32_bf16 v[152:155], a[248:251], a[44:47], v[152:155]
ds_read_b128 a[108:111], v14 offset:12288
s_lshl_b32 s4, s4, 9
v_mfma_f32_16x16x32_bf16 v[148:151], a[240:243], a[44:47], v[148:151]
ds_read_b128 a[112:115], v14 offset:14336
s_add_u32 s91, s91, s4
v_mfma_f32_16x16x32_bf16 v[144:147], a[196:199], a[44:47], v[144:147]
buffer_load_dwordx4 v7, s[28:31], s65 offen offset:1024 lds
v_mfma_f32_16x16x32_bf16 v[160:163], a[196:199], a[48:51], v[160:163]
s_and_b32 s97, s70, 7
s_xor_b32 s97, s97, 5
v_mfma_f32_16x16x32_bf16 v[164:167], a[240:243], a[48:51], v[164:167]
s_mul_i32 s66, s97, 229376
s_add_u32 m0, s68, 106496
v_mfma_f32_16x16x32_bf16 v[168:171], a[248:251], a[48:51], v[168:171]
ds_read_b128 a[60:63], v14 offset:16384
s_add_u32 s4, s7, 1
v_mfma_f32_16x16x32_bf16 v[172:175], a[24:27], a[48:51], v[172:175]
buffer_load_dwordx4 v9, s[32:35], s66 offen offset:0 lds
v_mfma_f32_16x16x32_bf16 v[188:191], a[24:27], a[52:55], v[188:191]
ds_read_b128 a[12:15], v14 offset:18432
s_lshr_b32 s5, s4, 2
v_mfma_f32_16x16x32_bf16 v[184:187], a[248:251], a[52:55], v[184:187]
ds_read_b128 a[56:59], v14 offset:20480
s_mul_i32 s92, s5, 294912
v_mfma_f32_16x16x32_bf16 v[180:183], a[240:243], a[52:55], v[180:183]
s_and_b32 s5, s4, 1
v_mfma_f32_16x16x32_bf16 v[176:179], a[196:199], a[52:55], v[176:179]
buffer_load_dwordx4 v10, s[32:35], s66 offen offset:1024 lds
v_mfma_f32_16x16x32_bf16 v[192:195], a[196:199], a[0:3], v[192:195]
s_mul_i32 s5, s5, 147456
v_mfma_f32_16x16x32_bf16 v[196:199], a[240:243], a[0:3], v[196:199]
s_add_u32 s92, s92, s5
v_mfma_f32_16x16x32_bf16 v[200:203], a[248:251], a[0:3], v[200:203]
v_mfma_f32_16x16x32_bf16 v[204:207], a[24:27], a[0:3], v[204:207]
buffer_load_dwordx4 v11, s[32:35], s66 offen offset:2048 lds
v_mfma_f32_16x16x32_bf16 v[220:223], a[24:27], a[244:247], v[220:223]
H_T1:
s_cbranch_execz H_Tret
s_and_b32 s4, s4, 2
s_lshl_b32 s4, s4, 9
v_mfma_f32_16x16x32_bf16 v[216:219], a[248:251], a[244:247], v[216:219]
v_mfma_f32_16x16x32_bf16 v[212:215], a[240:243], a[244:247], v[212:215]
s_add_u32 s92, s92, s4
v_mfma_f32_16x16x32_bf16 v[208:211], a[196:199], a[244:247], v[208:211]
buffer_load_dwordx4 v12, s[32:35], s66 offen offset:3072 lds
v_mfma_f32_16x16x32_bf16 v[224:227], a[196:199], a[252:255], v[224:227]
s_add_u32 s4, s7, 3
v_mfma_f32_16x16x32_bf16 v[228:231], a[240:243], a[252:255], v[228:231]
v_mfma_f32_16x16x32_bf16 v[232:235], a[248:251], a[252:255], v[232:235]
s_lshr_b32 s5, s4, 2
v_mfma_f32_16x16x32_bf16 v[236:239], a[24:27], a[252:255], v[236:239]
s_waitcnt vmcnt(16) lgkmcnt(0)
s_barrier
v_mfma_f32_16x16x32_bf16 v[64:67], a[4:7], a[20:23], v[64:67]
s_add_u32 s66, s66, 114688
s_add_u32 m0, s68, 122880
v_mfma_f32_16x16x32_bf16 v[68:71], a[8:11], a[20:23], v[68:71]
ds_read_b64_tr_b16 a[64:65], v17 offset:24576
s_mul_i32 s93, s5, 294912
v_mfma_f32_16x16x32_bf16 v[72:75], a[16:19], a[20:23], v[72:75]
buffer_load_dwordx4 v9, s[32:35], s66 offen offset:0 lds
v_mfma_f32_16x16x32_bf16 v[76:79], a[84:87], a[20:23], v[76:79]
ds_read_b64_tr_b16 a[66:67], v17 offset:25088
s_and_b32 s5, s4, 1
v_mfma_f32_16x16x32_bf16 v[92:95], a[84:87], a[88:91], v[92:95]
ds_read_b128 a[80:83], v13 offset:24576
s_mul_i32 s5, s5, 147456
v_mfma_f32_16x16x32_bf16 v[88:91], a[16:19], a[88:91], v[88:91]
ds_read_b64_tr_b16 a[68:69], v18 offset:24576
v_mfma_f32_16x16x32_bf16 v[84:87], a[8:11], a[88:91], v[84:87]
buffer_load_dwordx4 v10, s[32:35], s66 offen offset:1024 lds
v_mfma_f32_16x16x32_bf16 v[80:83], a[4:7], a[88:91], v[80:83]
ds_read_b64_tr_b16 a[70:71], v18 offset:25088
s_add_u32 s93, s93, s5
v_mfma_f32_16x16x32_bf16 v[96:99], a[4:7], a[92:95], v[96:99]
ds_read_b64_tr_b16 a[76:77], v17 offset:32768
s_and_b32 s4, s4, 2
v_mfma_f32_16x16x32_bf16 v[100:103], a[8:11], a[92:95], v[100:103]
ds_read_b64_tr_b16 a[78:79], v17 offset:33280
v_mfma_f32_16x16x32_bf16 v[104:107], a[16:19], a[92:95], v[104:107]
buffer_load_dwordx4 v11, s[32:35], s66 offen offset:2048 lds
v_mfma_f32_16x16x32_bf16 v[108:111], a[84:87], a[92:95], v[108:111]
ds_read_b64_tr_b16 a[208:209], v18 offset:32768
s_lshl_b32 s4, s4, 9
v_mfma_f32_16x16x32_bf16 v[124:127], a[84:87], a[96:99], v[124:127]
ds_read_b64_tr_b16 a[210:211], v18 offset:33280
s_add_u32 s93, s93, s4
v_mfma_f32_16x16x32_bf16 v[120:123], a[16:19], a[96:99], v[120:123]
ds_read_b128 a[212:215], v13 offset:26624
v_mfma_f32_16x16x32_bf16 v[116:119], a[8:11], a[96:99], v[116:119]
buffer_load_dwordx4 v12, s[32:35], s66 offen offset:3072 lds
v_mfma_f32_16x16x32_bf16 v[112:115], a[4:7], a[96:99], v[112:115]
s_add_u32 s77, s77, 16384
s_add_u32 m0, s71, 147456
v_mfma_f32_16x16x32_bf16 v[128:131], a[4:7], a[100:103], v[128:131]
ds_read_b128 a[216:219], v13 offset:28672
s_add_u32 s4, s7, 5
v_mfma_f32_16x16x32_bf16 v[132:135], a[8:11], a[100:103], v[132:135]
ds_read_b128 a[220:223], v13 offset:30720
s_lshr_b32 s5, s4, 2
v_mfma_f32_16x16x32_bf16 v[136:139], a[16:19], a[100:103], v[136:139]
buffer_load_dwordx4 v62, s[44:47], s77 offen offset:0 lds
v_mfma_f32_16x16x32_bf16 v[140:143], a[84:87], a[100:103], v[140:143]
ds_read_b128 a[224:227], v13 offset:32768
s_mul_i32 s94, s5, 294912
v_mfma_f32_16x16x32_bf16 v[156:159], a[84:87], a[104:107], v[156:159]
ds_read_b128 a[228:231], v13 offset:34816
s_and_b32 s5, s4, 1
v_mfma_f32_16x16x32_bf16 v[152:155], a[16:19], a[104:107], v[152:155]
ds_read_b128 a[232:235], v13 offset:36864
v_mfma_f32_16x16x32_bf16 v[148:151], a[8:11], a[104:107], v[148:151]
ds_read_b128 a[236:239], v13 offset:38912
s_mul_i32 s5, s5, 147456
v_mfma_f32_16x16x32_bf16 v[144:147], a[4:7], a[104:107], v[144:147]
buffer_load_dwordx4 v0, s[44:47], s77 offen offset:1024 lds
v_mfma_f32_16x16x32_bf16 v[160:163], a[4:7], a[108:111], v[160:163]
s_lshl_b32 s77, s75, 4
s_add_u32 m0, s71, 155648
v_mfma_f32_16x16x32_bf16 v[164:167], a[8:11], a[108:111], v[164:167]
ds_read_b128 a[120:123], v13 offset:40960
s_add_u32 s94, s94, s5
v_mfma_f32_16x16x32_bf16 v[168:171], a[16:19], a[108:111], v[168:171]
ds_read_b128 a[72:75], v13 offset:43008
s_and_b32 s4, s4, 2
v_mfma_f32_16x16x32_bf16 v[172:175], a[84:87], a[108:111], v[172:175]
buffer_load_dwordx4 v62, s[44:47], s77 offen offset:0 lds
v_mfma_f32_16x16x32_bf16 v[188:191], a[84:87], a[112:115], v[188:191]
ds_read_b128 a[116:119], v13 offset:45056
s_lshl_b32 s4, s4, 9
v_mfma_f32_16x16x32_bf16 v[184:187], a[16:19], a[112:115], v[184:187]
v_mfma_f32_16x16x32_bf16 v[180:183], a[8:11], a[112:115], v[180:183]
s_add_u32 s94, s94, s4
v_mfma_f32_16x16x32_bf16 v[176:179], a[4:7], a[112:115], v[176:179]
buffer_load_dwordx4 v0, s[44:47], s77 offen offset:1024 lds
v_mfma_f32_16x16x32_bf16 v[192:195], a[4:7], a[60:63], v[192:195]
s_and_b32 s97, s70, 7
s_xor_b32 s97, s97, 6
v_mfma_f32_16x16x32_bf16 v[196:199], a[8:11], a[60:63], v[196:199]
s_mul_i32 s65, s97, 128
s_add_u32 m0, s67, 0
v_mfma_f32_16x16x32_bf16 v[200:203], a[16:19], a[60:63], v[200:203]
s_add_u32 s4, s7, 7
s_lshr_b32 s5, s4, 2
v_mfma_f32_16x16x32_bf16 v[204:207], a[84:87], a[60:63], v[204:207]
buffer_load_dwordx4 v2, s[28:31], s65 offen offset:0 lds
v_mfma_f32_16x16x32_bf16 v[220:223], a[84:87], a[12:15], v[220:223]
s_mul_i32 s95, s5, 294912
v_mfma_f32_16x16x32_bf16 v[216:219], a[16:19], a[12:15], v[216:219]
v_mfma_f32_16x16x32_bf16 v[212:215], a[8:11], a[12:15], v[212:215]
s_and_b32 s5, s4, 1
v_mfma_f32_16x16x32_bf16 v[208:211], a[4:7], a[12:15], v[208:211]
buffer_load_dwordx4 v3, s[28:31], s65 offen offset:1024 lds
v_mfma_f32_16x16x32_bf16 v[224:227], a[4:7], a[56:59], v[224:227]
s_mul_i32 s5, s5, 147456
v_mfma_f32_16x16x32_bf16 v[228:231], a[8:11], a[56:59], v[228:231]
v_mfma_f32_16x16x32_bf16 v[232:235], a[16:19], a[56:59], v[232:235]
s_add_u32 s95, s95, s5
v_mfma_f32_16x16x32_bf16 v[236:239], a[84:87], a[56:59], v[236:239]
s_waitcnt vmcnt(20) lgkmcnt(0)
s_barrier
v_mfma_f32_16x16x32_bf16 v[64:67], a[64:67], a[80:83], v[64:67]
buffer_load_dwordx4 v4, s[28:31], s65 offen offset:2048 lds
v_mfma_f32_16x16x32_bf16 v[68:71], a[68:71], a[80:83], v[68:71]
ds_read_b64_tr_b16 a[124:125], v17 offset:40960
s_and_b32 s4, s4, 2
v_mfma_f32_16x16x32_bf16 v[72:75], a[76:79], a[80:83], v[72:75]
ds_read_b64_tr_b16 a[126:127], v17 offset:41472
v_mfma_f32_16x16x32_bf16 v[76:79], a[208:211], a[80:83], v[76:79]
ds_read_b128 a[204:207], v14 offset:24576
s_lshl_b32 s4, s4, 9
v_mfma_f32_16x16x32_bf16 v[92:95], a[208:211], a[212:215], v[92:95]
ds_read_b64_tr_b16 a[192:193], v18 offset:40960
v_mfma_f32_16x16x32_bf16 v[88:91], a[76:79], a[212:215], v[88:91]
buffer_load_dwordx4 v5, s[28:31], s65 offen offset:3072 lds
v_mfma_f32_16x16x32_bf16 v[84:87], a[68:71], a[212:215], v[84:87]
s_add_u32 m0, s67, 4096
ds_read_b64_tr_b16 a[194:195], v18 offset:41472
v_mfma_f32_16x16x32_bf16 v[80:83], a[64:67], a[212:215], v[80:83]
ds_read_b64_tr_b16 a[200:201], v19 offset:0
s_add_u32 s95, s95, s4
v_mfma_f32_16x16x32_bf16 v[96:99], a[64:67], a[216:219], v[96:99]
ds_read_b64_tr_b16 a[202:203], v19 offset:512
v_mfma_f32_16x16x32_bf16 v[100:103], a[68:71], a[216:219], v[100:103]
ds_read_b64_tr_b16 a[28:29], v20 offset:0
ds_read_b64_tr_b16 a[128:129], v37 offset:8192
v_mfma_f32_16x16x32_bf16 v[104:107], a[76:79], a[216:219], v[104:107]
ds_read_b64_tr_b16 a[30:31], v20 offset:512
s_add_u32 s4, s7, 9
v_mfma_f32_16x16x32_bf16 v[108:111], a[208:211], a[216:219], v[108:111]
buffer_load_dwordx4 v6, s[28:31], s65 offen offset:0 lds
v_mfma_f32_16x16x32_bf16 v[124:127], a[208:211], a[220:223], v[124:127]
ds_read_b128 a[32:35], v14 offset:26624
s_lshr_b32 s5, s4, 2
v_mfma_f32_16x16x32_bf16 v[120:123], a[76:79], a[220:223], v[120:123]
ds_read_b128 a[36:39], v14 offset:28672
v_mfma_f32_16x16x32_bf16 v[116:119], a[68:71], a[220:223], v[116:119]
ds_read_b128 a[40:43], v14 offset:30720
v_mfma_f32_16x16x32_bf16 v[112:115], a[64:67], a[220:223], v[112:115]
ds_read_b128 a[44:47], v14 offset:32768
s_mul_i32 s96, s5, 294912
v_mfma_f32_16x16x32_bf16 v[128:131], a[64:67], a[224:227], v[128:131]
buffer_load_dwordx4 v7, s[28:31], s65 offen offset:1024 lds
v_mfma_f32_16x16x32_bf16 v[132:135], a[68:71], a[224:227], v[132:135]
s_and_b32 s97, s70, 7
s_xor_b32 s97, s97, 6
v_mfma_f32_16x16x32_bf16 v[136:139], a[76:79], a[224:227], v[136:139]
s_mul_i32 s66, s97, 229376
s_add_u32 m0, s68, 73728
v_mfma_f32_16x16x32_bf16 v[140:143], a[208:211], a[224:227], v[140:143]
ds_read_b128 a[48:51], v14 offset:34816
ds_read_b64_tr_b16 a[132:133], v39 offset:8192
v_mfma_f32_16x16x32_bf16 v[156:159], a[208:211], a[228:231], v[156:159]
ds_read_b128 a[52:55], v14 offset:36864
s_and_b32 s5, s4, 1
v_mfma_f32_16x16x32_bf16 v[152:155], a[76:79], a[228:231], v[152:155]
ds_read_b128 a[0:3], v14 offset:38912
s_mul_i32 s5, s5, 147456
v_mfma_f32_16x16x32_bf16 v[148:151], a[68:71], a[228:231], v[148:151]
buffer_load_dwordx4 v9, s[32:35], s66 offen offset:0 lds
v_mfma_f32_16x16x32_bf16 v[144:147], a[64:67], a[228:231], v[144:147]
ds_read_b128 a[244:247], v14 offset:40960
v_mfma_f32_16x16x32_bf16 v[160:163], a[64:67], a[232:235], v[160:163]
ds_read_b128 a[196:199], v14 offset:43008
s_add_u32 s96, s96, s5
v_mfma_f32_16x16x32_bf16 v[164:167], a[68:71], a[232:235], v[164:167]
ds_read_b128 a[240:243], v14 offset:45056
v_mfma_f32_16x16x32_bf16 v[168:171], a[76:79], a[232:235], v[168:171]
v_mfma_f32_16x16x32_bf16 v[172:175], a[208:211], a[232:235], v[172:175]
buffer_load_dwordx4 v10, s[32:35], s66 offen offset:1024 lds
v_mfma_f32_16x16x32_bf16 v[188:191], a[208:211], a[236:239], v[188:191]
s_and_b32 s4, s4, 2
v_mfma_f32_16x16x32_bf16 v[184:187], a[76:79], a[236:239], v[184:187]
ds_read_b64_tr_b16 a[136:137], v41 offset:8192
v_mfma_f32_16x16x32_bf16 v[180:183], a[68:71], a[236:239], v[180:183]
s_lshl_b32 s4, s4, 9
v_mfma_f32_16x16x32_bf16 v[176:179], a[64:67], a[236:239], v[176:179]
v_mfma_f32_16x16x32_bf16 v[192:195], a[64:67], a[120:123], v[192:195]
v_mfma_f32_16x16x32_bf16 v[196:199], a[68:71], a[120:123], v[196:199]
buffer_load_dwordx4 v11, s[32:35], s66 offen offset:2048 lds
v_mfma_f32_16x16x32_bf16 v[200:203], a[76:79], a[120:123], v[200:203]
s_add_u32 s96, s96, s4
v_mfma_f32_16x16x32_bf16 v[204:207], a[208:211], a[120:123], v[204:207]
v_mfma_f32_16x16x32_bf16 v[220:223], a[208:211], a[72:75], v[220:223]
buffer_load_dwordx2 v[28:29], v49, s[56:59], 0 offen sc1
v_mfma_f32_16x16x32_bf16 v[216:219], a[76:79], a[72:75], v[216:219]
v_mfma_f32_16x16x32_bf16 v[212:215], a[68:71], a[72:75], v[212:215]
buffer_load_dwordx4 v12, s[32:35], s66 offen offset:3072 lds
v_mfma_f32_16x16x32_bf16 v[208:211], a[64:67], a[72:75], v[208:211]
ds_read_b64_tr_b16 a[140:141], v43 offset:8192
v_mfma_f32_16x16x32_bf16 v[224:227], a[64:67], a[116:119], v[224:227]
v_mfma_f32_16x16x32_bf16 v[228:231], a[68:71], a[116:119], v[228:231]
v_mfma_f32_16x16x32_bf16 v[232:235], a[76:79], a[116:119], v[232:235]
v_mfma_f32_16x16x32_bf16 v[236:239], a[208:211], a[116:119], v[236:239]
s_waitcnt vmcnt(11) lgkmcnt(1)
s_barrier
s_waitcnt lgkmcnt(0)
v_mfma_f32_16x16x32_bf16 v[64:67], a[124:127], a[204:207], v[64:67]
s_add_u32 s66, s66, 114688
s_add_u32 m0, s68, 90112
v_mfma_f32_16x16x32_bf16 v[68:71], a[192:195], a[204:207], v[68:71]
ds_read_b64_tr_b16 a[248:249], v19 offset:8192
ds_read_b64_tr_b16 a[250:251], v19 offset:8704
v_mfma_f32_16x16x32_bf16 v[72:75], a[200:203], a[204:207], v[72:75]
buffer_load_dwordx4 v9, s[32:35], s66 offen offset:0 lds
v_mfma_f32_16x16x32_bf16 v[76:79], a[28:31], a[204:207], v[76:79]
ds_read_b128 a[24:27], v21 offset:0
ds_read_b64_tr_b16 a[252:253], v20 offset:8192
v_mfma_f32_16x16x32_bf16 v[92:95], a[28:31], a[32:35], v[92:95]
ds_read_b64_tr_b16 a[254:255], v20 offset:8704
ds_read_b64_tr_b16 a[20:21], v19 offset:16384
v_mfma_f32_16x16x32_bf16 v[88:91], a[200:203], a[32:35], v[88:91]
buffer_load_dwordx4 v10, s[32:35], s66 offen offset:1024 lds
v_mfma_f32_16x16x32_bf16 v[84:87], a[192:195], a[32:35], v[84:87]
ds_read_b64_tr_b16 a[22:23], v19 offset:16896
ds_read_b64_tr_b16 a[88:89], v20 offset:16384
v_mfma_f32_16x16x32_bf16 v[80:83], a[124:127], a[32:35], v[80:83]
ds_read_b64_tr_b16 a[90:91], v20 offset:16896
ds_read_b128 a[92:95], v21 offset:2048
ds_read_b64_tr_b16 a[130:131], v37 offset:16384
v_mfma_f32_16x16x32_bf16 v[96:99], a[124:127], a[36:39], v[96:99]
buffer_load_dwordx4 v11, s[32:35], s66 offen offset:2048 lds
v_mfma_f32_16x16x32_bf16 v[100:103], a[192:195], a[36:39], v[100:103]
ds_read_b128 a[96:99], v21 offset:4096
ds_read_b128 a[100:103], v21 offset:6144
ds_read_b64_tr_b16 a[134:135], v39 offset:16384
v_mfma_f32_16x16x32_bf16 v[104:107], a[200:203], a[36:39], v[104:107]
ds_read_b128 a[104:107], v21 offset:8192
ds_read_b128 a[108:111], v21 offset:10240
v_mfma_f32_16x16x32_bf16 v[108:111], a[28:31], a[36:39], v[108:111]
buffer_load_dwordx4 v12, s[32:35], s66 offen offset:3072 lds
v_mfma_f32_16x16x32_bf16 v[124:127], a[28:31], a[40:43], v[124:127]
s_and_b32 s97, s70, 7
s_xor_b32 s97, s97, 7
ds_read_b64_tr_b16 a[138:139], v41 offset:16384
v_mfma_f32_16x16x32_bf16 v[120:123], a[200:203], a[40:43], v[120:123]
s_mul_i32 s65, s97, 128
s_add_u32 m0, s67, 24576
v_mfma_f32_16x16x32_bf16 v[116:119], a[192:195], a[40:43], v[116:119]
buffer_load_dwordx4 v2, s[28:31], s65 offen offset:0 lds
v_mfma_f32_16x16x32_bf16 v[112:115], a[124:127], a[40:43], v[112:115]
ds_read_b64_tr_b16 a[142:143], v43 offset:16384
ds_read_b64_tr_b16 a[144:145], v37 offset:24576
v_mfma_f32_16x16x32_bf16 v[128:131], a[124:127], a[44:47], v[128:131]
ds_read_b64_tr_b16 a[148:149], v39 offset:24576
v_mfma_f32_16x16x32_bf16 v[132:135], a[192:195], a[44:47], v[132:135]
buffer_load_dwordx4 v3, s[28:31], s65 offen offset:1024 lds
v_mfma_f32_16x16x32_bf16 v[136:139], a[200:203], a[44:47], v[136:139]
ds_read_b64_tr_b16 a[152:153], v41 offset:24576
v_mfma_f32_16x16x32_bf16 v[140:143], a[28:31], a[44:47], v[140:143]
ds_read_b64_tr_b16 a[156:157], v43 offset:24576
v_mfma_f32_16x16x32_bf16 v[156:159], a[28:31], a[48:51], v[156:159]
buffer_load_dwordx4 v4, s[28:31], s65 offen offset:2048 lds
v_mfma_f32_16x16x32_bf16 v[152:155], a[200:203], a[48:51], v[152:155]
v_mfma_f32_16x16x32_bf16 v[148:151], a[192:195], a[48:51], v[148:151]
v_mfma_f32_16x16x32_bf16 v[144:147], a[124:127], a[48:51], v[144:147]
s_waitcnt lgkmcnt(2)
s_barrier
s_waitcnt lgkmcnt(0)
v_mfma_f32_16x16x32_bf16 v[64:67], a[248:251], a[24:27], v[64:67]
buffer_load_dwordx4 v5, s[28:31], s65 offen offset:3072 lds
v_mfma_f32_16x16x32_bf16 v[68:71], a[252:255], a[24:27], v[68:71]
s_add_u32 m0, s67, 28672
ds_read_b64_tr_b16 a[112:113], v19 offset:24576
v_mfma_f32_16x16x32_bf16 v[72:75], a[20:23], a[24:27], v[72:75]
ds_read_b64_tr_b16 a[114:115], v19 offset:25088
v_mfma_f32_16x16x32_bf16 v[76:79], a[88:91], a[24:27], v[76:79]
buffer_load_dwordx4 v6, s[28:31], s65 offen offset:0 lds
v_mfma_f32_16x16x32_bf16 v[92:95], a[88:91], a[92:95], v[92:95]
ds_read_b128 a[60:63], v22 offset:0
v_mfma_f32_16x16x32_bf16 v[88:91], a[20:23], a[92:95], v[88:91]
ds_read_b64_tr_b16 a[12:13], v20 offset:24576
v_mfma_f32_16x16x32_bf16 v[84:87], a[252:255], a[92:95], v[84:87]
buffer_load_dwordx4 v7, s[28:31], s65 offen offset:1024 lds
v_mfma_f32_16x16x32_bf16 v[80:83], a[248:251], a[92:95], v[80:83]
s_and_b32 s97, s70, 7
s_xor_b32 s97, s97, 7
v_mfma_f32_16x16x32_bf16 v[96:99], a[248:251], a[96:99], v[96:99]
s_mul_i32 s66, s97, 229376
s_add_u32 m0, s68, 106496
v_mfma_f32_16x16x32_bf16 v[100:103], a[252:255], a[96:99], v[100:103]
ds_read_b64_tr_b16 a[14:15], v20 offset:25088
v_mfma_f32_16x16x32_bf16 v[104:107], a[20:23], a[96:99], v[104:107]
buffer_load_dwordx4 v9, s[32:35], s66 offen offset:0 lds
v_mfma_f32_16x16x32_bf16 v[108:111], a[88:91], a[96:99], v[108:111]
ds_read_b64_tr_b16 a[4:5], v19 offset:32768
v_mfma_f32_16x16x32_bf16 v[124:127], a[88:91], a[100:103], v[124:127]
ds_read_b64_tr_b16 a[6:7], v19 offset:33280
v_mfma_f32_16x16x32_bf16 v[120:123], a[20:23], a[100:103], v[120:123]
buffer_load_dwordx4 v10, s[32:35], s66 offen offset:1024 lds
v_mfma_f32_16x16x32_bf16 v[116:119], a[252:255], a[100:103], v[116:119]
ds_read_b64_tr_b16 a[8:9], v20 offset:32768
v_mfma_f32_16x16x32_bf16 v[112:115], a[248:251], a[100:103], v[112:115]
ds_read_b64_tr_b16 a[10:11], v20 offset:33280
v_mfma_f32_16x16x32_bf16 v[128:131], a[248:251], a[104:107], v[128:131]
ds_read_b128 a[16:19], v22 offset:2048
v_mfma_f32_16x16x32_bf16 v[132:135], a[252:255], a[104:107], v[132:135]
buffer_load_dwordx4 v11, s[32:35], s66 offen offset:2048 lds
v_mfma_f32_16x16x32_bf16 v[136:139], a[20:23], a[104:107], v[136:139]
ds_read_b128 a[84:87], v22 offset:4096
v_mfma_f32_16x16x32_bf16 v[140:143], a[88:91], a[104:107], v[140:143]
ds_read_b128 a[56:59], v22 offset:6144
v_mfma_f32_16x16x32_bf16 v[156:159], a[88:91], a[108:111], v[156:159]
buffer_load_dwordx4 v12, s[32:35], s66 offen offset:3072 lds
v_mfma_f32_16x16x32_bf16 v[152:155], a[20:23], a[108:111], v[152:155]
ds_read_b128 a[80:83], v22 offset:8192
v_mfma_f32_16x16x32_bf16 v[148:151], a[252:255], a[108:111], v[148:151]
ds_read_b128 a[212:215], v22 offset:10240
v_mfma_f32_16x16x32_bf16 v[144:147], a[248:251], a[108:111], v[144:147]
s_waitcnt vmcnt(10) lgkmcnt(2)
s_barrier
s_mov_b32 s4, 0
H_tag:
v_cmp_eq_u32 vcc, 0, v29
s_nop 1
s_cmp_eq_u64 vcc, 0
s_cbranch_scc1 H_tagok
buffer_load_dwordx2 v[28:29], v49, s[56:59], 0 offen sc1
s_add_u32 s4, s4, 1
s_waitcnt vmcnt(0)
s_cmp_lt_u32 s4, 0x8000
s_cbranch_scc1 H_tag
H_tagok:
v_lshrrev_b32 v28, v48, v28
v_and_b32 v28, 1, v28
v_or_b32 v29, 2, v28
v_mfma_f32_16x16x32_bf16 v[64:67], a[112:115], a[60:63], v[64:67]
s_add_u32 s66, s66, 114688
s_add_u32 m0, s68, 122880
v_mfma_f32_16x16x32_bf16 v[68:71], a[12:15], a[60:63], v[68:71]
ds_read_b64_tr_b16 a[216:217], v17 offset:24576
v_mfma_f32_16x16x32_bf16 v[72:75], a[4:7], a[60:63], v[72:75]
buffer_load_dwordx4 v9, s[32:35], s66 offen offset:0 lds
v_mfma_f32_16x16x32_bf16 v[76:79], a[8:11], a[60:63], v[76:79]
ds_read_b64_tr_b16 a[218:219], v17 offset:25088
v_mfma_f32_16x16x32_bf16 v[92:95], a[8:11], a[16:19], v[92:95]
ds_read_b128 a[220:223], v13 offset:0
v_mfma_f32_16x16x32_bf16 v[88:91], a[4:7], a[16:19], v[88:91]
buffer_load_dwordx4 v10, s[32:35], s66 offen offset:1024 lds
v_mfma_f32_16x16x32_bf16 v[84:87], a[12:15], a[16:19], v[84:87]
ds_read_b64_tr_b16 a[224:225], v18 offset:24576
v_mfma_f32_16x16x32_bf16 v[80:83], a[112:115], a[16:19], v[80:83]
ds_read_b64_tr_b16 a[226:227], v18 offset:25088
v_mfma_f32_16x16x32_bf16 v[96:99], a[112:115], a[84:87], v[96:99]
buffer_load_dwordx4 v11, s[32:35], s66 offen offset:2048 lds
v_mfma_f32_16x16x32_bf16 v[100:103], a[12:15], a[84:87], v[100:103]
ds_read_b64_tr_b16 a[228:229], v17 offset:32768
v_mfma_f32_16x16x32_bf16 v[104:107], a[4:7], a[84:87], v[104:107]
ds_read_b64_tr_b16 a[230:231], v17 offset:33280
v_mfma_f32_16x16x32_bf16 v[108:111], a[8:11], a[84:87], v[108:111]
buffer_load_dwordx4 v12, s[32:35], s66 offen offset:3072 lds
v_mfma_f32_16x16x32_bf16 v[124:127], a[8:11], a[56:59], v[124:127]
s_add_u32 s77, s77, 16384
s_add_u32 m0, s71, 49152
v_mfma_f32_16x16x32_bf16 v[120:123], a[4:7], a[56:59], v[120:123]
ds_read_b64_tr_b16 a[232:233], v18 offset:32768
v_mfma_f32_16x16x32_bf16 v[116:119], a[12:15], a[56:59], v[116:119]
buffer_load_dwordx4 v62, s[44:47], s77 offen offset:0 lds
v_mfma_f32_16x16x32_bf16 v[112:115], a[112:115], a[56:59], v[112:115]
ds_read_b64_tr_b16 a[234:235], v18 offset:33280
s_waitcnt lgkmcnt(4)
v_mfma_f32_16x16x32_bf16 v[128:131], a[112:115], a[80:83], v[128:131]
ds_read_b128 a[236:239], v13 offset:2048
v_mfma_f32_16x16x32_bf16 v[132:135], a[12:15], a[80:83], v[132:135]
buffer_load_dwordx4 v0, s[44:47], s77 offen offset:1024 lds
v_mfma_f32_16x16x32_bf16 v[136:139], a[4:7], a[80:83], v[136:139]
s_lshl_b32 s77, s76, 4
s_add_u32 m0, s71, 139264
v_mfma_f32_16x16x32_bf16 v[140:143], a[8:11], a[80:83], v[140:143]
ds_read_b64_tr_b16 a[120:121], v17 offset:40960
v_mfma_f32_16x16x32_bf16 v[156:159], a[8:11], a[212:215], v[156:159]
buffer_load_dwordx4 v62, s[48:51], s77 offen offset:0 lds
v_mfma_f32_16x16x32_bf16 v[152:155], a[4:7], a[212:215], v[152:155]
ds_read_b64_tr_b16 a[122:123], v17 offset:41472
v_mfma_f32_16x16x32_bf16 v[148:151], a[12:15], a[212:215], v[148:151]
ds_read_b128 a[72:75], v14 offset:0
v_mfma_f32_16x16x32_bf16 v[144:147], a[112:115], a[212:215], v[144:147]
ds_read_b64_tr_b16 a[64:65], v18 offset:40960
s_waitcnt vmcnt(7) lgkmcnt(4)
s_barrier
v_mfma_f32_16x16x32_bf16 v[64:67], a[216:219], a[220:223], v[64:67]
buffer_load_dwordx4 v0, s[48:51], s77 offen offset:1024 lds
v_mfma_f32_16x16x32_bf16 v[68:71], a[224:227], a[220:223], v[68:71]
s_add_u32 s77, s77, 16384
s_add_u32 m0, s71, 73728
v_mfma_f32_16x16x32_bf16 v[72:75], a[228:231], a[220:223], v[72:75]
ds_read_b64_tr_b16 a[66:67], v18 offset:41472
ds_read_b64_tr_b16 a[68:69], v19 offset:0
v_mfma_f32_16x16x32_bf16 v[76:79], a[232:235], a[220:223], v[76:79]
ds_read_b64_tr_b16 a[70:71], v19 offset:512
ds_read_b64_tr_b16 a[76:77], v20 offset:0
v_mfma_f32_16x16x32_bf16 v[80:83], a[216:219], a[236:239], v[80:83]
buffer_load_dwordx4 v62, s[48:51], s77 offen offset:0 lds
v_mfma_f32_16x16x32_bf16 v[84:87], a[224:227], a[236:239], v[84:87]
ds_read_b64_tr_b16 a[78:79], v20 offset:512
ds_read_b128 a[208:211], v14 offset:2048
v_mfma_f32_16x16x32_bf16 v[88:91], a[228:231], a[236:239], v[88:91]
ds_read_b64_tr_b16 a[116:117], v19 offset:8192
ds_read_b64_tr_b16 a[118:119], v19 offset:8704
v_mfma_f32_16x16x32_bf16 v[92:95], a[232:235], a[236:239], v[92:95]
ds_read_b128 a[204:207], v13 offset:24576
ds_read_b64_tr_b16 a[32:33], v20 offset:8192
s_waitcnt lgkmcnt(10)
v_mfma_f32_16x16x32_bf16 v[64:67], a[120:123], a[72:75], v[64:67]
buffer_load_dwordx4 v0, s[48:51], s77 offen offset:1024 lds
s_waitcnt lgkmcnt(9)
v_mfma_f32_16x16x32_bf16 v[68:71], a[64:67], a[72:75], v[68:71]
s_lshl_b32 s77, s78, 4
s_add_u32 m0, s71, 81920
s_waitcnt lgkmcnt(7)
v_mfma_f32_16x16x32_bf16 v[72:75], a[68:71], a[72:75], v[72:75]
ds_read_b64_tr_b16 a[34:35], v20 offset:8704
ds_read_b64_tr_b16 a[36:37], v19 offset:16384
s_waitcnt lgkmcnt(7)
v_mfma_f32_16x16x32_bf16 v[76:79], a[76:79], a[72:75], v[76:79]
ds_read_b64_tr_b16 a[38:39], v19 offset:16896
ds_read_b64_tr_b16 a[40:41], v20 offset:16384
s_waitcnt lgkmcnt(8)
v_mfma_f32_16x16x32_bf16 v[80:83], a[120:123], a[208:211], v[80:83]
buffer_load_dwordx4 v62, s[48:51], s77 offen offset:0 lds
v_mfma_f32_16x16x32_bf16 v[84:87], a[64:67], a[208:211], v[84:87]
ds_read_b64_tr_b16 a[42:43], v20 offset:16896
ds_read_b128 a[44:47], v13 offset:26624
v_mfma_f32_16x16x32_bf16 v[88:91], a[68:71], a[208:211], v[88:91]
v_mfma_f32_16x16x32_bf16 v[92:95], a[76:79], a[208:211], v[92:95]
s_waitcnt vmcnt(7) lgkmcnt(1)
s_barrier
v_mfma_f32_16x16x32_bf16 v[64:67], a[116:119], a[204:207], v[64:67]
buffer_load_dwordx4 v0, s[48:51], s77 offen offset:1024 lds
v_mfma_f32_16x16x32_bf16 v[68:71], a[32:35], a[204:207], v[68:71]
s_add_u32 s77, s77, 16384
s_add_u32 m0, s71, 90112
v_mfma_f32_16x16x32_bf16 v[72:75], a[36:39], a[204:207], v[72:75]
ds_read_b64_tr_b16 a[48:49], v19 offset:24576
ds_read_b64_tr_b16 a[50:51], v19 offset:25088
v_mfma_f32_16x16x32_bf16 v[76:79], a[40:43], a[204:207], v[76:79]
ds_read_b128 a[24:27], v14 offset:24576
ds_read_b64_tr_b16 a[92:93], v20 offset:24576
s_waitcnt lgkmcnt(4)
v_mfma_f32_16x16x32_bf16 v[80:83], a[116:119], a[44:47], v[80:83]
buffer_load_dwordx4 v62, s[48:51], s77 offen offset:0 lds
v_mfma_f32_16x16x32_bf16 v[84:87], a[32:35], a[44:47], v[84:87]
ds_read_b64_tr_b16 a[94:95], v20 offset:25088
ds_read_b64_tr_b16 a[96:97], v19 offset:32768
s_lshl_b32 s14, s2, 13
v_mfma_f32_16x16x32_bf16 v[88:91], a[36:39], a[44:47], v[88:91]
ds_read_b64_tr_b16 a[98:99], v19 offset:33280
ds_read_b64_tr_b16 a[100:101], v20 offset:32768
v_mfma_f32_16x16x32_bf16 v[92:95], a[40:43], a[44:47], v[92:95]
ds_read_b64_tr_b16 a[102:103], v20 offset:33280
ds_read_b128 a[104:107], v14 offset:26624
s_lshl_b32 s15, s60, 11
s_waitcnt lgkmcnt(7)
v_mfma_f32_16x16x32_bf16 v[64:67], a[48:51], a[24:27], v[64:67]
buffer_load_dwordx4 v0, s[48:51], s77 offen offset:1024 lds
s_add_u32 s14, s14, s15
s_waitcnt lgkmcnt(5)
v_mfma_f32_16x16x32_bf16 v[68:71], a[92:95], a[24:27], v[68:71]
s_lshl_b32 s77, s79, 4
s_add_u32 m0, s71, 98304
s_waitcnt lgkmcnt(3)
v_mfma_f32_16x16x32_bf16 v[72:75], a[96:99], a[24:27], v[72:75]
ds_read_b128 a[108:111], v13 offset:4096
ds_read_b128 a[60:63], v14 offset:4096
s_add_u32 s14, s14, 32768
s_waitcnt lgkmcnt(3)
v_mfma_f32_16x16x32_bf16 v[76:79], a[100:103], a[24:27], v[76:79]
ds_read_b128 a[16:19], v13 offset:28672
ds_read_b128 a[84:87], v14 offset:28672
s_waitcnt lgkmcnt(4)
v_mfma_f32_16x16x32_bf16 v[80:83], a[48:51], a[104:107], v[80:83]
buffer_load_dwordx4 v62, s[48:51], s77 offen offset:0 lds
v_lshl_add_u32 v3, v1, 4, s14
v_mfma_f32_16x16x32_bf16 v[84:87], a[92:95], a[104:107], v[84:87]
ds_read_b128 a[56:59], v13 offset:6144
ds_read_b128 a[80:83], v14 offset:6144
v_mfma_f32_16x16x32_bf16 v[88:91], a[96:99], a[104:107], v[88:91]
ds_read_b128 a[212:215], v13 offset:30720
ds_read_b128 a[220:223], v14 offset:30720
v_mov_b32 v4, -1
v_mfma_f32_16x16x32_bf16 v[92:95], a[100:103], a[104:107], v[92:95]
ds_read_b128 a[236:239], v13 offset:8192
ds_read_b128 a[72:75], v14 offset:8192
v_mov_b32 v5, -1
v_mov_b32 v6, -1
v_mov_b32 v7, -1
s_barrier
s_waitcnt lgkmcnt(8)
v_mfma_f32_16x16x32_bf16 v[96:99], a[216:219], a[108:111], v[96:99]
buffer_load_dwordx4 v0, s[48:51], s77 offen offset:1024 lds
ds_read_b128 a[208:211], v13 offset:32768
v_mul_f32 v64, s82, v64
v_mul_f32 v65, s82, v65
v_mul_f32 v66, s82, v66
v_mul_f32 v67, s82, v67
v_mul_f32 v68, s82, v68
v_mul_f32 v69, s82, v69
v_mul_f32 v70, s82, v70
v_mfma_f32_16x16x32_bf16 v[96:99], a[120:123], a[60:63], v[96:99]
s_add_u32 s77, s77, 16384
s_add_u32 m0, s71, 106496
ds_read_b128 a[204:207], v14 offset:32768
v_mul_f32 v71, s82, v71
v_exp_f32 v64, v64
v_exp_f32 v65, v65
v_exp_f32 v66, v66
s_waitcnt lgkmcnt(2)
v_mfma_f32_16x16x32_bf16 v[96:99], a[116:119], a[16:19], v[96:99]
ds_read_b128 a[44:47], v13 offset:10240
v_exp_f32 v67, v67
v_exp_f32 v68, v68
v_exp_f32 v69, v69
v_mfma_f32_16x16x32_bf16 v[96:99], a[48:51], a[84:87], v[96:99]
buffer_load_dwordx4 v62, s[48:51], s77 offen offset:0 lds
ds_read_b128 a[24:27], v14 offset:10240
v_exp_f32 v70, v70
v_exp_f32 v71, v71
v_add_f32 v64, 1.0, v64
v_mfma_f32_16x16x32_bf16 v[100:103], a[224:227], a[108:111], v[100:103]
ds_read_b128 a[104:107], v13 offset:34816
v_add_f32 v65, 1.0, v65
v_add_f32 v66, 1.0, v66
v_add_f32 v67, 1.0, v67
v_add_f32 v68, 1.0, v68
v_add_f32 v69, 1.0, v69
v_add_f32 v70, 1.0, v70
v_mfma_f32_16x16x32_bf16 v[100:103], a[64:67], a[60:63], v[100:103]
v_add_f32 v71, 1.0, v71
v_rcp_f32 v64, v64
v_rcp_f32 v65, v65
v_rcp_f32 v66, v66
v_mfma_f32_16x16x32_bf16 v[100:103], a[32:35], a[16:19], v[100:103]
buffer_load_dwordx4 v0, s[48:51], s77 offen offset:1024 lds
v_rcp_f32 v67, v67
v_rcp_f32 v68, v68
v_rcp_f32 v69, v69
v_mfma_f32_16x16x32_bf16 v[100:103], a[92:95], a[84:87], v[100:103]
s_lshl_b32 s77, s80, 4
s_add_u32 m0, s71, 114688
v_rcp_f32 v70, v70
v_rcp_f32 v71, v71
v_mul_f32 v72, v72, v64
v_mfma_f32_16x16x32_bf16 v[104:107], a[228:231], a[108:111], v[104:107]
v_mul_f32 v73, v73, v65
v_mul_f32 v74, v74, v66
v_mul_f32 v75, v75, v67
v_mul_f32 v76, v76, v68
v_mul_f32 v77, v77, v69
v_mul_f32 v78, v78, v70
v_mfma_f32_16x16x32_bf16 v[104:107], a[68:71], a[60:63], v[104:107]
buffer_load_dwordx4 v62, s[48:51], s77 offen offset:0 lds
v_mul_f32 v79, v79, v71
v_cvt_pk_bf16_f32 v64, v72, v73
v_cvt_pk_bf16_f32 v65, v74, v75
v_cvt_pk_bf16_f32 v66, v76, v77
v_cvt_pk_bf16_f32 v67, v78, v79
buffer_store_dwordx4 v[64:67], v61, s[36:39], s86 offen sc1
v_mfma_f32_16x16x32_bf16 v[104:107], a[36:39], a[16:19], v[104:107]
v_mul_f32 v80, s82, v80
v_mul_f32 v81, s82, v81
H_T2:
s_cbranch_execz H_Tret
v_mul_f32 v82, s82, v82
v_mul_f32 v83, s82, v83
v_mfma_f32_16x16x32_bf16 v[104:107], a[96:99], a[84:87], v[104:107]
v_mul_f32 v84, s82, v84
v_mul_f32 v85, s82, v85
v_mul_f32 v86, s82, v86
v_mul_f32 v87, s82, v87
v_exp_f32 v80, v80
v_mfma_f32_16x16x32_bf16 v[108:111], a[232:235], a[108:111], v[108:111]
buffer_load_dwordx4 v0, s[48:51], s77 offen offset:1024 lds
ds_read_b128 a[108:111], v14 offset:34816
v_exp_f32 v81, v81
v_exp_f32 v82, v82
v_exp_f32 v83, v83
v_mfma_f32_16x16x32_bf16 v[108:111], a[76:79], a[60:63], v[108:111]
ds_read_b128 a[60:63], v21 offset:12288
v_exp_f32 v84, v84
v_exp_f32 v85, v85
v_exp_f32 v86, v86
v_mfma_f32_16x16x32_bf16 v[108:111], a[40:43], a[16:19], v[108:111]
ds_read_b128 a[16:19], v22 offset:12288
v_exp_f32 v87, v87
v_add_f32 v80, 1.0, v80
v_add_f32 v81, 1.0, v81
v_add_f32 v82, 1.0, v82
v_add_f32 v83, 1.0, v83
v_mfma_f32_16x16x32_bf16 v[108:111], a[100:103], a[84:87], v[108:111]
ds_read_b128 a[84:87], v13 offset:12288
v_add_f32 v84, 1.0, v84
v_add_f32 v85, 1.0, v85
v_add_f32 v86, 1.0, v86
v_add_f32 v87, 1.0, v87
v_rcp_f32 v80, v80
s_barrier
v_mfma_f32_16x16x32_bf16 v[112:115], a[216:219], a[56:59], v[112:115]
s_add_u32 s77, s77, 16384
s_add_u32 m0, s71, 0
v_rcp_f32 v81, v81
v_rcp_f32 v82, v82
v_rcp_f32 v83, v83
v_mfma_f32_16x16x32_bf16 v[112:115], a[120:123], a[80:83], v[112:115]
v_rcp_f32 v84, v84
v_rcp_f32 v85, v85
v_rcp_f32 v86, v86
v_mfma_f32_16x16x32_bf16 v[112:115], a[116:119], a[212:215], v[112:115]
buffer_load_dwordx4 v62, s[48:51], s77 offen offset:0 lds
v_rcp_f32 v87, v87
v_mul_f32 v88, v88, v80
v_mul_f32 v89, v89, v81
v_mul_f32 v90, v90, v82
v_mul_f32 v91, v91, v83
v_mfma_f32_16x16x32_bf16 v[112:115], a[48:51], a[220:223], v[112:115]
v_mul_f32 v92, v92, v84
v_mul_f32 v93, v93, v85
v_mul_f32 v94, v94, v86
v_mul_f32 v95, v95, v87
v_cvt_pk_bf16_f32 v80, v88, v89
v_mfma_f32_16x16x32_bf16 v[116:119], a[224:227], a[56:59], v[116:119]
buffer_load_dwordx4 v0, s[48:51], s77 offen offset:1024 lds
v_cvt_pk_bf16_f32 v81, v90, v91
v_cvt_pk_bf16_f32 v82, v92, v93
v_cvt_pk_bf16_f32 v83, v94, v95
buffer_store_dwordx4 v[80:83], v61, s[36:39], s87 offen sc1
v_mfma_f32_16x16x32_bf16 v[116:119], a[64:67], a[80:83], v[116:119]
s_lshl_b32 s77, s81, 4
s_add_u32 m0, s71, 24576
v_mul_f32 v96, s82, v96
v_mul_f32 v97, s82, v97
v_mul_f32 v98, s82, v98
v_mul_f32 v99, s82, v99
v_mul_f32 v100, s82, v100
v_mul_f32 v101, s82, v101
v_mfma_f32_16x16x32_bf16 v[116:119], a[32:35], a[212:215], v[116:119]
v_mul_f32 v102, s82, v102
v_mul_f32 v103, s82, v103
v_exp_f32 v96, v96
v_exp_f32 v97, v97
v_mfma_f32_16x16x32_bf16 v[116:119], a[92:95], a[220:223], v[116:119]
buffer_load_dwordx4 v62, s[48:51], s77 offen offset:0 lds
v_exp_f32 v98, v98
v_exp_f32 v99, v99
v_exp_f32 v100, v100
v_mfma_f32_16x16x32_bf16 v[120:123], a[228:231], a[56:59], v[120:123]
v_exp_f32 v101, v101
v_exp_f32 v102, v102
v_exp_f32 v103, v103
v_mfma_f32_16x16x32_bf16 v[120:123], a[68:71], a[80:83], v[120:123]
v_add_f32 v96, 1.0, v96
v_add_f32 v97, 1.0, v97
v_add_f32 v98, 1.0, v98
v_add_f32 v99, 1.0, v99
v_add_f32 v100, 1.0, v100
v_mfma_f32_16x16x32_bf16 v[120:123], a[36:39], a[212:215], v[120:123]
buffer_load_dwordx4 v0, s[48:51], s77 offen offset:1024 lds
v_add_f32 v101, 1.0, v101
v_add_f32 v102, 1.0, v102
v_add_f32 v103, 1.0, v103
v_rcp_f32 v96, v96
v_rcp_f32 v97, v97
v_mfma_f32_16x16x32_bf16 v[120:123], a[96:99], a[220:223], v[120:123]
s_add_u32 s77, s77, 16384
s_add_u32 m0, s71, 122880
v_rcp_f32 v98, v98
v_rcp_f32 v99, v99
v_mfma_f32_16x16x32_bf16 v[124:127], a[232:235], a[56:59], v[124:127]
ds_read_b128 a[56:59], v14 offset:12288
v_rcp_f32 v100, v100
v_rcp_f32 v101, v101
v_rcp_f32 v102, v102
v_mfma_f32_16x16x32_bf16 v[124:127], a[76:79], a[80:83], v[124:127]
buffer_load_dwordx4 v62, s[48:51], s77 offen offset:0 lds
ds_read_b128 a[80:83], v13 offset:36864
v_rcp_f32 v103, v103
v_mul_f32 v104, v104, v96
v_mul_f32 v105, v105, v97
v_mul_f32 v106, v106, v98
v_mul_f32 v107, v107, v99
v_mfma_f32_16x16x32_bf16 v[124:127], a[40:43], a[212:215], v[124:127]
ds_read_b128 a[212:215], v14 offset:36864
v_mul_f32 v108, v108, v100
v_mul_f32 v109, v109, v101
v_mul_f32 v110, v110, v102
v_mul_f32 v111, v111, v103
v_cvt_pk_bf16_f32 v96, v104, v105
v_mfma_f32_16x16x32_bf16 v[124:127], a[100:103], a[220:223], v[124:127]
ds_read_b128 a[220:223], v21 offset:14336
v_cvt_pk_bf16_f32 v97, v106, v107
v_cvt_pk_bf16_f32 v98, v108, v109
v_cvt_pk_bf16_f32 v99, v110, v111
buffer_store_dwordx4 v[96:99], v61, s[36:39], s88 offen sc1
s_waitcnt vmcnt(20)
v_mfma_f32_16x16x32_bf16 v[128:131], a[216:219], a[236:239], v[128:131]
buffer_load_dwordx4 v0, s[48:51], s77 offen offset:1024 lds
v_mul_f32 v112, s82, v112
v_mul_f32 v113, s82, v113
v_mul_f32 v114, s82, v114
v_mul_f32 v115, s82, v115
v_mfma_f32_16x16x32_bf16 v[128:131], a[120:123], a[72:75], v[128:131]
s_lshl_b32 s77, s18, 4
s_add_u32 m0, s71, 131072
ds_read_b64_tr_b16 a[146:147], v32 offset:49152
v_mul_f32 v116, s82, v116
v_mul_f32 v117, s82, v117
v_mul_f32 v118, s82, v118
v_mul_f32 v119, s82, v119
s_waitcnt lgkmcnt(2)
v_mfma_f32_16x16x32_bf16 v[128:131], a[116:119], a[208:211], v[128:131]
ds_read_b64_tr_b16 a[150:151], v33 offset:49152
v_exp_f32 v112, v112
v_exp_f32 v113, v113
v_mfma_f32_16x16x32_bf16 v[128:131], a[48:51], a[204:207], v[128:131]
buffer_load_dwordx4 v62, s[48:51], s77 offen offset:0 lds
v_exp_f32 v114, v114
v_exp_f32 v115, v115
v_mfma_f32_16x16x32_bf16 v[132:135], a[224:227], a[236:239], v[132:135]
ds_read_b64_tr_b16 a[154:155], v34 offset:49152
v_exp_f32 v116, v116
v_exp_f32 v117, v117
v_mfma_f32_16x16x32_bf16 v[132:135], a[64:67], a[72:75], v[132:135]
ds_read_b64_tr_b16 a[158:159], v35 offset:49152
v_exp_f32 v118, v118
v_exp_f32 v119, v119
v_mfma_f32_16x16x32_bf16 v[132:135], a[32:35], a[208:211], v[132:135]
buffer_load_dwordx4 v0, s[48:51], s77 offen offset:1024 lds
v_add_f32 v112, 1.0, v112
v_add_f32 v113, 1.0, v113
v_add_f32 v114, 1.0, v114
v_add_f32 v115, 1.0, v115
v_mfma_f32_16x16x32_bf16 v[132:135], a[92:95], a[204:207], v[132:135]
s_add_u32 s77, s77, 16384
s_add_u32 m0, s71, 147456
ds_read_b64_tr_b16 a[160:161], v37 offset:8192
v_add_f32 v116, 1.0, v116
v_add_f32 v117, 1.0, v117
v_add_f32 v118, 1.0, v118
v_add_f32 v119, 1.0, v119
v_mfma_f32_16x16x32_bf16 v[136:139], a[228:231], a[236:239], v[136:139]
ds_read_b64_tr_b16 a[164:165], v39 offset:8192
v_rcp_f32 v112, v112
v_rcp_f32 v113, v113
v_mfma_f32_16x16x32_bf16 v[136:139], a[68:71], a[72:75], v[136:139]
buffer_load_dwordx4 v62, s[48:51], s77 offen offset:0 lds
v_rcp_f32 v114, v114
v_rcp_f32 v115, v115
v_mfma_f32_16x16x32_bf16 v[136:139], a[36:39], a[208:211], v[136:139]
ds_read_b64_tr_b16 a[168:169], v41 offset:8192
v_rcp_f32 v116, v116
v_rcp_f32 v117, v117
v_mfma_f32_16x16x32_bf16 v[136:139], a[96:99], a[204:207], v[136:139]
ds_read_b64_tr_b16 a[172:173], v43 offset:8192
v_rcp_f32 v118, v118
v_rcp_f32 v119, v119
v_mfma_f32_16x16x32_bf16 v[140:143], a[232:235], a[236:239], v[140:143]
buffer_load_dwordx4 v0, s[48:51], s77 offen offset:1024 lds
ds_read_b128 a[236:239], v22 offset:14336
v_mul_f32 v120, v120, v112
v_mul_f32 v121, v121, v113
v_mul_f32 v122, v122, v114
v_mfma_f32_16x16x32_bf16 v[140:143], a[76:79], a[72:75], v[140:143]
ds_read_b128 a[72:75], v13 offset:14336
v_mul_f32 v123, v123, v115
v_mul_f32 v124, v124, v116
v_mul_f32 v125, v125, v117
v_mul_f32 v126, v126, v118
v_mfma_f32_16x16x32_bf16 v[140:143], a[40:43], a[208:211], v[140:143]
ds_read_b128 a[208:211], v14 offset:14336
v_mul_f32 v127, v127, v119
v_cvt_pk_bf16_f32 v112, v120, v121
v_cvt_pk_bf16_f32 v113, v122, v123
v_cvt_pk_bf16_f32 v114, v124, v125
v_mfma_f32_16x16x32_bf16 v[140:143], a[100:103], a[204:207], v[140:143]
ds_read_b128 a[204:207], v13 offset:38912
v_cvt_pk_bf16_f32 v115, v126, v127
buffer_store_dwordx4 v[112:115], v61, s[36:39], s89 offen sc1
s_waitcnt vmcnt(22)
s_waitcnt lgkmcnt(4)
v_mfma_f32_16x16x32_bf16 v[144:147], a[216:219], a[44:47], v[144:147]
s_lshl_b32 s77, s19, 4
s_add_u32 m0, s71, 49152
v_mul_f32 v128, s82, v128
v_mul_f32 v129, s82, v129
v_mul_f32 v130, s82, v130
v_mul_f32 v131, s82, v131
v_mfma_f32_16x16x32_bf16 v[144:147], a[120:123], a[24:27], v[144:147]
ds_read_b64_tr_b16 a[162:163], v36 offset:8192
v_mul_f32 v132, s82, v132
v_mul_f32 v133, s82, v133
v_mul_f32 v134, s82, v134
v_mul_f32 v135, s82, v135
v_mfma_f32_16x16x32_bf16 v[144:147], a[116:119], a[104:107], v[144:147]
buffer_load_dwordx4 v62, s[48:51], s77 offen offset:0 lds
ds_read_b64_tr_b16 a[166:167], v38 offset:8192
v_exp_f32 v128, v128
v_exp_f32 v129, v129
v_mfma_f32_16x16x32_bf16 v[144:147], a[48:51], a[108:111], v[144:147]
v_exp_f32 v130, v130
v_exp_f32 v131, v131
v_mfma_f32_16x16x32_bf16 v[148:151], a[224:227], a[44:47], v[148:151]
ds_read_b64_tr_b16 a[170:171], v40 offset:8192
v_exp_f32 v132, v132
v_exp_f32 v133, v133
v_mfma_f32_16x16x32_bf16 v[148:151], a[64:67], a[24:27], v[148:151]
buffer_load_dwordx4 v0, s[48:51], s77 offen offset:1024 lds
ds_read_b64_tr_b16 a[174:175], v42 offset:8192
v_exp_f32 v134, v134
v_exp_f32 v135, v135
v_mfma_f32_16x16x32_bf16 v[148:151], a[32:35], a[104:107], v[148:151]
s_add_u32 s77, s77, 16384
s_add_u32 m0, s71, 139264
v_add_f32 v128, 1.0, v128
v_add_f32 v129, 1.0, v129
v_add_f32 v130, 1.0, v130
v_add_f32 v131, 1.0, v131
v_mfma_f32_16x16x32_bf16 v[148:151], a[92:95], a[108:111], v[148:151]
ds_read_b64_tr_b16 a[176:177], v36 offset:16384
v_add_f32 v132, 1.0, v132
v_add_f32 v133, 1.0, v133
v_add_f32 v134, 1.0, v134
v_add_f32 v135, 1.0, v135
v_mfma_f32_16x16x32_bf16 v[152:155], a[228:231], a[44:47], v[152:155]
ds_read_b64_tr_b16 a[180:181], v38 offset:16384
v_rcp_f32 v128, v128
v_rcp_f32 v129, v129
v_mfma_f32_16x16x32_bf16 v[152:155], a[68:71], a[24:27], v[152:155]
buffer_load_dwordx4 v62, s[48:51], s77 offen offset:0 lds
v_rcp_f32 v130, v130
v_rcp_f32 v131, v131
v_mfma_f32_16x16x32_bf16 v[152:155], a[36:39], a[104:107], v[152:155]
ds_read_b64_tr_b16 a[184:185], v40 offset:16384
v_rcp_f32 v132, v132
v_rcp_f32 v133, v133
v_mfma_f32_16x16x32_bf16 v[152:155], a[96:99], a[108:111], v[152:155]
ds_read_b64_tr_b16 a[188:189], v42 offset:16384
v_rcp_f32 v134, v134
v_rcp_f32 v135, v135
v_mfma_f32_16x16x32_bf16 v[156:159], a[232:235], a[44:47], v[156:159]
buffer_load_dwordx4 v0, s[48:51], s77 offen offset:1024 lds
ds_read_b128 a[44:47], v14 offset:38912
v_mul_f32 v136, v136, v128
v_mul_f32 v137, v137, v129
v_mul_f32 v138, v138, v130
v_mfma_f32_16x16x32_bf16 v[156:159], a[76:79], a[24:27], v[156:159]
ds_read_b128 a[24:27], v21 offset:16384
v_mul_f32 v139, v139, v131
v_mul_f32 v140, v140, v132
v_mul_f32 v141, v141, v133
v_mul_f32 v142, v142, v134
v_mfma_f32_16x16x32_bf16 v[156:159], a[40:43], a[104:107], v[156:159]
ds_read_b128 a[104:107], v22 offset:16384
v_mul_f32 v143, v143, v135
v_cvt_pk_bf16_f32 v128, v136, v137
v_cvt_pk_bf16_f32 v129, v138, v139
v_cvt_pk_bf16_f32 v130, v140, v141
v_mfma_f32_16x16x32_bf16 v[156:159], a[100:103], a[108:111], v[156:159]
ds_read_b128 a[108:111], v13 offset:16384
v_cvt_pk_bf16_f32 v131, v142, v143
buffer_store_dwordx4 v[128:131], v61, s[36:39], s90 offen sc1
s_waitcnt vmcnt(25)
s_waitcnt lgkmcnt(4)
v_mfma_f32_16x16x32_bf16 v[160:163], a[124:127], a[52:55], v[160:163]
v_mul_f32 v144, s82, v144
v_mul_f32 v145, s82, v145
v_mul_f32 v146, s82, v146
v_mfma_f32_16x16x32_bf16 v[160:163], a[248:251], a[60:63], v[160:163]
v_mul_f32 v147, s82, v147
v_mul_f32 v148, s82, v148
v_mfma_f32_16x16x32_bf16 v[160:163], a[112:115], a[16:19], v[160:163]
v_mul_f32 v149, s82, v149
v_mul_f32 v150, s82, v150
v_mfma_f32_16x16x32_bf16 v[160:163], a[216:219], a[84:87], v[160:163]
v_mul_f32 v151, s82, v151
v_exp_f32 v144, v144
v_mfma_f32_16x16x32_bf16 v[160:163], a[120:123], a[56:59], v[160:163]
v_exp_f32 v145, v145
v_mfma_f32_16x16x32_bf16 v[160:163], a[116:119], a[80:83], v[160:163]
ds_read_b64_tr_b16 a[178:179], v36 offset:24576
v_exp_f32 v146, v146
v_mfma_f32_16x16x32_bf16 v[160:163], a[48:51], a[212:215], v[160:163]
v_exp_f32 v147, v147
v_mfma_f32_16x16x32_bf16 v[164:167], a[192:195], a[52:55], v[164:167]
v_exp_f32 v148, v148
v_mfma_f32_16x16x32_bf16 v[164:167], a[252:255], a[60:63], v[164:167]
v_exp_f32 v149, v149
v_exp_f32 v150, v150
v_mfma_f32_16x16x32_bf16 v[164:167], a[12:15], a[16:19], v[164:167]
v_exp_f32 v151, v151
v_mfma_f32_16x16x32_bf16 v[164:167], a[224:227], a[84:87], v[164:167]
v_add_f32 v144, 1.0, v144
v_mfma_f32_16x16x32_bf16 v[164:167], a[64:67], a[56:59], v[164:167]
ds_read_b64_tr_b16 a[182:183], v38 offset:24576
v_add_f32 v145, 1.0, v145
v_add_f32 v146, 1.0, v146
v_mfma_f32_16x16x32_bf16 v[164:167], a[32:35], a[80:83], v[164:167]
v_add_f32 v147, 1.0, v147
v_add_f32 v148, 1.0, v148
v_add_f32 v149, 1.0, v149
v_mfma_f32_16x16x32_bf16 v[164:167], a[92:95], a[212:215], v[164:167]
v_add_f32 v150, 1.0, v150
v_add_f32 v151, 1.0, v151
v_mfma_f32_16x16x32_bf16 v[168:171], a[200:203], a[52:55], v[168:171]
v_rcp_f32 v144, v144
v_mfma_f32_16x16x32_bf16 v[168:171], a[20:23], a[60:63], v[168:171]
v_rcp_f32 v145, v145
v_mfma_f32_16x16x32_bf16 v[168:171], a[4:7], a[16:19], v[168:171]
v_rcp_f32 v146, v146
v_mfma_f32_16x16x32_bf16 v[168:171], a[228:231], a[84:87], v[168:171]
ds_read_b64_tr_b16 a[186:187], v40 offset:24576
v_rcp_f32 v147, v147
v_rcp_f32 v148, v148
v_mfma_f32_16x16x32_bf16 v[168:171], a[68:71], a[56:59], v[168:171]
v_rcp_f32 v149, v149
v_mfma_f32_16x16x32_bf16 v[168:171], a[36:39], a[80:83], v[168:171]
v_rcp_f32 v150, v150
v_mfma_f32_16x16x32_bf16 v[168:171], a[96:99], a[212:215], v[168:171]
v_rcp_f32 v151, v151
v_mfma_f32_16x16x32_bf16 v[172:175], a[28:31], a[52:55], v[172:175]
ds_read_b128 a[52:55], v14 offset:16384
v_mul_f32 v152, v152, v144
v_mul_f32 v153, v153, v145
v_mfma_f32_16x16x32_bf16 v[172:175], a[88:91], a[60:63], v[172:175]
ds_read_b128 a[60:63], v13 offset:40960
v_mul_f32 v154, v154, v146
v_mul_f32 v155, v155, v147
v_mfma_f32_16x16x32_bf16 v[172:175], a[8:11], a[16:19], v[172:175]
ds_read_b128 a[16:19], v14 offset:40960
ds_read_b64_tr_b16 a[190:191], v42 offset:24576
v_mul_f32 v156, v156, v148
v_mul_f32 v157, v157, v149
v_mfma_f32_16x16x32_bf16 v[172:175], a[232:235], a[84:87], v[172:175]
ds_read_b128 a[84:87], v21 offset:18432
v_mul_f32 v158, v158, v150
v_mul_f32 v159, v159, v151
v_mfma_f32_16x16x32_bf16 v[172:175], a[76:79], a[56:59], v[172:175]
ds_read_b128 a[56:59], v22 offset:18432
v_cvt_pk_bf16_f32 v144, v152, v153
v_cvt_pk_bf16_f32 v145, v154, v155
v_cvt_pk_bf16_f32 v146, v156, v157
v_mfma_f32_16x16x32_bf16 v[172:175], a[40:43], a[80:83], v[172:175]
ds_read_b128 a[80:83], v13 offset:18432
v_cvt_pk_bf16_f32 v147, v158, v159
buffer_store_dwordx4 v[144:147], v61, s[36:39], s91 offen sc1
v_mfma_f32_16x16x32_bf16 v[172:175], a[100:103], a[212:215], v[172:175]
ds_read_b128 a[212:215], v14 offset:18432
s_waitcnt lgkmcnt(4)
v_mfma_f32_16x16x32_bf16 v[176:179], a[124:127], a[0:3], v[176:179]
v_mul_f32 v160, s82, v160
v_mul_f32 v161, s82, v161
v_mul_f32 v162, s82, v162
v_mfma_f32_16x16x32_bf16 v[176:179], a[248:251], a[220:223], v[176:179]
v_mul_f32 v163, s82, v163
v_mul_f32 v164, s82, v164
v_mfma_f32_16x16x32_bf16 v[176:179], a[112:115], a[236:239], v[176:179]
v_mul_f32 v165, s82, v165
v_mul_f32 v166, s82, v166
v_mfma_f32_16x16x32_bf16 v[176:179], a[216:219], a[72:75], v[176:179]
v_mul_f32 v167, s82, v167
v_exp_f32 v160, v160
v_mfma_f32_16x16x32_bf16 v[176:179], a[120:123], a[208:211], v[176:179]
v_exp_f32 v161, v161
v_mfma_f32_16x16x32_bf16 v[176:179], a[116:119], a[204:207], v[176:179]
v_exp_f32 v162, v162
v_mfma_f32_16x16x32_bf16 v[176:179], a[48:51], a[44:47], v[176:179]
v_exp_f32 v163, v163
v_mfma_f32_16x16x32_bf16 v[180:183], a[192:195], a[0:3], v[180:183]
v_exp_f32 v164, v164
v_mfma_f32_16x16x32_bf16 v[180:183], a[252:255], a[220:223], v[180:183]
v_exp_f32 v165, v165
v_exp_f32 v166, v166
v_mfma_f32_16x16x32_bf16 v[180:183], a[12:15], a[236:239], v[180:183]
v_exp_f32 v167, v167
v_mfma_f32_16x16x32_bf16 v[180:183], a[224:227], a[72:75], v[180:183]
v_add_f32 v160, 1.0, v160
v_mfma_f32_16x16x32_bf16 v[180:183], a[64:67], a[208:211], v[180:183]
v_add_f32 v161, 1.0, v161
v_add_f32 v162, 1.0, v162
v_mfma_f32_16x16x32_bf16 v[180:183], a[32:35], a[204:207], v[180:183]
v_add_f32 v163, 1.0, v163
v_add_f32 v164, 1.0, v164
v_add_f32 v165, 1.0, v165
v_mfma_f32_16x16x32_bf16 v[180:183], a[92:95], a[44:47], v[180:183]
v_add_f32 v166, 1.0, v166
v_add_f32 v167, 1.0, v167
v_mfma_f32_16x16x32_bf16 v[184:187], a[200:203], a[0:3], v[184:187]
v_rcp_f32 v160, v160
v_mfma_f32_16x16x32_bf16 v[184:187], a[20:23], a[220:223], v[184:187]
v_rcp_f32 v161, v161
v_mfma_f32_16x16x32_bf16 v[184:187], a[4:7], a[236:239], v[184:187]
v_rcp_f32 v162, v162
v_mfma_f32_16x16x32_bf16 v[184:187], a[228:231], a[72:75], v[184:187]
v_rcp_f32 v163, v163
v_rcp_f32 v164, v164
v_mfma_f32_16x16x32_bf16 v[184:187], a[68:71], a[208:211], v[184:187]
v_rcp_f32 v165, v165
v_mfma_f32_16x16x32_bf16 v[184:187], a[36:39], a[204:207], v[184:187]
v_rcp_f32 v166, v166
v_mfma_f32_16x16x32_bf16 v[184:187], a[96:99], a[44:47], v[184:187]
v_rcp_f32 v167, v167
v_mfma_f32_16x16x32_bf16 v[188:191], a[28:31], a[0:3], v[188:191]
ds_read_b128 a[0:3], v13 offset:43008
v_mul_f32 v168, v168, v160
v_mul_f32 v169, v169, v161
v_mfma_f32_16x16x32_bf16 v[188:191], a[88:91], a[220:223], v[188:191]
ds_read_b128 a[220:223], v14 offset:43008
v_mul_f32 v170, v170, v162
v_mul_f32 v171, v171, v163
v_mfma_f32_16x16x32_bf16 v[188:191], a[8:11], a[236:239], v[188:191]
ds_read_b128 a[236:239], v21 offset:20480
v_mul_f32 v172, v172, v164
v_mul_f32 v173, v173, v165
v_mfma_f32_16x16x32_bf16 v[188:191], a[232:235], a[72:75], v[188:191]
ds_read_b128 a[72:75], v22 offset:20480
v_mul_f32 v174, v174, v166
v_mul_f32 v175, v175, v167
v_mfma_f32_16x16x32_bf16 v[188:191], a[76:79], a[208:211], v[188:191]
ds_read_b128 a[208:211], v13 offset:20480
v_cvt_pk_bf16_f32 v160, v168, v169
v_cvt_pk_bf16_f32 v161, v170, v171
v_cvt_pk_bf16_f32 v162, v172, v173
v_mfma_f32_16x16x32_bf16 v[188:191], a[40:43], a[204:207], v[188:191]
ds_read_b128 a[204:207], v14 offset:20480
v_cvt_pk_bf16_f32 v163, v174, v175
buffer_store_dwordx4 v[160:163], v61, s[36:39], s92 offen sc1
v_mfma_f32_16x16x32_bf16 v[188:191], a[100:103], a[44:47], v[188:191]
ds_read_b128 a[44:47], v13 offset:45056
v_mfma_f32_16x16x32_bf16 v[192:195], a[124:127], a[244:247], v[192:195]
v_mul_f32 v176, s82, v176
v_mul_f32 v177, s82, v177
v_mul_f32 v178, s82, v178
v_mfma_f32_16x16x32_bf16 v[192:195], a[248:251], a[24:27], v[192:195]
v_mul_f32 v179, s82, v179
v_mul_f32 v180, s82, v180
v_mfma_f32_16x16x32_bf16 v[192:195], a[112:115], a[104:107], v[192:195]
v_mul_f32 v181, s82, v181
v_mul_f32 v182, s82, v182
v_mul_f32 v183, s82, v183
v_mfma_f32_16x16x32_bf16 v[192:195], a[216:219], a[108:111], v[192:195]
v_exp_f32 v176, v176
v_mfma_f32_16x16x32_bf16 v[192:195], a[120:123], a[52:55], v[192:195]
s_waitcnt vmcnt(1)
s_barrier
s_cmp_lg_u32 s60, 0
s_cbranch_scc1 H_fa
s_mov_b32 exec_lo, 0
s_brev_b32 exec_hi, 1
buffer_store_dword v28, v30, s[20:23], 0 offen sc1
s_mov_b64 exec, -1
H_fa:
v_exp_f32 v177, v177
v_mfma_f32_16x16x32_bf16 v[192:195], a[116:119], a[60:63], v[192:195]
v_exp_f32 v178, v178
v_mfma_f32_16x16x32_bf16 v[192:195], a[48:51], a[16:19], v[192:195]
v_exp_f32 v179, v179
v_mfma_f32_16x16x32_bf16 v[196:199], a[192:195], a[244:247], v[196:199]
v_exp_f32 v180, v180
v_mfma_f32_16x16x32_bf16 v[196:199], a[252:255], a[24:27], v[196:199]
v_exp_f32 v181, v181
v_exp_f32 v182, v182
v_mfma_f32_16x16x32_bf16 v[196:199], a[12:15], a[104:107], v[196:199]
v_exp_f32 v183, v183
v_mfma_f32_16x16x32_bf16 v[196:199], a[224:227], a[108:111], v[196:199]
v_add_f32 v176, 1.0, v176
v_mfma_f32_16x16x32_bf16 v[196:199], a[64:67], a[52:55], v[196:199]
v_add_f32 v177, 1.0, v177
v_add_f32 v178, 1.0, v178
v_add_f32 v179, 1.0, v179
v_mfma_f32_16x16x32_bf16 v[196:199], a[32:35], a[60:63], v[196:199]
buffer_store_dwordx4 v[4:7], v3, s[20:23], 0 offen offset:0 sc1
v_mfma_f32_16x16x32_bf16 v[196:199], a[92:95], a[16:19], v[196:199]
v_add_f32 v180, 1.0, v180
v_add_f32 v181, 1.0, v181
v_mfma_f32_16x16x32_bf16 v[200:203], a[200:203], a[244:247], v[200:203]
v_add_f32 v182, 1.0, v182
v_add_f32 v183, 1.0, v183
v_mfma_f32_16x16x32_bf16 v[200:203], a[20:23], a[24:27], v[200:203]
v_rcp_f32 v176, v176
v_rcp_f32 v177, v177
v_mfma_f32_16x16x32_bf16 v[200:203], a[4:7], a[104:107], v[200:203]
v_rcp_f32 v178, v178
v_mfma_f32_16x16x32_bf16 v[200:203], a[228:231], a[108:111], v[200:203]
v_rcp_f32 v179, v179
v_mfma_f32_16x16x32_bf16 v[200:203], a[68:71], a[52:55], v[200:203]
v_rcp_f32 v180, v180
v_mfma_f32_16x16x32_bf16 v[200:203], a[36:39], a[60:63], v[200:203]
v_rcp_f32 v181, v181
v_mfma_f32_16x16x32_bf16 v[200:203], a[96:99], a[16:19], v[200:203]
v_rcp_f32 v182, v182
v_mfma_f32_16x16x32_bf16 v[204:207], a[28:31], a[244:247], v[204:207]
ds_read_b128 a[244:247], v14 offset:45056
v_rcp_f32 v183, v183
v_mul_f32 v184, v184, v176
v_mfma_f32_16x16x32_bf16 v[204:207], a[88:91], a[24:27], v[204:207]
v_mul_f32 v185, v185, v177
v_mul_f32 v186, v186, v178
v_mfma_f32_16x16x32_bf16 v[204:207], a[8:11], a[104:107], v[204:207]
v_mul_f32 v187, v187, v179
v_mul_f32 v188, v188, v180
v_mul_f32 v189, v189, v181
v_mfma_f32_16x16x32_bf16 v[204:207], a[232:235], a[108:111], v[204:207]
v_mul_f32 v190, v190, v182
v_mul_f32 v191, v191, v183
v_mfma_f32_16x16x32_bf16 v[204:207], a[76:79], a[52:55], v[204:207]
v_cvt_pk_bf16_f32 v176, v184, v185
v_cvt_pk_bf16_f32 v177, v186, v187
v_mfma_f32_16x16x32_bf16 v[204:207], a[40:43], a[60:63], v[204:207]
v_cvt_pk_bf16_f32 v178, v188, v189
v_cvt_pk_bf16_f32 v179, v190, v191
buffer_store_dwordx4 v[176:179], v61, s[36:39], s93 offen sc1
v_mfma_f32_16x16x32_bf16 v[204:207], a[100:103], a[16:19], v[204:207]
v_mfma_f32_16x16x32_bf16 v[208:211], a[124:127], a[196:199], v[208:211]
v_mul_f32 v192, s82, v192
v_mul_f32 v193, s82, v193
v_mul_f32 v194, s82, v194
s_waitcnt lgkmcnt(0)
v_mfma_f32_16x16x32_bf16 v[208:211], a[248:251], a[84:87], v[208:211]
v_mul_f32 v195, s82, v195
v_mul_f32 v196, s82, v196
v_mfma_f32_16x16x32_bf16 v[208:211], a[112:115], a[56:59], v[208:211]
v_mul_f32 v197, s82, v197
v_mul_f32 v198, s82, v198
v_mfma_f32_16x16x32_bf16 v[208:211], a[216:219], a[80:83], v[208:211]
v_mul_f32 v199, s82, v199
v_exp_f32 v192, v192
v_mfma_f32_16x16x32_bf16 v[208:211], a[120:123], a[212:215], v[208:211]
v_exp_f32 v193, v193
v_mfma_f32_16x16x32_bf16 v[208:211], a[116:119], a[0:3], v[208:211]
v_exp_f32 v194, v194
v_mfma_f32_16x16x32_bf16 v[208:211], a[48:51], a[220:223], v[208:211]
v_exp_f32 v195, v195
v_exp_f32 v196, v196
v_mfma_f32_16x16x32_bf16 v[212:215], a[192:195], a[196:199], v[212:215]
v_exp_f32 v197, v197
v_mfma_f32_16x16x32_bf16 v[212:215], a[252:255], a[84:87], v[212:215]
v_exp_f32 v198, v198
v_mfma_f32_16x16x32_bf16 v[212:215], a[12:15], a[56:59], v[212:215]
v_exp_f32 v199, v199
v_mfma_f32_16x16x32_bf16 v[212:215], a[224:227], a[80:83], v[212:215]
v_add_f32 v192, 1.0, v192
v_add_f32 v193, 1.0, v193
v_mfma_f32_16x16x32_bf16 v[212:215], a[64:67], a[212:215], v[212:215]
v_add_f32 v194, 1.0, v194
v_add_f32 v195, 1.0, v195
v_mfma_f32_16x16x32_bf16 v[212:215], a[32:35], a[0:3], v[212:215]
buffer_store_dwordx4 v[4:7], v3, s[20:23], 0 offen offset:1024 sc1
v_mfma_f32_16x16x32_bf16 v[212:215], a[92:95], a[220:223], v[212:215]
v_add_f32 v196, 1.0, v196
v_add_f32 v197, 1.0, v197
v_mfma_f32_16x16x32_bf16 v[216:219], a[200:203], a[196:199], v[216:219]
v_add_f32 v198, 1.0, v198
v_add_f32 v199, 1.0, v199
v_rcp_f32 v192, v192
v_mfma_f32_16x16x32_bf16 v[216:219], a[20:23], a[84:87], v[216:219]
v_rcp_f32 v193, v193
v_mfma_f32_16x16x32_bf16 v[216:219], a[4:7], a[56:59], v[216:219]
v_rcp_f32 v194, v194
v_mfma_f32_16x16x32_bf16 v[216:219], a[228:231], a[80:83], v[216:219]
v_rcp_f32 v195, v195
v_mfma_f32_16x16x32_bf16 v[216:219], a[68:71], a[212:215], v[216:219]
v_rcp_f32 v196, v196
v_mfma_f32_16x16x32_bf16 v[216:219], a[36:39], a[0:3], v[216:219]
v_rcp_f32 v197, v197
v_mfma_f32_16x16x32_bf16 v[216:219], a[96:99], a[220:223], v[216:219]
v_rcp_f32 v198, v198
v_rcp_f32 v199, v199
v_mfma_f32_16x16x32_bf16 v[220:223], a[28:31], a[196:199], v[220:223]
v_mul_f32 v200, v200, v192
v_mfma_f32_16x16x32_bf16 v[220:223], a[88:91], a[84:87], v[220:223]
v_mul_f32 v201, v201, v193
v_mul_f32 v202, v202, v194
v_mfma_f32_16x16x32_bf16 v[220:223], a[8:11], a[56:59], v[220:223]
v_mul_f32 v203, v203, v195
v_mul_f32 v204, v204, v196
v_mul_f32 v205, v205, v197
v_mfma_f32_16x16x32_bf16 v[220:223], a[232:235], a[80:83], v[220:223]
v_mul_f32 v206, v206, v198
v_mul_f32 v207, v207, v199
v_mfma_f32_16x16x32_bf16 v[220:223], a[76:79], a[212:215], v[220:223]
v_cvt_pk_bf16_f32 v192, v200, v201
v_cvt_pk_bf16_f32 v193, v202, v203
v_mfma_f32_16x16x32_bf16 v[220:223], a[40:43], a[0:3], v[220:223]
v_cvt_pk_bf16_f32 v194, v204, v205
v_cvt_pk_bf16_f32 v195, v206, v207
buffer_store_dwordx4 v[192:195], v61, s[36:39], s94 offen sc1
v_mfma_f32_16x16x32_bf16 v[220:223], a[100:103], a[220:223], v[220:223]
v_mfma_f32_16x16x32_bf16 v[224:227], a[124:127], a[240:243], v[224:227]
v_mul_f32 v208, s82, v208
v_mul_f32 v209, s82, v209
v_mul_f32 v210, s82, v210
v_mfma_f32_16x16x32_bf16 v[224:227], a[248:251], a[236:239], v[224:227]
v_mul_f32 v211, s82, v211
v_mul_f32 v212, s82, v212
v_mfma_f32_16x16x32_bf16 v[224:227], a[112:115], a[72:75], v[224:227]
v_mul_f32 v213, s82, v213
v_mul_f32 v214, s82, v214
v_mfma_f32_16x16x32_bf16 v[224:227], a[216:219], a[208:211], v[224:227]
v_mul_f32 v215, s82, v215
s_mov_b32 exec_lo, s27
s_mov_b32 exec_hi, 1
buffer_load_dword v16, v30, s[20:23], 0 offen sc1
s_mov_b64 exec, -1
v_exp_f32 v208, v208
v_mfma_f32_16x16x32_bf16 v[224:227], a[120:123], a[204:207], v[224:227]
v_exp_f32 v209, v209
v_mfma_f32_16x16x32_bf16 v[224:227], a[116:119], a[44:47], v[224:227]
v_exp_f32 v210, v210
v_mfma_f32_16x16x32_bf16 v[224:227], a[48:51], a[244:247], v[224:227]
v_exp_f32 v211, v211
v_mfma_f32_16x16x32_bf16 v[228:231], a[192:195], a[240:243], v[228:231]
v_exp_f32 v212, v212
v_mfma_f32_16x16x32_bf16 v[228:231], a[252:255], a[236:239], v[228:231]
v_exp_f32 v213, v213
v_mfma_f32_16x16x32_bf16 v[228:231], a[12:15], a[72:75], v[228:231]
v_exp_f32 v214, v214
v_mfma_f32_16x16x32_bf16 v[228:231], a[224:227], a[208:211], v[228:231]
v_exp_f32 v215, v215
v_mfma_f32_16x16x32_bf16 v[228:231], a[64:67], a[204:207], v[228:231]
v_add_f32 v208, 1.0, v208
v_add_f32 v209, 1.0, v209
v_add_f32 v210, 1.0, v210
v_mfma_f32_16x16x32_bf16 v[228:231], a[32:35], a[44:47], v[228:231]
v_add_f32 v211, 1.0, v211
v_add_f32 v212, 1.0, v212
v_mfma_f32_16x16x32_bf16 v[228:231], a[92:95], a[244:247], v[228:231]
v_add_f32 v213, 1.0, v213
v_add_f32 v214, 1.0, v214
v_mfma_f32_16x16x32_bf16 v[232:235], a[200:203], a[240:243], v[232:235]
v_add_f32 v215, 1.0, v215
v_rcp_f32 v208, v208
v_mfma_f32_16x16x32_bf16 v[232:235], a[20:23], a[236:239], v[232:235]
v_rcp_f32 v209, v209
v_mfma_f32_16x16x32_bf16 v[232:235], a[4:7], a[72:75], v[232:235]
v_rcp_f32 v210, v210
v_mfma_f32_16x16x32_bf16 v[232:235], a[228:231], a[208:211], v[232:235]
v_rcp_f32 v211, v211
v_mfma_f32_16x16x32_bf16 v[232:235], a[68:71], a[204:207], v[232:235]
v_rcp_f32 v212, v212
v_rcp_f32 v213, v213
v_mfma_f32_16x16x32_bf16 v[232:235], a[36:39], a[44:47], v[232:235]
v_rcp_f32 v214, v214
v_mfma_f32_16x16x32_bf16 v[232:235], a[96:99], a[244:247], v[232:235]
v_rcp_f32 v215, v215
v_mfma_f32_16x16x32_bf16 v[236:239], a[28:31], a[240:243], v[236:239]
v_mul_f32 v216, v216, v208
v_mfma_f32_16x16x32_bf16 v[236:239], a[88:91], a[236:239], v[236:239]
v_mul_f32 v217, v217, v209
v_mul_f32 v218, v218, v210
v_mul_f32 v219, v219, v211
v_mfma_f32_16x16x32_bf16 v[236:239], a[8:11], a[72:75], v[236:239]
v_mul_f32 v220, v220, v212
v_mul_f32 v221, v221, v213
v_mfma_f32_16x16x32_bf16 v[236:239], a[232:235], a[208:211], v[236:239]
v_mul_f32 v222, v222, v214
v_mul_f32 v223, v223, v215
v_mfma_f32_16x16x32_bf16 v[236:239], a[76:79], a[204:207], v[236:239]
v_cvt_pk_bf16_f32 v208, v216, v217
v_cvt_pk_bf16_f32 v209, v218, v219
v_mfma_f32_16x16x32_bf16 v[236:239], a[40:43], a[44:47], v[236:239]
v_cvt_pk_bf16_f32 v210, v220, v221
v_cvt_pk_bf16_f32 v211, v222, v223
buffer_store_dwordx4 v[208:211], v61, s[36:39], s95 offen sc1
v_mfma_f32_16x16x32_bf16 v[236:239], a[100:103], a[244:247], v[236:239]
v_lshlrev_b32 v22, 4, v1
s_xor_b32 s4, s72, 1
s_mul_i32 s4, s4, 294912
v_add_u32 v8, s4, v22
v_pk_mul_f32 v[224:225], v[224:225], s[82:83]
H_T3:
s_cbranch_execz H_Tret
v_pk_mul_f32 v[226:227], v[226:227], s[82:83]
v_pk_mul_f32 v[228:229], v[228:229], s[82:83]
v_pk_mul_f32 v[230:231], v[230:231], s[82:83]
v_exp_f32 v224, v224
v_exp_f32 v225, v225
v_exp_f32 v226, v226
v_exp_f32 v227, v227
v_exp_f32 v228, v228
v_exp_f32 v229, v229
v_exp_f32 v230, v230
v_exp_f32 v231, v231
v_pk_add_f32 v[224:225], v[224:225], s[84:85]
v_pk_add_f32 v[226:227], v[226:227], s[84:85]
v_pk_add_f32 v[228:229], v[228:229], s[84:85]
v_pk_add_f32 v[230:231], v[230:231], s[84:85]
v_rcp_f32 v224, v224
v_rcp_f32 v225, v225
v_rcp_f32 v226, v226
v_rcp_f32 v227, v227
v_rcp_f32 v228, v228
v_rcp_f32 v229, v229
v_rcp_f32 v230, v230
v_rcp_f32 v231, v231
v_pk_mul_f32 v[232:233], v[232:233], v[224:225]
v_pk_mul_f32 v[234:235], v[234:235], v[226:227]
v_pk_mul_f32 v[236:237], v[236:237], v[228:229]
v_pk_mul_f32 v[238:239], v[238:239], v[230:231]
v_cvt_pk_bf16_f32 v224, v232, v233
v_cvt_pk_bf16_f32 v225, v234, v235
v_cvt_pk_bf16_f32 v226, v236, v237
v_cvt_pk_bf16_f32 v227, v238, v239
buffer_store_dwordx4 v[224:227], v61, s[36:39], s96 offen sc1
s_waitcnt vmcnt(2)
s_mov_b32 exec_lo, s27
s_mov_b32 exec_hi, 1
s_mov_b32 s4, 0
H_pa:
v_and_b32 v16, 1, v16
v_cmp_ne_u32 vcc, v28, v16
s_nop 1
s_cmp_eq_u64 vcc, 0
s_cbranch_scc1 H_pa_ok
buffer_load_dword v16, v30, s[20:23], 0 offen sc1
s_add_u32 s4, s4, 1
s_waitcnt vmcnt(0)
s_cmp_lt_u32 s4, 0x8000
s_cbranch_scc1 H_pa
H_pa_ok:
s_mov_b64 exec, -1
v_and_b32 v23, 15, v1
s_lshl_b32 s4, s72, 9
v_lshl_add_u32 v27, v23, 2, s4
v_xor_b32 v26, 512, v27
buffer_load_dwordx4 a[0:3], v8, s[36:39], s74 offen offset:0 sc1
buffer_load_dwordx4 a[4:7], v8, s[36:39], s75 offen offset:0 sc1
buffer_load_dwordx4 a[8:11], v8, s[36:39], s74 offen offset:1024 sc1
buffer_load_dwordx4 a[12:15], v8, s[36:39], s75 offen offset:1024 sc1
buffer_load_dword v44, v26, s[40:43], 0 offen offset:0 sc1
buffer_load_dword v46, v26, s[40:43], 0 offen offset:256 sc1
buffer_load_dwordx4 a[16:19], v8, s[36:39], s76 offen offset:0 sc1
buffer_load_dwordx4 a[20:23], v8, s[36:39], s78 offen offset:0 sc1
buffer_load_dwordx4 a[24:27], v8, s[36:39], s76 offen offset:1024 sc1
buffer_load_dwordx4 a[28:31], v8, s[36:39], s78 offen offset:1024 sc1
ds_read_b64_tr_b16 a[192:193], v36 offset:32768
ds_read_b64_tr_b16 a[196:197], v38 offset:32768
ds_read_b64_tr_b16 a[200:201], v40 offset:32768
ds_read_b64_tr_b16 a[204:205], v42 offset:32768
ds_read_b64_tr_b16 a[194:195], v36 offset:40960
ds_read_b64_tr_b16 a[198:199], v38 offset:40960
ds_read_b64_tr_b16 a[202:203], v40 offset:40960
ds_read_b64_tr_b16 a[206:207], v42 offset:40960
ds_read_b64_tr_b16 a[208:209], v36 offset:49152
ds_read_b64_tr_b16 a[212:213], v38 offset:49152
ds_read_b64_tr_b16 a[216:217], v40 offset:49152
ds_read_b64_tr_b16 a[220:221], v42 offset:49152
ds_read_b64_tr_b16 a[210:211], v32 offset:0
ds_read_b64_tr_b16 a[214:215], v33 offset:0
ds_read_b64_tr_b16 a[218:219], v34 offset:0
ds_read_b64_tr_b16 a[222:223], v35 offset:0
ds_read_b64_tr_b16 a[224:225], v32 offset:24576
ds_read_b64_tr_b16 a[228:229], v33 offset:24576
ds_read_b64_tr_b16 a[232:233], v34 offset:24576
ds_read_b64_tr_b16 a[236:237], v35 offset:24576
ds_read_b64_tr_b16 a[226:227], v36 offset:57344
ds_read_b64_tr_b16 a[230:231], v38 offset:57344
ds_read_b64_tr_b16 a[234:235], v40 offset:57344
ds_read_b64_tr_b16 a[238:239], v42 offset:57344
ds_read_b64_tr_b16 a[240:241], v37 offset:0
ds_read_b64_tr_b16 a[244:245], v39 offset:0
ds_read_b64_tr_b16 a[248:249], v41 offset:0
ds_read_b64_tr_b16 a[252:253], v43 offset:0
ds_read_b64_tr_b16 a[242:243], v37 offset:16384
ds_read_b64_tr_b16 a[246:247], v39 offset:16384
ds_read_b64_tr_b16 a[250:251], v41 offset:16384
ds_read_b64_tr_b16 a[254:255], v43 offset:16384
ds_read_b64_tr_b16 a[112:113], v32 offset:49152
ds_read_b64_tr_b16 a[116:117], v33 offset:49152
ds_read_b64_tr_b16 a[120:121], v34 offset:49152
ds_read_b64_tr_b16 a[124:125], v35 offset:49152
ds_read_b64_tr_b16 a[114:115], v37 offset:8192
ds_read_b64_tr_b16 a[118:119], v39 offset:8192
ds_read_b64_tr_b16 a[122:123], v41 offset:8192
ds_read_b64_tr_b16 a[126:127], v43 offset:8192
s_waitcnt lgkmcnt(0)
s_mul_i32 s4, s72, 294912
v_add_u32 v10, s4, v22
v_add_u32 v9, 147456, v8
v_add_u32 v11, 147456, v10
s_lshl_b32 s4, s2, 13
s_lshl_b32 s5, s60, 11
s_add_u32 s4, s4, s5
s_add_u32 s4, s4, 32768
v_add_u32 v14, s4, v22
v_xor_b32 v15, 0x2000, v14
s_add_u32 s14, s71, 155648
v_mov_b32 v60, s14
v_mov_b32 v61, 0
ds_write_b32 v60, v61
s_waitcnt vmcnt(10) lgkmcnt(0)
s_barrier
s_cmp_lg_u32 s60, 0
s_cbranch_scc1 H_fb
s_mov_b32 exec_lo, 0
s_brev_b32 exec_hi, 1
buffer_store_dword v29, v30, s[20:23], 0 offen sc1
s_mov_b64 exec, -1
H_fb:
s_waitcnt vmcnt(8)
v_mfma_f32_16x16x32_bf16 v[64:67], a[128:131], a[0:3], 0
buffer_load_dwordx4 a[32:35], v8, s[36:39], s79 offen offset:0 sc1
v_mfma_f32_16x16x32_bf16 v[64:67], a[144:147], a[4:7], v[64:67]
buffer_load_dword v48, v27, s[40:43], 0 offen offset:0 sc1
v_mfma_f32_16x16x32_bf16 v[68:71], a[132:135], a[0:3], 0
buffer_load_dwordx4 a[36:39], v8, s[36:39], s80 offen offset:0 sc1
buffer_load_dword v50, v27, s[40:43], 0 offen offset:256 sc1
v_mfma_f32_16x16x32_bf16 v[68:71], a[148:151], a[4:7], v[68:71]
buffer_load_dword v45, v26, s[40:43], 0 offen offset:128 sc1
buffer_load_dword v47, v26, s[40:43], 0 offen offset:384 sc1
v_mfma_f32_16x16x32_bf16 v[72:75], a[136:139], a[0:3], 0
buffer_load_dwordx4 a[40:43], v8, s[36:39], s81 offen offset:0 sc1
v_mfma_f32_16x16x32_bf16 v[72:75], a[152:155], a[4:7], v[72:75]
buffer_load_dword v49, v27, s[40:43], 0 offen offset:128 sc1
v_mfma_f32_16x16x32_bf16 v[76:79], a[140:143], a[0:3], 0
buffer_load_dword v51, v27, s[40:43], 0 offen offset:384 sc1
v_lshrrev_b32 v24, 4, v1
v_mfma_f32_16x16x32_bf16 v[76:79], a[156:159], a[4:7], v[76:79]
v_and_b32 v25, 2, v24
v_xor_b32 v25, v25, v23
v_lshl_add_u32 v25, v24, 4, v25
s_waitcnt vmcnt(15)
s_waitcnt vmcnt(13)
v_mfma_f32_16x16x32_bf16 v[80:83], a[128:131], a[8:11], 0
buffer_load_dwordx4 a[44:47], v8, s[36:39], s18 offen offset:0 sc1
v_mfma_f32_16x16x32_bf16 v[80:83], a[144:147], a[12:15], v[80:83]
v_mul_f32 v64, v64, v44
v_mul_f32 v65, v65, v44
v_mfma_f32_16x16x32_bf16 v[84:87], a[132:135], a[8:11], 0
v_mul_f32 v66, v66, v44
v_mul_f32 v67, v67, v44
v_mul_f32 v68, v68, v44
buffer_load_dwordx4 a[48:51], v8, s[36:39], s19 offen offset:0 sc1
v_mfma_f32_16x16x32_bf16 v[84:87], a[148:151], a[12:15], v[84:87]
v_mul_f32 v69, v69, v44
v_mul_f32 v70, v70, v44
v_mul_f32 v71, v71, v44
v_mfma_f32_16x16x32_bf16 v[88:91], a[136:139], a[8:11], 0
buffer_load_dwordx4 a[52:55], v8, s[36:39], s79 offen offset:1024 sc1
v_mfma_f32_16x16x32_bf16 v[88:91], a[152:155], a[12:15], v[88:91]
v_mul_f32 v72, v72, v44
v_mul_f32 v73, v73, v44
v_mul_f32 v74, v74, v44
v_mfma_f32_16x16x32_bf16 v[92:95], a[140:143], a[8:11], 0
v_mul_f32 v75, v75, v44
v_mul_f32 v76, v76, v44
v_mul_f32 v77, v77, v44
v_mfma_f32_16x16x32_bf16 v[92:95], a[156:159], a[12:15], v[92:95]
v_mul_f32 v78, v78, v44
v_mul_f32 v79, v79, v44
s_waitcnt vmcnt(14)
v_mfma_f32_16x16x32_bf16 v[64:67], a[160:163], a[16:19], v[64:67]
buffer_load_dwordx4 a[56:59], v8, s[36:39], s80 offen offset:1024 sc1
v_mfma_f32_16x16x32_bf16 v[64:67], a[176:179], a[20:23], v[64:67]
v_mul_f32 v80, v80, v46
v_mul_f32 v81, v81, v46
v_mfma_f32_16x16x32_bf16 v[68:71], a[164:167], a[16:19], v[68:71]
v_mul_f32 v82, v82, v46
v_mul_f32 v83, v83, v46
v_mul_f32 v84, v84, v46
buffer_load_dwordx4 a[60:63], v8, s[36:39], s81 offen offset:1024 sc1
v_mfma_f32_16x16x32_bf16 v[68:71], a[180:183], a[20:23], v[68:71]
v_mul_f32 v85, v85, v46
v_mul_f32 v86, v86, v46
v_mul_f32 v87, v87, v46
v_mfma_f32_16x16x32_bf16 v[72:75], a[168:171], a[16:19], v[72:75]
buffer_load_dwordx4 a[64:67], v8, s[36:39], s18 offen offset:1024 sc1
v_mfma_f32_16x16x32_bf16 v[72:75], a[184:187], a[20:23], v[72:75]
v_mul_f32 v88, v88, v46
v_mul_f32 v89, v89, v46
v_mul_f32 v90, v90, v46
v_mfma_f32_16x16x32_bf16 v[76:79], a[172:175], a[16:19], v[76:79]
v_mul_f32 v91, v91, v46
v_mul_f32 v92, v92, v46
v_mul_f32 v93, v93, v46
v_mfma_f32_16x16x32_bf16 v[76:79], a[188:191], a[20:23], v[76:79]
v_mul_f32 v94, v94, v46
v_mul_f32 v95, v95, v46
s_waitcnt vmcnt(15)
v_mfma_f32_16x16x32_bf16 v[80:83], a[160:163], a[24:27], v[80:83]
buffer_load_dwordx4 a[68:71], v8, s[36:39], s19 offen offset:1024 sc1
v_mfma_f32_16x16x32_bf16 v[80:83], a[176:179], a[28:31], v[80:83]
v_lshl_add_u32 v18, v25, 4, s71
v_xor_b32 v19, 64, v18
v_mfma_f32_16x16x32_bf16 v[84:87], a[164:167], a[24:27], v[84:87]
buffer_load_dwordx4 a[72:75], v10, s[36:39], s74 offen offset:0 sc1
v_xor_b32 v20, 128, v18
v_xor_b32 v21, 192, v18
v_and_b32 v22, 7, v1
v_mfma_f32_16x16x32_bf16 v[84:87], a[180:183], a[28:31], v[84:87]
v_lshrrev_b32 v23, 3, v1
s_and_b32 s4, s60, 1
s_lshl_b32 s4, s4, 3
v_mfma_f32_16x16x32_bf16 v[88:91], a[168:171], a[24:27], v[88:91]
buffer_load_dwordx4 a[76:79], v10, s[36:39], s75 offen offset:0 sc1
v_mfma_f32_16x16x32_bf16 v[88:91], a[184:187], a[28:31], v[88:91]
v_add_u32 v23, s4, v23
s_lshl_b32 s5, s72, 1
v_mfma_f32_16x16x32_bf16 v[92:95], a[172:175], a[24:27], v[92:95]
s_lshr_b32 s6, s60, 1
s_add_u32 s5, s5, s6
s_lshl_b32 s5, s5, 15
v_mfma_f32_16x16x32_bf16 v[92:95], a[188:191], a[28:31], v[92:95]
s_lshl_b32 s7, s73, 7
s_add_u32 s5, s5, s7
v_lshl_add_u32 v13, v22, 4, s5
s_waitcnt vmcnt(15)
v_mfma_f32_16x16x32_bf16 v[64:67], a[192:195], a[32:35], v[64:67]
buffer_load_dwordx4 a[80:83], v10, s[36:39], s74 offen offset:1024 sc1
v_mfma_f32_16x16x32_bf16 v[64:67], a[208:211], a[36:39], v[64:67]
v_lshl_add_u32 v13, v23, 11, v13
s_lshl_b32 s8, s72, 9
v_mfma_f32_16x16x32_bf16 v[68:71], a[196:199], a[32:35], v[68:71]
s_lshl_b32 s9, s6, 8
s_add_u32 s8, s8, s9
v_lshl_add_u32 v56, v23, 2, s8
v_mfma_f32_16x16x32_bf16 v[68:71], a[212:215], a[36:39], v[68:71]
v_lshlrev_b32 v24, 1, v22
v_xor_b32 v23, v23, v24
v_lshlrev_b32 v23, 4, v23
v_mfma_f32_16x16x32_bf16 v[72:75], a[200:203], a[32:35], v[72:75]
buffer_load_dwordx4 a[84:87], v10, s[36:39], s75 offen offset:1024 sc1
v_mfma_f32_16x16x32_bf16 v[72:75], a[216:219], a[36:39], v[72:75]
v_and_b32 v24, 3, v22
v_lshl_add_u32 v23, v24, 9, v23
v_mfma_f32_16x16x32_bf16 v[76:79], a[204:207], a[32:35], v[76:79]
v_lshrrev_b32 v22, 2, v22
v_lshl_add_u32 v23, v22, 13, v23
s_lshl_b32 s6, s6, 14
v_mfma_f32_16x16x32_bf16 v[76:79], a[220:223], a[36:39], v[76:79]
v_add_u32 v17, s6, v23
v_add_u32 v2, 0x10000, v17
v_add_u32 v3, 0x10000, v18
s_waitcnt vmcnt(10)
v_mfma_f32_16x16x32_bf16 v[64:67], a[224:227], a[40:43], v[64:67]
buffer_load_dwordx4 a[88:91], v10, s[36:39], s76 offen offset:0 sc1
v_mfma_f32_16x16x32_bf16 v[64:67], a[240:243], a[44:47], v[64:67]
v_add_u32 v4, 0x10000, v19
v_add_u32 v5, 0x10000, v20
v_mfma_f32_16x16x32_bf16 v[68:71], a[228:231], a[40:43], v[68:71]
v_add_u32 v6, 0x10000, v21
v_and_b32 v7, 3, v1
v_lshlrev_b32 v7, 11, v7
v_mfma_f32_16x16x32_bf16 v[68:71], a[244:247], a[44:47], v[68:71]
v_add_u32 v7, 155648, v7
s_add_u32 s4, s71, 155648
v_mov_b32 v12, s4
v_mfma_f32_16x16x32_bf16 v[72:75], a[232:235], a[40:43], v[72:75]
buffer_load_dwordx4 a[92:95], v10, s[36:39], s78 offen offset:0 sc1
s_mov_b32 exec_lo, s27
s_mov_b32 exec_hi, 1
buffer_load_dword v16, v30, s[20:23], 0 offen sc1
s_mov_b64 exec, -1
v_mfma_f32_16x16x32_bf16 v[72:75], a[248:251], a[44:47], v[72:75]
buffer_load_dword v54, v56, s[40:43], 0 offen offset:0 sc1
v_mfma_f32_16x16x32_bf16 v[76:79], a[236:239], a[40:43], v[76:79]
buffer_load_dword v55, v56, s[40:43], 0 offen offset:128 sc1
v_mfma_f32_16x16x32_bf16 v[76:79], a[252:255], a[44:47], v[76:79]
s_waitcnt vmcnt(13)
v_mfma_f32_16x16x32_bf16 v[64:67], a[112:115], a[48:51], v[64:67]
buffer_load_dwordx4 a[96:99], v10, s[36:39], s76 offen offset:1024 sc1
v_mfma_f32_16x16x32_bf16 v[68:71], a[116:119], a[48:51], v[68:71]
v_mfma_f32_16x16x32_bf16 v[72:75], a[120:123], a[48:51], v[72:75]
v_mfma_f32_16x16x32_bf16 v[76:79], a[124:127], a[48:51], v[76:79]
v_mfma_f32_16x16x32_bf16 v[80:83], a[192:195], a[52:55], v[80:83]
buffer_load_dwordx4 a[100:103], v10, s[36:39], s78 offen offset:1024 sc1
v_mfma_f32_16x16x32_bf16 v[84:87], a[196:199], a[52:55], v[84:87]
v_mfma_f32_16x16x32_bf16 v[88:91], a[200:203], a[52:55], v[88:91]
v_mfma_f32_16x16x32_bf16 v[92:95], a[204:207], a[52:55], v[92:95]
s_waitcnt vmcnt(13)
v_mfma_f32_16x16x32_bf16 v[80:83], a[208:211], a[56:59], v[80:83]
buffer_load_dwordx4 a[104:107], v10, s[36:39], s79 offen offset:0 sc1
v_mfma_f32_16x16x32_bf16 v[80:83], a[224:227], a[60:63], v[80:83]
ds_write_b128 v18, v[64:67] offset:0
v_mfma_f32_16x16x32_bf16 v[84:87], a[212:215], a[56:59], v[84:87]
ds_write_b128 v19, v[68:71] offset:1024
v_mfma_f32_16x16x32_bf16 v[84:87], a[228:231], a[60:63], v[84:87]
ds_write_b128 v20, v[72:75] offset:8192
ds_write_b128 v21, v[76:79] offset:9216
v_mfma_f32_16x16x32_bf16 v[88:91], a[216:219], a[56:59], v[88:91]
buffer_load_dwordx4 a[108:111], v10, s[36:39], s80 offen offset:0 sc1
v_mfma_f32_16x16x32_bf16 v[88:91], a[232:235], a[60:63], v[88:91]
v_mfma_f32_16x16x32_bf16 v[92:95], a[220:223], a[56:59], v[92:95]
v_mfma_f32_16x16x32_bf16 v[92:95], a[236:239], a[60:63], v[92:95]
s_waitcnt vmcnt(13)
v_mfma_f32_16x16x32_bf16 v[80:83], a[240:243], a[64:67], v[80:83]
buffer_load_dwordx4 a[0:3], v10, s[36:39], s81 offen offset:0 sc1
v_mfma_f32_16x16x32_bf16 v[80:83], a[112:115], a[68:71], v[80:83]
v_mfma_f32_16x16x32_bf16 v[84:87], a[244:247], a[64:67], v[84:87]
v_mfma_f32_16x16x32_bf16 v[84:87], a[116:119], a[68:71], v[84:87]
v_mfma_f32_16x16x32_bf16 v[88:91], a[248:251], a[64:67], v[88:91]
buffer_load_dwordx4 a[4:7], v10, s[36:39], s18 offen offset:0 sc1
v_mfma_f32_16x16x32_bf16 v[88:91], a[120:123], a[68:71], v[88:91]
v_mfma_f32_16x16x32_bf16 v[92:95], a[252:255], a[64:67], v[92:95]
v_mfma_f32_16x16x32_bf16 v[92:95], a[124:127], a[68:71], v[92:95]
s_waitcnt vmcnt(13)
v_mfma_f32_16x16x32_bf16 v[128:131], a[128:131], a[72:75], 0
buffer_load_dwordx4 a[8:11], v10, s[36:39], s19 offen offset:0 sc1
v_mfma_f32_16x16x32_bf16 v[128:131], a[144:147], a[76:79], v[128:131]
ds_write_b128 v18, v[80:83] offset:16384
v_mfma_f32_16x16x32_bf16 v[132:135], a[132:135], a[72:75], 0
ds_write_b128 v19, v[84:87] offset:17408
v_mfma_f32_16x16x32_bf16 v[132:135], a[148:151], a[76:79], v[132:135]
ds_write_b128 v20, v[88:91] offset:24576
ds_write_b128 v21, v[92:95] offset:25600
s_waitcnt vmcnt(9)
s_mov_b32 exec_lo, s27
s_mov_b32 exec_hi, 1
s_mov_b32 s4, 0
H_pb:
v_and_b32 v16, 3, v16
v_cmp_ne_u32 vcc, v29, v16
s_nop 1
s_cmp_eq_u64 vcc, 0
s_cbranch_scc1 H_pb_ok
buffer_load_dword v16, v30, s[20:23], 0 offen sc1
s_add_u32 s4, s4, 1
s_waitcnt vmcnt(0)
s_cmp_lt_u32 s4, 0x8000
s_cbranch_scc1 H_pb
H_pb_ok:
s_mov_b64 exec, -1
v_mfma_f32_16x16x32_bf16 v[136:139], a[136:139], a[72:75], 0
buffer_load_dwordx4 a[12:15], v9, s[36:39], s74 offen offset:0 sc1
v_mfma_f32_16x16x32_bf16 v[136:139], a[152:155], a[76:79], v[136:139]
v_mov_b32 v192, 1
v_mfma_f32_16x16x32_bf16 v[140:143], a[140:143], a[72:75], 0
ds_write_b32 v12, v192
v_mfma_f32_16x16x32_bf16 v[140:143], a[156:159], a[76:79], v[140:143]
v_mfma_f32_16x16x32_bf16 v[144:147], a[128:131], a[80:83], 0
buffer_load_dwordx4 a[16:19], v9, s[36:39], s75 offen offset:0 sc1
v_mfma_f32_16x16x32_bf16 v[144:147], a[144:147], a[84:87], v[144:147]
v_mul_f32 v128, v128, v48
v_mul_f32 v129, v129, v48
v_mfma_f32_16x16x32_bf16 v[148:151], a[132:135], a[80:83], 0
v_mul_f32 v130, v130, v48
v_mul_f32 v131, v131, v48
v_mul_f32 v132, v132, v48
v_mfma_f32_16x16x32_bf16 v[148:151], a[148:151], a[84:87], v[148:151]
v_mul_f32 v133, v133, v48
v_mul_f32 v134, v134, v48
v_mul_f32 v135, v135, v48
v_mfma_f32_16x16x32_bf16 v[152:155], a[136:139], a[80:83], 0
buffer_load_dwordx4 a[20:23], v9, s[36:39], s74 offen offset:1024 sc1
v_mfma_f32_16x16x32_bf16 v[152:155], a[152:155], a[84:87], v[152:155]
v_mul_f32 v136, v136, v48
v_mul_f32 v137, v137, v48
v_mul_f32 v138, v138, v48
v_mfma_f32_16x16x32_bf16 v[156:159], a[140:143], a[80:83], 0
v_mul_f32 v139, v139, v48
v_mul_f32 v140, v140, v48
v_mul_f32 v141, v141, v48
v_mfma_f32_16x16x32_bf16 v[156:159], a[156:159], a[84:87], v[156:159]
v_mul_f32 v142, v142, v48
v_mul_f32 v143, v143, v48
v_mfma_f32_16x16x32_bf16 v[128:131], a[160:163], a[88:91], v[128:131]
buffer_load_dwordx4 a[24:27], v9, s[36:39], s75 offen offset:1024 sc1
v_mfma_f32_16x16x32_bf16 v[128:131], a[176:179], a[92:95], v[128:131]
v_mul_f32 v144, v144, v50
v_mul_f32 v145, v145, v50
v_mfma_f32_16x16x32_bf16 v[132:135], a[164:167], a[88:91], v[132:135]
v_mul_f32 v146, v146, v50
v_mul_f32 v147, v147, v50
v_mul_f32 v148, v148, v50
v_mfma_f32_16x16x32_bf16 v[132:135], a[180:183], a[92:95], v[132:135]
v_mul_f32 v149, v149, v50
v_mul_f32 v150, v150, v50
v_mul_f32 v151, v151, v50
v_mfma_f32_16x16x32_bf16 v[136:139], a[168:171], a[88:91], v[136:139]
buffer_load_dwordx4 a[28:31], v9, s[36:39], s76 offen offset:0 sc1
v_mfma_f32_16x16x32_bf16 v[136:139], a[184:187], a[92:95], v[136:139]
v_mul_f32 v152, v152, v50
v_mul_f32 v153, v153, v50
v_mul_f32 v154, v154, v50
v_mfma_f32_16x16x32_bf16 v[140:143], a[172:175], a[88:91], v[140:143]
v_mul_f32 v155, v155, v50
v_mul_f32 v156, v156, v50
v_mul_f32 v157, v157, v50
v_mfma_f32_16x16x32_bf16 v[140:143], a[188:191], a[92:95], v[140:143]
v_mul_f32 v158, v158, v50
v_mul_f32 v159, v159, v50
s_waitcnt vmcnt(10)
v_mfma_f32_16x16x32_bf16 v[144:147], a[160:163], a[96:99], v[144:147]
buffer_load_dwordx4 a[32:35], v9, s[36:39], s78 offen offset:0 sc1
v_mfma_f32_16x16x32_bf16 v[144:147], a[176:179], a[100:103], v[144:147]
ds_read_b32 v192, v7
v_mfma_f32_16x16x32_bf16 v[148:151], a[164:167], a[96:99], v[148:151]
v_mfma_f32_16x16x32_bf16 v[148:151], a[180:183], a[100:103], v[148:151]
v_mfma_f32_16x16x32_bf16 v[152:155], a[168:171], a[96:99], v[152:155]
buffer_load_dwordx4 a[36:39], v9, s[36:39], s76 offen offset:1024 sc1
v_mfma_f32_16x16x32_bf16 v[152:155], a[184:187], a[100:103], v[152:155]
v_mfma_f32_16x16x32_bf16 v[156:159], a[172:175], a[96:99], v[156:159]
v_mfma_f32_16x16x32_bf16 v[156:159], a[188:191], a[100:103], v[156:159]
s_waitcnt vmcnt(10)
v_mfma_f32_16x16x32_bf16 v[128:131], a[192:195], a[104:107], v[128:131]
buffer_load_dwordx4 a[40:43], v9, s[36:39], s78 offen offset:1024 sc1
v_mfma_f32_16x16x32_bf16 v[128:131], a[208:211], a[108:111], v[128:131]
s_waitcnt lgkmcnt(0)
v_mfma_f32_16x16x32_bf16 v[132:135], a[196:199], a[104:107], v[132:135]
H_c0:
v_cmp_gt_u32 vcc, 1, v192
s_nop 1
s_cmp_eq_u64 vcc, 0
s_cbranch_scc1 H_c0_ok
ds_read_b32 v192, v7
s_waitcnt lgkmcnt(0)
s_branch H_c0
H_c0_ok:
v_mfma_f32_16x16x32_bf16 v[132:135], a[212:215], a[108:111], v[132:135]
ds_read_b128 v[64:67], v17 offset:0
ds_read_b128 v[68:71], v17 offset:256
v_mfma_f32_16x16x32_bf16 v[136:139], a[200:203], a[104:107], v[136:139]
buffer_load_dwordx4 a[44:47], v9, s[36:39], s79 offen offset:0 sc1
v_mfma_f32_16x16x32_bf16 v[136:139], a[216:219], a[108:111], v[136:139]
ds_read_b128 v[72:75], v17 offset:2048
ds_read_b128 v[76:79], v17 offset:2304
v_mfma_f32_16x16x32_bf16 v[140:143], a[204:207], a[104:107], v[140:143]
ds_read_b128 v[80:83], v17 offset:4096
ds_read_b128 v[84:87], v17 offset:4352
v_mfma_f32_16x16x32_bf16 v[140:143], a[220:223], a[108:111], v[140:143]
ds_read_b128 v[88:91], v17 offset:6144
ds_read_b128 v[92:95], v17 offset:6400
s_waitcnt vmcnt(10)
v_mfma_f32_16x16x32_bf16 v[128:131], a[224:227], a[0:3], v[128:131]
buffer_load_dwordx4 a[48:51], v9, s[36:39], s80 offen offset:0 sc1
v_mfma_f32_16x16x32_bf16 v[128:131], a[240:243], a[4:7], v[128:131]
v_mfma_f32_16x16x32_bf16 v[132:135], a[228:231], a[0:3], v[132:135]
v_mfma_f32_16x16x32_bf16 v[132:135], a[244:247], a[4:7], v[132:135]
v_mfma_f32_16x16x32_bf16 v[136:139], a[232:235], a[0:3], v[136:139]
buffer_load_dwordx4 a[52:55], v9, s[36:39], s81 offen offset:0 sc1
v_mfma_f32_16x16x32_bf16 v[136:139], a[248:251], a[4:7], v[136:139]
s_waitcnt lgkmcnt(0)
v_add_f32 v64, v64, v72
v_mfma_f32_16x16x32_bf16 v[140:143], a[236:239], a[0:3], v[140:143]
v_add_f32 v65, v65, v73
v_add_f32 v66, v66, v74
v_add_f32 v67, v67, v75
v_mfma_f32_16x16x32_bf16 v[140:143], a[252:255], a[4:7], v[140:143]
v_add_f32 v68, v68, v76
v_add_f32 v69, v69, v77
v_add_f32 v70, v70, v78
s_waitcnt vmcnt(10)
v_mfma_f32_16x16x32_bf16 v[128:131], a[112:115], a[8:11], v[128:131]
buffer_load_dwordx4 a[56:59], v9, s[36:39], s18 offen offset:0 sc1
v_mfma_f32_16x16x32_bf16 v[132:135], a[116:119], a[8:11], v[132:135]
v_add_f32 v54, 1.0, v54
v_mfma_f32_16x16x32_bf16 v[136:139], a[120:123], a[8:11], v[136:139]
v_add_f32 v55, 1.0, v55
v_rcp_f32 v54, v54
v_mfma_f32_16x16x32_bf16 v[140:143], a[124:127], a[8:11], v[140:143]
v_rcp_f32 v55, v55
v_add_f32 v71, v71, v79
v_mfma_f32_16x16x32_bf16 v[96:99], a[128:131], a[12:15], 0
buffer_load_dwordx4 a[60:63], v9, s[36:39], s19 offen offset:0 sc1
v_mfma_f32_16x16x32_bf16 v[100:103], a[132:135], a[12:15], 0
v_add_f32 v80, v80, v88
v_add_f32 v81, v81, v89
v_mfma_f32_16x16x32_bf16 v[104:107], a[136:139], a[12:15], 0
v_add_f32 v82, v82, v90
v_add_f32 v83, v83, v91
v_add_f32 v84, v84, v92
v_mfma_f32_16x16x32_bf16 v[108:111], a[140:143], a[12:15], 0
v_add_f32 v85, v85, v93
v_add_f32 v86, v86, v94
v_add_f32 v87, v87, v95
s_waitcnt vmcnt(10)
v_mfma_f32_16x16x32_bf16 v[96:99], a[144:147], a[16:19], v[96:99]
buffer_load_dwordx4 a[64:67], v9, s[36:39], s79 offen offset:1024 sc1
v_mfma_f32_16x16x32_bf16 v[100:103], a[148:151], a[16:19], v[100:103]
v_add_f32 v64, v64, v80
v_add_f32 v65, v65, v81
v_mfma_f32_16x16x32_bf16 v[104:107], a[152:155], a[16:19], v[104:107]
v_add_f32 v66, v66, v82
v_add_f32 v67, v67, v83
v_add_f32 v68, v68, v84
v_mfma_f32_16x16x32_bf16 v[108:111], a[156:159], a[16:19], v[108:111]
v_add_f32 v69, v69, v85
v_add_f32 v70, v70, v86
v_add_f32 v71, v71, v87
v_mfma_f32_16x16x32_bf16 v[112:115], a[128:131], a[20:23], 0
buffer_load_dwordx4 a[68:71], v9, s[36:39], s80 offen offset:1024 sc1
v_mfma_f32_16x16x32_bf16 v[116:119], a[132:135], a[20:23], 0
v_mul_f32 v96, v96, v45
v_mul_f32 v97, v97, v45
v_mfma_f32_16x16x32_bf16 v[120:123], a[136:139], a[20:23], 0
v_mul_f32 v98, v98, v45
v_mul_f32 v99, v99, v45
v_mul_f32 v100, v100, v45
v_mfma_f32_16x16x32_bf16 v[124:127], a[140:143], a[20:23], 0
v_mul_f32 v101, v101, v45
v_mul_f32 v102, v102, v45
v_mul_f32 v103, v103, v45
s_waitcnt vmcnt(10)
v_mfma_f32_16x16x32_bf16 v[112:115], a[144:147], a[24:27], v[112:115]
buffer_load_dwordx4 a[72:75], v9, s[36:39], s81 offen offset:1024 sc1
v_mfma_f32_16x16x32_bf16 v[116:119], a[148:151], a[24:27], v[116:119]
v_mul_f32 v104, v104, v45
v_mul_f32 v105, v105, v45
v_mul_f32 v106, v106, v45
v_mfma_f32_16x16x32_bf16 v[120:123], a[152:155], a[24:27], v[120:123]
v_mul_f32 v107, v107, v45
v_mul_f32 v108, v108, v45
v_mul_f32 v109, v109, v45
v_mfma_f32_16x16x32_bf16 v[124:127], a[156:159], a[24:27], v[124:127]
v_mul_f32 v110, v110, v45
v_mul_f32 v111, v111, v45
v_mfma_f32_16x16x32_bf16 v[96:99], a[160:163], a[28:31], v[96:99]
buffer_load_dwordx4 a[76:79], v9, s[36:39], s18 offen offset:1024 sc1
v_mfma_f32_16x16x32_bf16 v[100:103], a[164:167], a[28:31], v[100:103]
v_mul_f32 v112, v112, v47
v_mul_f32 v113, v113, v47
v_mfma_f32_16x16x32_bf16 v[104:107], a[168:171], a[28:31], v[104:107]
v_mul_f32 v114, v114, v47
v_mul_f32 v115, v115, v47
v_mul_f32 v116, v116, v47
v_mfma_f32_16x16x32_bf16 v[108:111], a[172:175], a[28:31], v[108:111]
v_mul_f32 v117, v117, v47
v_mul_f32 v118, v118, v47
v_mul_f32 v119, v119, v47
s_waitcnt vmcnt(10)
v_mfma_f32_16x16x32_bf16 v[96:99], a[176:179], a[32:35], v[96:99]
buffer_load_dwordx4 a[80:83], v9, s[36:39], s19 offen offset:1024 sc1
v_mfma_f32_16x16x32_bf16 v[100:103], a[180:183], a[32:35], v[100:103]
v_mul_f32 v120, v120, v47
v_mul_f32 v121, v121, v47
v_mul_f32 v122, v122, v47
v_mfma_f32_16x16x32_bf16 v[104:107], a[184:187], a[32:35], v[104:107]
v_mul_f32 v123, v123, v47
v_mul_f32 v124, v124, v47
v_mul_f32 v125, v125, v47
v_mfma_f32_16x16x32_bf16 v[108:111], a[188:191], a[32:35], v[108:111]
v_mul_f32 v126, v126, v47
v_mul_f32 v127, v127, v47
v_mfma_f32_16x16x32_bf16 v[112:115], a[160:163], a[36:39], v[112:115]
buffer_load_dwordx4 a[84:87], v10, s[36:39], s79 offen offset:1024 sc1
v_mfma_f32_16x16x32_bf16 v[116:119], a[164:167], a[36:39], v[116:119]
v_cvt_pk_bf16_f32 v64, v64, v65
v_cvt_pk_bf16_f32 v65, v66, v67
v_mfma_f32_16x16x32_bf16 v[120:123], a[168:171], a[36:39], v[120:123]
v_cvt_pk_bf16_f32 v66, v68, v69
v_cvt_pk_bf16_f32 v67, v70, v71
v_mfma_f32_16x16x32_bf16 v[124:127], a[172:175], a[36:39], v[124:127]
buffer_store_dwordx4 v[64:67], v15, s[20:23], 0 offen offset:0 sc1
ds_write_b128 v3, v[128:131] offset:0
s_waitcnt vmcnt(11)
v_mfma_f32_16x16x32_bf16 v[112:115], a[176:179], a[40:43], v[112:115]
buffer_load_dwordx4 a[88:91], v10, s[36:39], s80 offen offset:1024 sc1
v_mfma_f32_16x16x32_bf16 v[116:119], a[180:183], a[40:43], v[116:119]
ds_write_b128 v4, v[132:135] offset:1024
v_mfma_f32_16x16x32_bf16 v[120:123], a[184:187], a[40:43], v[120:123]
ds_write_b128 v5, v[136:139] offset:8192
v_mfma_f32_16x16x32_bf16 v[124:127], a[188:191], a[40:43], v[124:127]
ds_write_b128 v6, v[140:143] offset:9216
v_mfma_f32_16x16x32_bf16 v[96:99], a[192:195], a[44:47], v[96:99]
buffer_load_dwordx4 a[92:95], v10, s[36:39], s81 offen offset:1024 sc1
v_mfma_f32_16x16x32_bf16 v[100:103], a[196:199], a[44:47], v[100:103]
v_mfma_f32_16x16x32_bf16 v[104:107], a[200:203], a[44:47], v[104:107]
v_mfma_f32_16x16x32_bf16 v[108:111], a[204:207], a[44:47], v[108:111]
s_waitcnt vmcnt(11)
v_mfma_f32_16x16x32_bf16 v[96:99], a[208:211], a[48:51], v[96:99]
buffer_load_dwordx4 a[96:99], v10, s[36:39], s18 offen offset:1024 sc1
v_mfma_f32_16x16x32_bf16 v[96:99], a[224:227], a[52:55], v[96:99]
v_mfma_f32_16x16x32_bf16 v[100:103], a[212:215], a[48:51], v[100:103]
v_mfma_f32_16x16x32_bf16 v[100:103], a[228:231], a[52:55], v[100:103]
v_mfma_f32_16x16x32_bf16 v[104:107], a[216:219], a[48:51], v[104:107]
buffer_load_dwordx4 a[100:103], v10, s[36:39], s19 offen offset:1024 sc1
v_mfma_f32_16x16x32_bf16 v[104:107], a[232:235], a[52:55], v[104:107]
v_mfma_f32_16x16x32_bf16 v[108:111], a[220:223], a[48:51], v[108:111]
v_mfma_f32_16x16x32_bf16 v[108:111], a[236:239], a[52:55], v[108:111]
s_waitcnt vmcnt(11)
v_mfma_f32_16x16x32_bf16 v[96:99], a[240:243], a[56:59], v[96:99]
buffer_load_dwordx4 a[104:107], v11, s[36:39], s74 offen offset:0 sc1
v_mfma_f32_16x16x32_bf16 v[96:99], a[112:115], a[60:63], v[96:99]
v_mfma_f32_16x16x32_bf16 v[100:103], a[244:247], a[56:59], v[100:103]
v_mfma_f32_16x16x32_bf16 v[100:103], a[116:119], a[60:63], v[100:103]
v_mfma_f32_16x16x32_bf16 v[104:107], a[248:251], a[56:59], v[104:107]
buffer_load_dwordx4 a[108:111], v11, s[36:39], s75 offen offset:0 sc1
v_mfma_f32_16x16x32_bf16 v[104:107], a[120:123], a[60:63], v[104:107]
v_mfma_f32_16x16x32_bf16 v[108:111], a[252:255], a[56:59], v[108:111]
v_mfma_f32_16x16x32_bf16 v[108:111], a[124:127], a[60:63], v[108:111]
s_waitcnt vmcnt(11)
v_mfma_f32_16x16x32_bf16 v[112:115], a[192:195], a[64:67], v[112:115]
buffer_load_dwordx4 a[0:3], v11, s[36:39], s74 offen offset:1024 sc1
v_mfma_f32_16x16x32_bf16 v[112:115], a[208:211], a[68:71], v[112:115]
v_mfma_f32_16x16x32_bf16 v[116:119], a[196:199], a[64:67], v[116:119]
v_mfma_f32_16x16x32_bf16 v[116:119], a[212:215], a[68:71], v[116:119]
v_mfma_f32_16x16x32_bf16 v[120:123], a[200:203], a[64:67], v[120:123]
buffer_load_dwordx4 a[4:7], v11, s[36:39], s75 offen offset:1024 sc1
v_mfma_f32_16x16x32_bf16 v[120:123], a[216:219], a[68:71], v[120:123]
ds_write_b128 v18, v[96:99] offset:32768
v_mfma_f32_16x16x32_bf16 v[124:127], a[204:207], a[64:67], v[124:127]
ds_write_b128 v19, v[100:103] offset:33792
v_mfma_f32_16x16x32_bf16 v[124:127], a[220:223], a[68:71], v[124:127]
ds_write_b128 v20, v[104:107] offset:40960
ds_write_b128 v21, v[108:111] offset:41984
s_waitcnt vmcnt(11)
v_mfma_f32_16x16x32_bf16 v[112:115], a[224:227], a[72:75], v[112:115]
buffer_load_dwordx4 a[8:11], v11, s[36:39], s76 offen offset:0 sc1
v_mfma_f32_16x16x32_bf16 v[112:115], a[240:243], a[76:79], v[112:115]
v_mfma_f32_16x16x32_bf16 v[116:119], a[228:231], a[72:75], v[116:119]
v_mfma_f32_16x16x32_bf16 v[116:119], a[244:247], a[76:79], v[116:119]
v_mfma_f32_16x16x32_bf16 v[120:123], a[232:235], a[72:75], v[120:123]
buffer_load_dwordx4 a[12:15], v11, s[36:39], s78 offen offset:0 sc1
v_mfma_f32_16x16x32_bf16 v[120:123], a[248:251], a[76:79], v[120:123]
v_mfma_f32_16x16x32_bf16 v[124:127], a[236:239], a[72:75], v[124:127]
v_mfma_f32_16x16x32_bf16 v[124:127], a[252:255], a[76:79], v[124:127]
s_waitcnt vmcnt(11)
v_mfma_f32_16x16x32_bf16 v[112:115], a[112:115], a[80:83], v[112:115]
buffer_load_dwordx4 a[16:19], v11, s[36:39], s76 offen offset:1024 sc1
v_mfma_f32_16x16x32_bf16 v[116:119], a[116:119], a[80:83], v[116:119]
v_mfma_f32_16x16x32_bf16 v[120:123], a[120:123], a[80:83], v[120:123]
v_mfma_f32_16x16x32_bf16 v[124:127], a[124:127], a[80:83], v[124:127]
v_mfma_f32_16x16x32_bf16 v[144:147], a[192:195], a[84:87], v[144:147]
buffer_load_dwordx4 a[20:23], v11, s[36:39], s78 offen offset:1024 sc1
H_T4:
s_cbranch_execz H_Tret
v_mfma_f32_16x16x32_bf16 v[148:151], a[196:199], a[84:87], v[148:151]
s_nop 0
ds_write_b128 v18, v[112:115] offset:49152
v_mfma_f32_16x16x32_bf16 v[152:155], a[200:203], a[84:87], v[152:155]
ds_write_b128 v19, v[116:119] offset:50176
ds_write_b128 v20, v[120:123] offset:57344
v_mfma_f32_16x16x32_bf16 v[156:159], a[204:207], a[84:87], v[156:159]
ds_write_b128 v21, v[124:127] offset:58368
v_mov_b32 v193, 2
ds_write_b32 v12, v193
s_waitcnt vmcnt(10)
v_mfma_f32_16x16x32_bf16 v[144:147], a[208:211], a[88:91], v[144:147]
buffer_load_dwordx4 a[24:27], v11, s[36:39], s79 offen offset:0 sc1
v_mfma_f32_16x16x32_bf16 v[144:147], a[224:227], a[92:95], v[144:147]
v_mfma_f32_16x16x32_bf16 v[148:151], a[212:215], a[88:91], v[148:151]
v_mfma_f32_16x16x32_bf16 v[148:151], a[228:231], a[92:95], v[148:151]
v_mfma_f32_16x16x32_bf16 v[152:155], a[216:219], a[88:91], v[152:155]
buffer_load_dwordx4 a[28:31], v11, s[36:39], s80 offen offset:0 sc1
v_mfma_f32_16x16x32_bf16 v[152:155], a[232:235], a[92:95], v[152:155]
ds_read_b32 v193, v7
v_mfma_f32_16x16x32_bf16 v[156:159], a[220:223], a[88:91], v[156:159]
v_mfma_f32_16x16x32_bf16 v[156:159], a[236:239], a[92:95], v[156:159]
s_waitcnt vmcnt(10)
v_mfma_f32_16x16x32_bf16 v[144:147], a[240:243], a[96:99], v[144:147]
buffer_load_dwordx4 a[32:35], v11, s[36:39], s81 offen offset:0 sc1
buffer_load_dwordx4 v[232:235], v14, s[20:23], 0 offen offset:0 sc1
v_mfma_f32_16x16x32_bf16 v[144:147], a[112:115], a[100:103], v[144:147]
v_mfma_f32_16x16x32_bf16 v[148:151], a[244:247], a[96:99], v[148:151]
v_mfma_f32_16x16x32_bf16 v[148:151], a[116:119], a[100:103], v[148:151]
v_mfma_f32_16x16x32_bf16 v[152:155], a[248:251], a[96:99], v[152:155]
buffer_load_dwordx4 a[36:39], v11, s[36:39], s18 offen offset:0 sc1
v_mfma_f32_16x16x32_bf16 v[152:155], a[120:123], a[100:103], v[152:155]
s_waitcnt lgkmcnt(0)
v_mfma_f32_16x16x32_bf16 v[156:159], a[252:255], a[96:99], v[156:159]
H_c1:
v_cmp_gt_u32 vcc, 2, v193
s_nop 1
s_cmp_eq_u64 vcc, 0
s_cbranch_scc1 H_c1_ok
ds_read_b32 v193, v7
s_waitcnt lgkmcnt(0)
s_branch H_c1
H_c1_ok:
ds_read_b128 v[96:99], v17 offset:32768
v_mfma_f32_16x16x32_bf16 v[156:159], a[124:127], a[100:103], v[156:159]
ds_read_b128 v[100:103], v17 offset:33024
ds_read_b128 v[104:107], v17 offset:34816
ds_read_b128 v[108:111], v17 offset:35072
ds_read_b128 v[112:115], v17 offset:36864
ds_read_b128 v[116:119], v17 offset:37120
ds_read_b128 v[120:123], v17 offset:38912
ds_read_b128 v[124:127], v17 offset:39168
s_waitcnt vmcnt(11)
v_mfma_f32_16x16x32_bf16 v[160:163], a[128:131], a[104:107], 0
buffer_load_dwordx4 a[40:43], v11, s[36:39], s19 offen offset:0 sc1
v_mfma_f32_16x16x32_bf16 v[160:163], a[144:147], a[108:111], v[160:163]
ds_write_b128 v3, v[144:147] offset:16384
v_mfma_f32_16x16x32_bf16 v[164:167], a[132:135], a[104:107], 0
ds_write_b128 v4, v[148:151] offset:17408
ds_write_b128 v5, v[152:155] offset:24576
v_mfma_f32_16x16x32_bf16 v[164:167], a[148:151], a[108:111], v[164:167]
ds_write_b128 v6, v[156:159] offset:25600
v_mov_b32 v194, 3
ds_write_b32 v12, v194
v_mfma_f32_16x16x32_bf16 v[168:171], a[136:139], a[104:107], 0
buffer_load_dwordx4 a[44:47], v11, s[36:39], s79 offen offset:1024 sc1
v_mfma_f32_16x16x32_bf16 v[168:171], a[152:155], a[108:111], v[168:171]
s_waitcnt lgkmcnt(5)
v_add_f32 v96, v96, v104
v_add_f32 v97, v97, v105
v_add_f32 v98, v98, v106
v_add_f32 v99, v99, v107
v_mfma_f32_16x16x32_bf16 v[172:175], a[140:143], a[104:107], 0
v_add_f32 v100, v100, v108
v_add_f32 v101, v101, v109
v_add_f32 v102, v102, v110
v_add_f32 v103, v103, v111
v_add_f32 v112, v112, v120
v_mfma_f32_16x16x32_bf16 v[172:175], a[156:159], a[108:111], v[172:175]
v_add_f32 v113, v113, v121
v_add_f32 v114, v114, v122
v_add_f32 v115, v115, v123
v_add_f32 v116, v116, v124
v_add_f32 v117, v117, v125
v_add_f32 v118, v118, v126
s_waitcnt vmcnt(11)
v_mfma_f32_16x16x32_bf16 v[176:179], a[128:131], a[0:3], 0
buffer_load_dwordx4 a[48:51], v11, s[36:39], s80 offen offset:1024 sc1
v_mfma_f32_16x16x32_bf16 v[176:179], a[144:147], a[4:7], v[176:179]
v_mul_f32 v160, v160, v49
v_mul_f32 v161, v161, v49
v_add_f32 v119, v119, v127
v_add_f32 v96, v96, v112
v_add_f32 v97, v97, v113
v_add_f32 v98, v98, v114
v_add_f32 v99, v99, v115
v_mfma_f32_16x16x32_bf16 v[180:183], a[132:135], a[0:3], 0
v_mul_f32 v162, v162, v49
v_mul_f32 v163, v163, v49
v_mul_f32 v164, v164, v49
v_add_f32 v100, v100, v116
v_add_f32 v101, v101, v117
v_add_f32 v102, v102, v118
v_add_f32 v103, v103, v119
v_cvt_pk_bf16_f32 v96, v96, v97
v_mfma_f32_16x16x32_bf16 v[180:183], a[148:151], a[4:7], v[180:183]
v_mul_f32 v165, v165, v49
v_mul_f32 v166, v166, v49
v_mul_f32 v167, v167, v49
v_cvt_pk_bf16_f32 v97, v98, v99
v_cvt_pk_bf16_f32 v98, v100, v101
v_cvt_pk_bf16_f32 v99, v102, v103
buffer_store_dwordx4 v[96:99], v15, s[20:23], 0 offen offset:1024 sc1
v_mfma_f32_16x16x32_bf16 v[184:187], a[136:139], a[0:3], 0
buffer_load_dwordx4 a[52:55], v11, s[36:39], s81 offen offset:1024 sc1
v_mfma_f32_16x16x32_bf16 v[184:187], a[152:155], a[4:7], v[184:187]
v_mul_f32 v168, v168, v49
v_mul_f32 v169, v169, v49
v_mul_f32 v170, v170, v49
ds_read_b32 v194, v7
v_mfma_f32_16x16x32_bf16 v[188:191], a[140:143], a[0:3], 0
v_mul_f32 v171, v171, v49
v_mul_f32 v172, v172, v49
v_mul_f32 v173, v173, v49
v_mfma_f32_16x16x32_bf16 v[188:191], a[156:159], a[4:7], v[188:191]
v_mul_f32 v174, v174, v49
v_mul_f32 v175, v175, v49
s_waitcnt vmcnt(12)
v_mfma_f32_16x16x32_bf16 v[160:163], a[160:163], a[8:11], v[160:163]
buffer_load_dwordx4 a[56:59], v11, s[36:39], s18 offen offset:1024 sc1
v_mfma_f32_16x16x32_bf16 v[160:163], a[176:179], a[12:15], v[160:163]
v_mul_f32 v176, v176, v51
v_mul_f32 v177, v177, v51
v_mfma_f32_16x16x32_bf16 v[164:167], a[164:167], a[8:11], v[164:167]
v_mul_f32 v178, v178, v51
v_mul_f32 v179, v179, v51
v_mul_f32 v180, v180, v51
v_mfma_f32_16x16x32_bf16 v[164:167], a[180:183], a[12:15], v[164:167]
v_mul_f32 v181, v181, v51
v_mul_f32 v182, v182, v51
v_mul_f32 v183, v183, v51
v_mfma_f32_16x16x32_bf16 v[168:171], a[168:171], a[8:11], v[168:171]
buffer_load_dwordx4 a[60:63], v11, s[36:39], s19 offen offset:1024 sc1
v_mfma_f32_16x16x32_bf16 v[168:171], a[184:187], a[12:15], v[168:171]
v_mul_f32 v184, v184, v51
v_mul_f32 v185, v185, v51
v_mul_f32 v186, v186, v51
s_waitcnt lgkmcnt(0)
v_mfma_f32_16x16x32_bf16 v[172:175], a[172:175], a[8:11], v[172:175]
v_mul_f32 v187, v187, v51
v_mul_f32 v188, v188, v51
v_mul_f32 v189, v189, v51
H_c2:
v_cmp_gt_u32 vcc, 3, v194
s_nop 1
s_cmp_eq_u64 vcc, 0
s_cbranch_scc1 H_c2_ok
ds_read_b32 v194, v7
s_waitcnt lgkmcnt(0)
s_branch H_c2
H_c2_ok:
ds_read_b128 v[128:131], v2 offset:0
v_mfma_f32_16x16x32_bf16 v[172:175], a[188:191], a[12:15], v[172:175]
v_mul_f32 v190, v190, v51
v_mul_f32 v191, v191, v51
ds_read_b128 v[132:135], v2 offset:256
ds_read_b128 v[136:139], v2 offset:2048
ds_read_b128 v[140:143], v2 offset:2304
ds_read_b128 v[144:147], v2 offset:4096
ds_read_b128 v[148:151], v2 offset:4352
ds_read_b128 v[152:155], v2 offset:6144
ds_read_b128 v[156:159], v2 offset:6400
s_waitcnt vmcnt(12)
v_mfma_f32_16x16x32_bf16 v[176:179], a[160:163], a[16:19], v[176:179]
v_mfma_f32_16x16x32_bf16 v[176:179], a[176:179], a[20:23], v[176:179]
v_mfma_f32_16x16x32_bf16 v[180:183], a[164:167], a[16:19], v[180:183]
v_mfma_f32_16x16x32_bf16 v[180:183], a[180:183], a[20:23], v[180:183]
v_mfma_f32_16x16x32_bf16 v[184:187], a[168:171], a[16:19], v[184:187]
s_waitcnt lgkmcnt(0)
v_add_f32 v128, v128, v136
v_mfma_f32_16x16x32_bf16 v[184:187], a[184:187], a[20:23], v[184:187]
v_add_f32 v129, v129, v137
v_add_f32 v130, v130, v138
v_mfma_f32_16x16x32_bf16 v[188:191], a[172:175], a[16:19], v[188:191]
v_add_f32 v131, v131, v139
v_add_f32 v132, v132, v140
v_add_f32 v133, v133, v141
v_mfma_f32_16x16x32_bf16 v[188:191], a[188:191], a[20:23], v[188:191]
v_add_f32 v134, v134, v142
v_add_f32 v135, v135, v143
v_add_f32 v144, v144, v152
s_waitcnt vmcnt(10)
v_mfma_f32_16x16x32_bf16 v[160:163], a[192:195], a[24:27], v[160:163]
v_add_f32 v145, v145, v153
v_add_f32 v146, v146, v154
v_mfma_f32_16x16x32_bf16 v[160:163], a[208:211], a[28:31], v[160:163]
v_add_f32 v147, v147, v155
v_add_f32 v148, v148, v156
v_mfma_f32_16x16x32_bf16 v[164:167], a[196:199], a[24:27], v[164:167]
v_add_f32 v149, v149, v157
v_add_f32 v150, v150, v158
v_add_f32 v151, v151, v159
v_mfma_f32_16x16x32_bf16 v[164:167], a[212:215], a[28:31], v[164:167]
v_add_f32 v128, v128, v144
v_add_f32 v129, v129, v145
v_add_f32 v130, v130, v146
v_mfma_f32_16x16x32_bf16 v[168:171], a[200:203], a[24:27], v[168:171]
v_add_f32 v131, v131, v147
v_add_f32 v132, v132, v148
v_mfma_f32_16x16x32_bf16 v[168:171], a[216:219], a[28:31], v[168:171]
v_add_f32 v133, v133, v149
v_add_f32 v134, v134, v150
v_mfma_f32_16x16x32_bf16 v[172:175], a[204:207], a[24:27], v[172:175]
v_add_f32 v135, v135, v151
s_waitcnt vmcnt(8)
v_mfma_f32_16x16x32_bf16 v[172:175], a[220:223], a[28:31], v[172:175]
s_waitcnt vmcnt(7)
v_mfma_f32_16x16x32_bf16 v[160:163], a[224:227], a[32:35], v[160:163]
s_mov_b32 s4, 0
H_r0:
v_max3_u32 v22, v232, v233, v234
v_max_u32 v22, v22, v235
v_cmp_eq_u32 vcc, -1, v22
s_nop 1
s_cmp_eq_u64 vcc, 0
s_cbranch_scc1 H_r0_ok
buffer_load_dwordx4 v[232:235], v14, s[20:23], 0 offen offset:0 sc1
s_add_u32 s4, s4, 1
s_waitcnt vmcnt(0)
s_cmp_lt_u32 s4, 0x2000
s_cbranch_scc1 H_r0
H_r0_ok:
v_mfma_f32_16x16x32_bf16 v[160:163], a[240:243], a[36:39], v[160:163]
v_lshlrev_b32 v224, 16, v232
v_and_b32 v225, 0xffff0000, v232
v_mfma_f32_16x16x32_bf16 v[164:167], a[228:231], a[32:35], v[164:167]
v_lshlrev_b32 v226, 16, v233
v_and_b32 v227, 0xffff0000, v233
v_mfma_f32_16x16x32_bf16 v[164:167], a[244:247], a[36:39], v[164:167]
v_lshlrev_b32 v228, 16, v234
v_mfma_f32_16x16x32_bf16 v[168:171], a[232:235], a[32:35], v[168:171]
v_and_b32 v229, 0xffff0000, v234
v_lshlrev_b32 v230, 16, v235
v_mfma_f32_16x16x32_bf16 v[168:171], a[248:251], a[36:39], v[168:171]
v_and_b32 v231, 0xffff0000, v235
v_add_f32 v128, v128, v224
v_mfma_f32_16x16x32_bf16 v[172:175], a[236:239], a[32:35], v[172:175]
v_add_f32 v129, v129, v225
v_add_f32 v130, v130, v226
v_add_f32 v131, v131, v227
v_mfma_f32_16x16x32_bf16 v[172:175], a[252:255], a[36:39], v[172:175]
v_add_f32 v132, v132, v228
v_add_f32 v133, v133, v229
v_add_f32 v134, v134, v230
s_waitcnt vmcnt(5)
v_mfma_f32_16x16x32_bf16 v[160:163], a[112:115], a[40:43], v[160:163]
v_add_f32 v135, v135, v231
v_mul_f32 v128, v128, v54
v_mfma_f32_16x16x32_bf16 v[164:167], a[116:119], a[40:43], v[164:167]
v_mul_f32 v129, v129, v54
v_mul_f32 v130, v130, v54
v_mfma_f32_16x16x32_bf16 v[168:171], a[120:123], a[40:43], v[168:171]
v_mul_f32 v131, v131, v54
v_mul_f32 v132, v132, v54
v_mul_f32 v133, v133, v54
v_mfma_f32_16x16x32_bf16 v[172:175], a[124:127], a[40:43], v[172:175]
v_mul_f32 v134, v134, v54
v_mul_f32 v135, v135, v54
v_cvt_pk_bf16_f32 v128, v128, v129
v_mfma_f32_16x16x32_bf16 v[176:179], a[192:195], a[44:47], v[176:179]
buffer_load_dwordx4 v[248:251], v14, s[20:23], 0 offen offset:1024 sc1
v_mfma_f32_16x16x32_bf16 v[180:183], a[196:199], a[44:47], v[180:183]
v_cvt_pk_bf16_f32 v129, v130, v131
v_cvt_pk_bf16_f32 v130, v132, v133
v_mfma_f32_16x16x32_bf16 v[184:187], a[200:203], a[44:47], v[184:187]
v_cvt_pk_bf16_f32 v131, v134, v135
v_mfma_f32_16x16x32_bf16 v[188:191], a[204:207], a[44:47], v[188:191]
buffer_store_dwordx4 v[128:131], v13, s[52:55], 0 offen offset:0 sc1
s_waitcnt vmcnt(4)
v_mfma_f32_16x16x32_bf16 v[176:179], a[208:211], a[48:51], v[176:179]
ds_write_b128 v3, v[160:163] offset:32768
v_mfma_f32_16x16x32_bf16 v[176:179], a[224:227], a[52:55], v[176:179]
ds_write_b128 v4, v[164:167] offset:33792
v_mfma_f32_16x16x32_bf16 v[180:183], a[212:215], a[48:51], v[180:183]
ds_write_b128 v5, v[168:171] offset:40960
v_mfma_f32_16x16x32_bf16 v[180:183], a[228:231], a[52:55], v[180:183]
ds_write_b128 v6, v[172:175] offset:41984
v_mfma_f32_16x16x32_bf16 v[184:187], a[216:219], a[48:51], v[184:187]
v_mfma_f32_16x16x32_bf16 v[184:187], a[232:235], a[52:55], v[184:187]
v_mfma_f32_16x16x32_bf16 v[188:191], a[220:223], a[48:51], v[188:191]
v_mfma_f32_16x16x32_bf16 v[188:191], a[236:239], a[52:55], v[188:191]
s_waitcnt vmcnt(2)
v_mfma_f32_16x16x32_bf16 v[176:179], a[240:243], a[56:59], v[176:179]
v_mfma_f32_16x16x32_bf16 v[176:179], a[112:115], a[60:63], v[176:179]
v_mfma_f32_16x16x32_bf16 v[180:183], a[244:247], a[56:59], v[180:183]
v_mfma_f32_16x16x32_bf16 v[180:183], a[116:119], a[60:63], v[180:183]
v_mfma_f32_16x16x32_bf16 v[184:187], a[248:251], a[56:59], v[184:187]
v_mfma_f32_16x16x32_bf16 v[184:187], a[120:123], a[60:63], v[184:187]
v_mfma_f32_16x16x32_bf16 v[188:191], a[252:255], a[56:59], v[188:191]
v_mfma_f32_16x16x32_bf16 v[188:191], a[124:127], a[60:63], v[188:191]
s_nop 1
ds_write_b128 v3, v[176:179] offset:49152
s_nop 0
ds_write_b128 v4, v[180:183] offset:50176
s_nop 0
ds_write_b128 v5, v[184:187] offset:57344
s_nop 0
ds_write_b128 v6, v[188:191] offset:58368
s_waitcnt lgkmcnt(0)
s_barrier
ds_read_b128 v[160:163], v2 offset:32768
ds_read_b128 v[164:167], v2 offset:33024
ds_read_b128 v[168:171], v2 offset:34816
ds_read_b128 v[172:175], v2 offset:35072
ds_read_b128 v[176:179], v2 offset:36864
ds_read_b128 v[180:183], v2 offset:37120
ds_read_b128 v[184:187], v2 offset:38912
ds_read_b128 v[188:191], v2 offset:39168
s_waitcnt vmcnt(1)
s_mov_b32 s4, 0
H_r1:
v_max3_u32 v22, v248, v249, v250
v_max_u32 v22, v22, v251
v_cmp_eq_u32 vcc, -1, v22
s_nop 1
s_cmp_eq_u64 vcc, 0
s_cbranch_scc1 H_r1_ok
buffer_load_dwordx4 v[248:251], v14, s[20:23], 0 offen offset:1024 sc1
s_add_u32 s4, s4, 1
s_waitcnt vmcnt(0)
s_cmp_lt_u32 s4, 0x2000
s_cbranch_scc1 H_r1
H_r1_ok:
v_lshlrev_b32 v240, 16, v248
v_and_b32 v241, 0xffff0000, v248
v_lshlrev_b32 v242, 16, v249
v_and_b32 v243, 0xffff0000, v249
v_lshlrev_b32 v244, 16, v250
v_and_b32 v245, 0xffff0000, v250
v_lshlrev_b32 v246, 16, v251
v_and_b32 v247, 0xffff0000, v251
s_waitcnt lgkmcnt(0)
v_pk_add_f32 v[160:161], v[160:161], v[168:169]
v_pk_add_f32 v[162:163], v[162:163], v[170:171]
v_pk_add_f32 v[164:165], v[164:165], v[172:173]
v_pk_add_f32 v[166:167], v[166:167], v[174:175]
v_pk_add_f32 v[176:177], v[176:177], v[184:185]
v_pk_add_f32 v[178:179], v[178:179], v[186:187]
v_pk_add_f32 v[180:181], v[180:181], v[188:189]
v_pk_add_f32 v[182:183], v[182:183], v[190:191]
v_pk_add_f32 v[160:161], v[160:161], v[176:177]
v_pk_add_f32 v[162:163], v[162:163], v[178:179]
v_pk_add_f32 v[164:165], v[164:165], v[180:181]
v_pk_add_f32 v[166:167], v[166:167], v[182:183]
v_pk_add_f32 v[160:161], v[160:161], v[240:241]
v_pk_add_f32 v[162:163], v[162:163], v[242:243]
v_pk_add_f32 v[164:165], v[164:165], v[244:245]
v_pk_add_f32 v[166:167], v[166:167], v[246:247]
v_pk_mul_f32 v[160:161], v[160:161], v[54:55] op_sel:[0,1] op_sel_hi:[1,1]
v_pk_mul_f32 v[162:163], v[162:163], v[54:55] op_sel:[0,1] op_sel_hi:[1,1]
v_pk_mul_f32 v[164:165], v[164:165], v[54:55] op_sel:[0,1] op_sel_hi:[1,1]
v_pk_mul_f32 v[166:167], v[166:167], v[54:55] op_sel:[0,1] op_sel_hi:[1,1]
v_cvt_pk_bf16_f32 v160, v160, v161
v_cvt_pk_bf16_f32 v161, v162, v163
v_cvt_pk_bf16_f32 v162, v164, v165
v_cvt_pk_bf16_f32 v163, v166, v167
buffer_store_dwordx4 v[160:163], v13, s[52:55], 0 offen offset:1024 sc1
s_endpgm
L_exit:
s_endpgm
.p2align 12
L_Q:
s_lshl_b32 s98, s96, 3
s_add_u32 s98, s98, s62
s_lshr_b32 s88, s63, 1
s_cmp_lg_u32 s88, 1
s_cbranch_scc1 Q_q3
s_lshl_b32 s88, s64, 2
s_add_u32 s88, s88, s60
s_mul_i32 s88, s88, 12288
v_min_u32 v59, 11, v1
v_lshl_add_u32 v59, v59, 10, s88
s_mov_b64 exec, 0xfff
global_load_dword v59, v59, s[6:7] offset:384
s_mov_b64 exec, -1
Q_q3:
v_and_b32 v40, 15, v1
v_lshrrev_b32 v41, 1, v40
v_xor_b32 v41, v41, v33
v_lshlrev_b32 v41, 4, v41
v_lshl_add_u32 v42, v40, 7, v41
s_lshr_b32 s88, s60, 1
s_lshl_b32 s89, s88, 11
s_add_u32 s89, s89, 4096
v_add_u32 v13, s89, v42
v_xor_b32 v14, 64, v13
s_lshl_b32 s89, s62, 2
s_add_u32 s89, s89, s60
s_add_u32 s89, s89, 2
s_cmp_lt_u32 s89, 14
s_cselect_b32 s89, s89, 1
s_lshl_b32 s89, s89, 11
v_add_u32 v19, s89, v42
v_xor_b32 v20, 64, v19
v_or_b32 v43, 8, v40
v_lshrrev_b32 v44, 1, v43
v_xor_b32 v44, v44, v33
v_lshlrev_b32 v44, 4, v44
v_lshl_add_u32 v44, v43, 7, v44
v_lshrrev_b32 v45, 3, v40
v_mul_u32_u24 v45, 12288, v45
v_add_u32 v44, v45, v44
v_add_u32 v44, 12288, v44
v_mov_b32 v45, v42
s_cmp_eq_u32 s88, 0
s_cselect_b64 vcc, -1, 0
v_cndmask_b32 v17, v44, v45, vcc
v_xor_b32 v18, 64, v17
v_lshrrev_b32 v42, 2, v40
v_lshl_add_u32 v43, v33, 3, v42
v_lshrrev_b32 v44, 1, v42
v_and_b32 v45, 1, v33
v_lshl_add_u32 v44, v45, 1, v44
s_and_b32 s88, s60, 1
s_lshl_b32 s88, s88, 1
v_xor_b32 v44, s88, v44
v_lshlrev_b32 v44, 5, v44
v_lshl_add_u32 v43, v43, 7, v44
v_and_b32 v45, 3, v1
v_lshl_add_u32 v15, v45, 3, v43
v_xor_b32 v16, 32, v15
v_lshlrev_b32 v45, 4, v33
v_add_u32 v21, 147456, v45
v_add_u32 v22, 0xc000, v13
v_add_u32 v23, 0xc000, v14
v_add_u32 v24, 0xc000, v17
v_add_u32 v25, 0xc000, v19
v_add_u32 v26, 0xc000, v18
v_add_u32 v27, 0xc000, v20
v_add_u32 v44, 0xc000, v15
v_add_u32 v45, 0xc000, v16
v_add_u32 v46, 0x18000, v15
v_add_u32 v47, 0x18000, v16
s_mov_b32 s36, s24
s_mov_b32 s37, s25
s_mov_b32 s38, 0x900000
s_mov_b32 s39, 0x20000
s_mov_b32 s44, s8
s_mov_b32 s45, s9
s_mov_b32 s46, 0x80000
s_mov_b32 s47, 0x20000
s_sub_u32 s48, s16, 524288
s_subb_u32 s49, s17, 0
s_mov_b32 s50, 0x240000
s_mov_b32 s51, 0x20000
s_mov_b32 s52, s20
s_mov_b32 s53, s21
s_mov_b32 s54, 0x200000
s_mov_b32 s55, 0x20000
s_mov_b32 s56, s22
s_mov_b32 s57, s23
s_mov_b32 s58, 0x100
s_mov_b32 s59, 0x20000
s_add_u32 s20, s24, 9453568
s_addc_u32 s21, s25, 0
s_mov_b32 s22, 0x208000
s_mov_b32 s23, 0x20000
s_mov_b32 s93, s64
s_cmp_eq_u32 s64, 11
s_cselect_b32 s93, 8, s93
s_cmp_eq_u32 s64, 8
s_cselect_b32 s93, 11, s93
s_cmp_eq_u32 s64, 19
s_cselect_b32 s93, 9, s93
s_cmp_eq_u32 s64, 9
s_cselect_b32 s93, 19, s93
s_cmp_eq_u32 s64, 27
s_cselect_b32 s93, 10, s93
s_cmp_eq_u32 s64, 10
s_cselect_b32 s93, 27, s93
s_lshr_b32 s88, s63, 1
s_and_b32 s89, s63, 1
s_lshl_b32 s72, s88, 3
s_lshr_b32 s90, s93, 3
s_lshl_b32 s90, s90, 1
s_add_u32 s72, s72, s90
s_add_u32 s72, s72, s89
s_and_b32 s90, s93, 0
s_xor_b32 s72, s72, s90
s_and_b32 s73, s93, 7
s_lshl_b32 s71, s60, 11
s_lshl_b32 s89, s89, 2
s_add_u32 s89, s89, s60
s_lshl_b32 s74, s89, 12
s_mov_b32 s90, s88
s_and_b32 s90, s90, 1
s_lshl_b32 s90, s90, 11
s_add_u32 s74, s74, s90
s_xor_b32 s75, s74, 0x800
s_mul_i32 s91, s89, 14336
s_add_u32 s91, s91, 32768
s_add_u32 s92, s91, 14336
s_mul_i32 s90, s88, 4096
s_add_u32 s76, s91, s90
s_add_u32 s78, s76, 2048
s_cmp_eq_u32 s78, s92
s_cselect_b32 s78, s91, s78
s_add_u32 s79, s78, 2048
s_cmp_eq_u32 s79, s92
s_cselect_b32 s79, s91, s79
s_add_u32 s80, s79, 2048
s_cmp_eq_u32 s80, s92
s_cselect_b32 s80, s91, s80
s_add_u32 s81, s80, 2048
s_cmp_eq_u32 s81, s92
s_cselect_b32 s81, s91, s81
s_add_u32 s18, s81, 2048
s_cmp_eq_u32 s18, s92
s_cselect_b32 s18, s91, s18
s_add_u32 s19, s18, 2048
s_cmp_eq_u32 s19, s92
s_cselect_b32 s19, s91, s19
s_add_u32 s66, s66, 98304
s_add_u32 m0, s68, 86016
s_nop 0
buffer_load_dwordx4 v9, s[32:35], s66 offen offset:0 lds
buffer_load_dwordx4 v10, s[32:35], s66 offen offset:1024 lds
buffer_load_dwordx4 v11, s[32:35], s66 offen offset:2048 lds
s_and_b32 s97, s70, 7
s_xor_b32 s97, s97, 1
s_mul_i32 s65, s97, 128
s_add_u32 m0, s67, 28672
s_nop 0
buffer_load_dwordx4 v2, s[28:31], s65 offen offset:0 lds
buffer_load_dwordx4 v3, s[28:31], s65 offen offset:1024 lds
buffer_load_dwordx4 v4, s[28:31], s65 offen offset:2048 lds
buffer_load_dwordx4 v5, s[28:31], s65 offen offset:3072 lds
s_add_u32 m0, s67, 32768
s_nop 0
buffer_load_dwordx4 v6, s[28:31], s65 offen offset:0 lds
buffer_load_dwordx4 v7, s[28:31], s65 offen offset:1024 lds
s_add_u32 m0, s69, 28672
s_nop 0
buffer_load_dwordx4 v8, s[28:31], s65 offen offset:0 lds
s_lshl_b32 s88, s62, 12
s_lshl_b32 s89, s62, 3
s_lshl_b32 s90, s60, 8
s_add_u32 s90, s90, s61
s_cmp_eq_u32 s90, 120
s_cselect_b32 s88, s88, 0x40000000
s_cselect_b32 s89, s89, 0x40000000
v_and_b32 v60, 31, v1
v_lshl_add_u32 v60, v60, 7, s88
v_lshl_add_u32 v62, v1, 24, s89
buffer_load_dword v60, v60, s[20:23], 0 offen sc1
s_mov_b64 exec, 0
s_cmp_eq_u32 s60, 0
s_cbranch_scc1 Q_T0
s_cmp_eq_u32 s60, 1
s_cbranch_scc1 Q_T1
s_cmp_eq_u32 s60, 2
s_cbranch_scc1 Q_T2
s_branch Q_T3
Q_Tret:
s_mov_b64 exec, -1
s_waitcnt vmcnt(11)
s_barrier
ds_read_b64_tr_b16 a[0:1], v44 offset:36864
ds_read_b64_tr_b16 a[2:3], v44 offset:37376
ds_read_b128 a[4:7], v13 offset:0
ds_read_b64_tr_b16 a[8:9], v44 offset:40960
ds_read_b64_tr_b16 a[10:11], v44 offset:41472
ds_read_b64_tr_b16 a[12:13], v44 offset:45056
ds_read_b64_tr_b16 a[14:15], v44 offset:45568
ds_read_b64_tr_b16 a[16:17], v45 offset:36864
ds_read_b64_tr_b16 a[18:19], v45 offset:37376
ds_read_b64_tr_b16 a[20:21], v45 offset:40960
ds_read_b64_tr_b16 a[22:23], v45 offset:41472
ds_read_b64_tr_b16 a[24:25], v45 offset:45056
ds_read_b64_tr_b16 a[26:27], v45 offset:45568
ds_read_b128 a[28:31], v13 offset:12288
ds_read_b128 a[32:35], v13 offset:4096
ds_read_b128 a[36:39], v13 offset:16384
ds_read_b128 a[40:43], v13 offset:8192
ds_read_b128 a[44:47], v13 offset:20480
ds_read_b128 a[48:51], v17 offset:0
ds_read_b128 a[52:55], v21 offset:0
ds_read_b128 a[56:59], v19 offset:0
s_waitcnt vmcnt(8)
s_barrier
s_waitcnt lgkmcnt(15)
v_mfma_f32_16x16x32_bf16 v[64:67], a[0:3], a[4:7], 0
s_and_b32 s97, s70, 7
s_xor_b32 s97, s97, 1
v_mfma_f32_16x16x32_bf16 v[88:91], a[8:11], a[4:7], 0
s_mul_i32 s66, s97, 196608
s_add_u32 m0, s68, 98304
s_waitcnt lgkmcnt(14)
v_mfma_f32_16x16x32_bf16 v[116:119], a[4:7], a[12:15], 0
buffer_load_dwordx4 v9, s[32:35], s66 offen offset:0 lds
s_waitcnt lgkmcnt(11)
v_mfma_f32_16x16x32_bf16 v[144:147], a[16:19], a[4:7], 0
ds_read_b64_tr_b16 a[60:61], v46 offset:0
v_lshrrev_b32 v12, 4, v1
s_waitcnt lgkmcnt(7)
v_mfma_f32_16x16x32_bf16 v[168:171], a[20:23], a[4:7], 0
ds_read_b64_tr_b16 a[62:63], v46 offset:512
v_lshlrev_b32 v12, 1, v12
v_mfma_f32_16x16x32_bf16 v[196:199], a[4:7], a[24:27], 0
ds_read_b128 a[64:67], v14 offset:0
v_mfma_f32_16x16x32_bf16 v[200:203], a[28:31], a[24:27], 0
buffer_load_dwordx4 v10, s[32:35], s66 offen offset:1024 lds
v_mfma_f32_16x16x32_bf16 v[172:175], a[20:23], a[28:31], 0
ds_read_b64_tr_b16 a[68:69], v46 offset:4096
v_mfma_f32_16x16x32_bf16 v[148:151], a[16:19], a[28:31], 0
ds_read_b64_tr_b16 a[70:71], v46 offset:4608
v_and_b32 v0, 7, v1
v_mfma_f32_16x16x32_bf16 v[120:123], a[28:31], a[12:15], 0
ds_read_b64_tr_b16 a[72:73], v46 offset:8192
v_mfma_f32_16x16x32_bf16 v[92:95], a[8:11], a[28:31], 0
ds_read_b64_tr_b16 a[74:75], v46 offset:8704
v_mfma_f32_16x16x32_bf16 v[68:71], a[0:3], a[28:31], 0
buffer_load_dwordx4 v11, s[32:35], s66 offen offset:2048 lds
v_mfma_f32_16x16x32_bf16 v[72:75], a[0:3], a[32:35], 0
s_add_u32 s66, s66, 98304
s_add_u32 m0, s68, 110592
v_mfma_f32_16x16x32_bf16 v[96:99], a[8:11], a[32:35], 0
ds_read_b64_tr_b16 a[76:77], v47 offset:0
v_xor_b32 v12, v12, v0
v_mfma_f32_16x16x32_bf16 v[124:127], a[32:35], a[12:15], 0
ds_read_b64_tr_b16 a[78:79], v47 offset:512
v_mfma_f32_16x16x32_bf16 v[152:155], a[16:19], a[32:35], 0
ds_read_b64_tr_b16 a[80:81], v47 offset:4096
v_mfma_f32_16x16x32_bf16 v[176:179], a[20:23], a[32:35], 0
buffer_load_dwordx4 v9, s[32:35], s66 offen offset:0 lds
v_mfma_f32_16x16x32_bf16 v[204:207], a[32:35], a[24:27], 0
ds_read_b64_tr_b16 a[82:83], v47 offset:4608
v_lshlrev_b32 v12, 4, v12
s_waitcnt lgkmcnt(4)
v_mfma_f32_16x16x32_bf16 v[208:211], a[36:39], a[24:27], 0
ds_read_b64_tr_b16 a[84:85], v47 offset:8192
v_mfma_f32_16x16x32_bf16 v[180:183], a[20:23], a[36:39], 0
ds_read_b64_tr_b16 a[86:87], v47 offset:8704
v_mfma_f32_16x16x32_bf16 v[156:159], a[16:19], a[36:39], 0
ds_read_b128 a[88:91], v14 offset:12288
v_lshrrev_b32 v0, 3, v1
v_mfma_f32_16x16x32_bf16 v[128:131], a[36:39], a[12:15], 0
buffer_load_dwordx4 v10, s[32:35], s66 offen offset:1024 lds
v_mfma_f32_16x16x32_bf16 v[100:103], a[8:11], a[36:39], 0
ds_read_b128 a[92:95], v14 offset:4096
v_mfma_f32_16x16x32_bf16 v[76:79], a[0:3], a[36:39], 0
ds_read_b128 a[96:99], v14 offset:16384
v_mfma_f32_16x16x32_bf16 v[80:83], a[0:3], a[40:43], 0
ds_read_b128 a[100:103], v14 offset:8192
v_lshl_add_u32 v12, v0, 10, v12
v_mfma_f32_16x16x32_bf16 v[104:107], a[8:11], a[40:43], 0
ds_read_b128 a[104:107], v14 offset:20480
v_mfma_f32_16x16x32_bf16 v[132:135], a[40:43], a[12:15], 0
buffer_load_dwordx4 v11, s[32:35], s66 offen offset:2048 lds
v_mfma_f32_16x16x32_bf16 v[160:163], a[16:19], a[40:43], 0
s_and_b32 s97, s70, 7
s_xor_b32 s97, s97, 2
v_mfma_f32_16x16x32_bf16 v[184:187], a[20:23], a[40:43], 0
s_mul_i32 s65, s97, 128
s_add_u32 m0, s67, 57344
v_mfma_f32_16x16x32_bf16 v[212:215], a[40:43], a[24:27], 0
ds_read_b128 a[108:111], v18 offset:0
s_lshl_b32 s4, s73, 7
v_mfma_f32_16x16x32_bf16 v[216:219], a[44:47], a[24:27], 0
ds_read_b128 a[112:115], v21 offset:64
v_mfma_f32_16x16x32_bf16 v[188:191], a[20:23], a[44:47], 0
buffer_load_dwordx4 v2, s[28:31], s65 offen offset:0 lds
v_mfma_f32_16x16x32_bf16 v[164:167], a[16:19], a[44:47], 0
ds_read_b128 a[116:119], v20 offset:0
v_add_u32 v12, s4, v12
v_mfma_f32_16x16x32_bf16 v[136:139], a[44:47], a[12:15], 0
v_mfma_f32_16x16x32_bf16 v[108:111], a[8:11], a[44:47], 0
v_mfma_f32_16x16x32_bf16 v[84:87], a[0:3], a[44:47], 0
v_mfma_f32_16x16x32_bf16 v[112:115], a[8:11], a[48:51], 0
buffer_load_dwordx4 v3, s[28:31], s65 offen offset:1024 lds
v_mfma_f32_16x16x32_bf16 v[140:143], a[48:51], a[12:15], 0
v_add_u32 v0, 7168, v12
v_mfma_f32_16x16x32_bf16 v[192:195], a[20:23], a[48:51], 0
v_mfma_f32_16x16x32_bf16 v[220:223], a[48:51], a[24:27], 0
v_mfma_f32_16x16x32_bf16 v[224:227], a[52:55], a[56:59], 0
s_waitcnt vmcnt(5) lgkmcnt(0)
s_barrier
v_mfma_f32_16x16x32_bf16 v[64:67], a[60:63], a[64:67], v[64:67]
buffer_load_dwordx4 v4, s[28:31], s65 offen offset:2048 lds
v_mfma_f32_16x16x32_bf16 v[88:91], a[68:71], a[64:67], v[88:91]
ds_read_b64_tr_b16 a[120:121], v46 offset:12288
v_lshrrev_b32 v33, 2, v1
v_mfma_f32_16x16x32_bf16 v[116:119], a[64:67], a[72:75], v[116:119]
ds_read_b64_tr_b16 a[122:123], v46 offset:12800
v_lshrrev_b32 v34, 3, v1
v_mfma_f32_16x16x32_bf16 v[144:147], a[76:79], a[64:67], v[144:147]
ds_read_b128 a[124:127], v13 offset:28672
v_mfma_f32_16x16x32_bf16 v[168:171], a[80:83], a[64:67], v[168:171]
ds_read_b64_tr_b16 a[192:193], v46 offset:16384
v_and_b32 v34, 3, v34
v_mfma_f32_16x16x32_bf16 v[196:199], a[64:67], a[84:87], v[196:199]
buffer_load_dwordx4 v5, s[28:31], s65 offen offset:3072 lds
v_mfma_f32_16x16x32_bf16 v[200:203], a[88:91], a[84:87], v[200:203]
s_add_u32 m0, s67, 61440
ds_read_b64_tr_b16 a[194:195], v46 offset:16896
v_mfma_f32_16x16x32_bf16 v[172:175], a[80:83], a[88:91], v[172:175]
ds_read_b64_tr_b16 a[196:197], v46 offset:20480
v_lshlrev_b32 v34, 5, v34
v_mfma_f32_16x16x32_bf16 v[148:151], a[76:79], a[88:91], v[148:151]
ds_read_b64_tr_b16 a[198:199], v46 offset:20992
v_lshl_add_u32 v33, v33, 7, v34
v_mfma_f32_16x16x32_bf16 v[120:123], a[88:91], a[72:75], v[120:123]
ds_read_b64_tr_b16 a[200:201], v47 offset:12288
v_mfma_f32_16x16x32_bf16 v[92:95], a[68:71], a[88:91], v[92:95]
buffer_load_dwordx4 v6, s[28:31], s65 offen offset:0 lds
v_mfma_f32_16x16x32_bf16 v[68:71], a[60:63], a[88:91], v[68:71]
ds_read_b64_tr_b16 a[202:203], v47 offset:12800
v_and_b32 v34, 3, v1
v_mfma_f32_16x16x32_bf16 v[72:75], a[60:63], a[92:95], v[72:75]
ds_read_b64_tr_b16 a[204:205], v47 offset:16384
v_lshl_add_u32 v33, v34, 3, v33
v_mfma_f32_16x16x32_bf16 v[96:99], a[68:71], a[92:95], v[96:99]
ds_read_b64_tr_b16 a[206:207], v47 offset:16896
v_mfma_f32_16x16x32_bf16 v[124:127], a[92:95], a[72:75], v[124:127]
ds_read_b64_tr_b16 a[208:209], v47 offset:20480
v_mfma_f32_16x16x32_bf16 v[152:155], a[76:79], a[92:95], v[152:155]
buffer_load_dwordx4 v7, s[28:31], s65 offen offset:1024 lds
v_mfma_f32_16x16x32_bf16 v[176:179], a[80:83], a[92:95], v[176:179]
s_add_u32 m0, s69, 57344
ds_read_b64_tr_b16 a[210:211], v47 offset:20992
v_mfma_f32_16x16x32_bf16 v[204:207], a[92:95], a[84:87], v[204:207]
ds_read_b128 a[212:215], v13 offset:40960
v_add_u32 v32, s71, v33
v_mfma_f32_16x16x32_bf16 v[208:211], a[96:99], a[84:87], v[208:211]
ds_read_b128 a[216:219], v13 offset:32768
v_xor_b32 v33, 32, v32
v_mfma_f32_16x16x32_bf16 v[180:183], a[80:83], a[96:99], v[180:183]
ds_read_b128 a[220:223], v13 offset:45056
v_xor_b32 v34, 64, v32
v_mfma_f32_16x16x32_bf16 v[156:159], a[76:79], a[96:99], v[156:159]
buffer_load_dwordx4 v8, s[28:31], s65 offen offset:0 lds
v_mfma_f32_16x16x32_bf16 v[128:131], a[96:99], a[72:75], v[128:131]
s_and_b32 s97, s70, 7
s_xor_b32 s97, s97, 2
v_mfma_f32_16x16x32_bf16 v[100:103], a[68:71], a[96:99], v[100:103]
s_mul_i32 s66, s97, 196608
s_add_u32 m0, s68, 122880
v_mfma_f32_16x16x32_bf16 v[76:79], a[60:63], a[96:99], v[76:79]
ds_read_b128 a[224:227], v13 offset:36864
v_xor_b32 v35, 96, v32
v_mfma_f32_16x16x32_bf16 v[80:83], a[60:63], a[100:103], v[80:83]
ds_read_b128 a[228:231], v22 offset:0
v_add_u32 v36, 0x10000, v32
v_mfma_f32_16x16x32_bf16 v[104:107], a[68:71], a[100:103], v[104:107]
buffer_load_dwordx4 v9, s[32:35], s66 offen offset:0 lds
v_mfma_f32_16x16x32_bf16 v[132:135], a[100:103], a[72:75], v[132:135]
ds_read_b128 a[232:235], v17 offset:28672
v_add_u32 v37, 0x20000, v32
v_mfma_f32_16x16x32_bf16 v[160:163], a[76:79], a[100:103], v[160:163]
ds_read_b128 a[236:239], v21 offset:128
v_mfma_f32_16x16x32_bf16 v[184:187], a[80:83], a[100:103], v[184:187]
ds_read_b128 a[240:243], v19 offset:28672
v_add_u32 v38, 0x10000, v33
v_mfma_f32_16x16x32_bf16 v[212:215], a[100:103], a[84:87], v[212:215]
v_mfma_f32_16x16x32_bf16 v[216:219], a[104:107], a[84:87], v[216:219]
buffer_load_dwordx4 v10, s[32:35], s66 offen offset:1024 lds
v_mfma_f32_16x16x32_bf16 v[188:191], a[80:83], a[104:107], v[188:191]
v_add_u32 v39, 0x20000, v33
v_mfma_f32_16x16x32_bf16 v[164:167], a[76:79], a[104:107], v[164:167]
v_add_u32 v40, 0x10000, v34
v_mfma_f32_16x16x32_bf16 v[136:139], a[104:107], a[72:75], v[136:139]
v_mfma_f32_16x16x32_bf16 v[108:111], a[68:71], a[104:107], v[108:111]
v_add_u32 v41, 0x20000, v34
v_mfma_f32_16x16x32_bf16 v[84:87], a[60:63], a[104:107], v[84:87]
buffer_load_dwordx4 v11, s[32:35], s66 offen offset:2048 lds
v_mfma_f32_16x16x32_bf16 v[112:115], a[68:71], a[108:111], v[112:115]
v_add_u32 v42, 0x10000, v35
v_mfma_f32_16x16x32_bf16 v[140:143], a[108:111], a[72:75], v[140:143]
v_mfma_f32_16x16x32_bf16 v[192:195], a[80:83], a[108:111], v[192:195]
v_add_u32 v43, 0x20000, v35
v_mfma_f32_16x16x32_bf16 v[220:223], a[108:111], a[84:87], v[220:223]
v_mfma_f32_16x16x32_bf16 v[224:227], a[112:115], a[116:119], v[224:227]
s_waitcnt vmcnt(10) lgkmcnt(0)
s_barrier
v_mfma_f32_16x16x32_bf16 v[64:67], a[120:123], a[124:127], v[64:67]
s_add_u32 s66, s66, 98304
s_add_u32 m0, s68, 73728
v_mfma_f32_16x16x32_bf16 v[88:91], a[192:195], a[124:127], v[88:91]
ds_read_b64_tr_b16 a[244:245], v46 offset:24576
v_and_b32 v60, 1, v60
v_mfma_f32_16x16x32_bf16 v[116:119], a[124:127], a[196:199], v[116:119]
buffer_load_dwordx4 v9, s[32:35], s66 offen offset:0 lds
v_mfma_f32_16x16x32_bf16 v[144:147], a[200:203], a[124:127], v[144:147]
ds_read_b64_tr_b16 a[246:247], v46 offset:25088
v_cmp_eq_u32 vcc, 0, v60
v_mfma_f32_16x16x32_bf16 v[168:171], a[204:207], a[124:127], v[168:171]
ds_read_b128 a[248:251], v14 offset:28672
v_mov_b32 v61, 1
v_mfma_f32_16x16x32_bf16 v[196:199], a[124:127], a[208:211], v[196:199]
ds_read_b64_tr_b16 a[252:253], v46 offset:28672
v_mfma_f32_16x16x32_bf16 v[200:203], a[212:215], a[208:211], v[200:203]
buffer_load_dwordx4 v10, s[32:35], s66 offen offset:1024 lds
v_mfma_f32_16x16x32_bf16 v[172:175], a[204:207], a[212:215], v[172:175]
ds_read_b64_tr_b16 a[254:255], v46 offset:29184
v_mov_b32 v60, vcc_lo
v_mfma_f32_16x16x32_bf16 v[148:151], a[200:203], a[212:215], v[148:151]
ds_read_b64_tr_b16 a[4:5], v46 offset:32768
v_mfma_f32_16x16x32_bf16 v[120:123], a[212:215], a[196:199], v[120:123]
ds_read_b64_tr_b16 a[6:7], v46 offset:33280
v_mfma_f32_16x16x32_bf16 v[92:95], a[192:195], a[212:215], v[92:95]
ds_read_b64_tr_b16 a[28:29], v47 offset:24576
v_mfma_f32_16x16x32_bf16 v[68:71], a[120:123], a[212:215], v[68:71]
buffer_load_dwordx4 v11, s[32:35], s66 offen offset:2048 lds
v_mfma_f32_16x16x32_bf16 v[72:75], a[120:123], a[216:219], v[72:75]
s_and_b32 s97, s70, 7
s_xor_b32 s97, s97, 3
v_mfma_f32_16x16x32_bf16 v[96:99], a[192:195], a[216:219], v[96:99]
s_mul_i32 s65, s97, 128
s_add_u32 m0, s67, 0
v_mfma_f32_16x16x32_bf16 v[124:127], a[216:219], a[196:199], v[124:127]
ds_read_b64_tr_b16 a[30:31], v47 offset:25088
v_mfma_f32_16x16x32_bf16 v[152:155], a[200:203], a[216:219], v[152:155]
ds_read_b64_tr_b16 a[32:33], v47 offset:28672
v_mfma_f32_16x16x32_bf16 v[176:179], a[204:207], a[216:219], v[176:179]
buffer_load_dwordx4 v2, s[28:31], s65 offen offset:0 lds
v_mfma_f32_16x16x32_bf16 v[204:207], a[216:219], a[208:211], v[204:207]
ds_read_b64_tr_b16 a[34:35], v47 offset:29184
v_mfma_f32_16x16x32_bf16 v[208:211], a[220:223], a[208:211], v[208:211]
ds_read_b64_tr_b16 a[36:37], v47 offset:32768
v_mfma_f32_16x16x32_bf16 v[180:183], a[204:207], a[220:223], v[180:183]
ds_read_b64_tr_b16 a[38:39], v47 offset:33280
v_mfma_f32_16x16x32_bf16 v[156:159], a[200:203], a[220:223], v[156:159]
ds_read_b128 a[40:43], v14 offset:40960
v_mfma_f32_16x16x32_bf16 v[128:131], a[220:223], a[196:199], v[128:131]
buffer_load_dwordx4 v3, s[28:31], s65 offen offset:1024 lds
v_mfma_f32_16x16x32_bf16 v[100:103], a[192:195], a[220:223], v[100:103]
ds_read_b128 a[16:19], v14 offset:32768
buffer_store_dwordx2 v[60:61], v62, s[56:59], 0 offen sc1
s_and_b32 s17, s63, 1
s_lshl_b32 s17, s17, 5
s_add_u32 s17, s17, s64
v_mfma_f32_16x16x32_bf16 v[76:79], a[120:123], a[220:223], v[76:79]
ds_read_b128 a[0:3], v14 offset:45056
s_lshl_b32 s16, s17, 2
v_mfma_f32_16x16x32_bf16 v[80:83], a[120:123], a[224:227], v[80:83]
ds_read_b128 a[44:47], v14 offset:36864
s_add_u32 s16, s16, s60
v_mfma_f32_16x16x32_bf16 v[104:107], a[192:195], a[224:227], v[104:107]
ds_read_b128 a[8:11], v23 offset:0
s_mul_i32 s17, s16, 7168
v_mfma_f32_16x16x32_bf16 v[132:135], a[224:227], a[196:199], v[132:135]
buffer_load_dwordx4 v4, s[28:31], s65 offen offset:2048 lds
v_mfma_f32_16x16x32_bf16 v[160:163], a[200:203], a[224:227], v[160:163]
ds_read_b128 a[12:15], v18 offset:28672
s_add_u32 s17, s17, 524288
v_mfma_f32_16x16x32_bf16 v[184:187], a[204:207], a[224:227], v[184:187]
ds_read_b128 a[20:23], v21 offset:192
s_lshl_b32 s16, s16, 11
v_mfma_f32_16x16x32_bf16 v[212:215], a[224:227], a[208:211], v[212:215]
ds_read_b128 a[48:51], v20 offset:28672
v_min_u32 v56, 6, v1
v_mfma_f32_16x16x32_bf16 v[216:219], a[228:231], a[208:211], v[216:219]
v_mfma_f32_16x16x32_bf16 v[188:191], a[204:207], a[228:231], v[188:191]
buffer_load_dwordx4 v5, s[28:31], s65 offen offset:3072 lds
v_mfma_f32_16x16x32_bf16 v[164:167], a[200:203], a[228:231], v[164:167]
s_add_u32 m0, s67, 4096
v_lshl_add_u32 v56, v56, 10, s17
v_mfma_f32_16x16x32_bf16 v[136:139], a[228:231], a[196:199], v[136:139]
v_and_b32 v57, 1, v1
v_mfma_f32_16x16x32_bf16 v[108:111], a[192:195], a[228:231], v[108:111]
v_mfma_f32_16x16x32_bf16 v[84:87], a[120:123], a[228:231], v[84:87]
v_lshl_add_u32 v57, v57, 10, s16
v_mfma_f32_16x16x32_bf16 v[112:115], a[192:195], a[232:235], v[112:115]
buffer_load_dwordx4 v6, s[28:31], s65 offen offset:0 lds
v_mfma_f32_16x16x32_bf16 v[140:143], a[232:235], a[196:199], v[140:143]
s_mov_b64 exec, 0x7f
buffer_load_dword v56, v56, s[48:51], 0 offen offset:384
s_mov_b64 exec, -1
v_mfma_f32_16x16x32_bf16 v[192:195], a[204:207], a[232:235], v[192:195]
v_mfma_f32_16x16x32_bf16 v[220:223], a[232:235], a[208:211], v[220:223]
s_mov_b64 exec, 0x3
buffer_load_dword v57, v57, s[44:47], 0 offen offset:384
s_mov_b64 exec, -1
v_mfma_f32_16x16x32_bf16 v[224:227], a[236:239], a[240:243], v[224:227]
s_waitcnt vmcnt(11) lgkmcnt(0)
s_barrier
v_mfma_f32_16x16x32_bf16 v[64:67], a[244:247], a[248:251], v[64:67]
buffer_load_dwordx4 v7, s[28:31], s65 offen offset:1024 lds
v_mfma_f32_16x16x32_bf16 v[88:91], a[252:255], a[248:251], v[88:91]
s_add_u32 m0, s69, 0
ds_read_b64_tr_b16 a[24:25], v46 offset:36864
v_mfma_f32_16x16x32_bf16 v[116:119], a[248:251], a[4:7], v[116:119]
ds_read_b64_tr_b16 a[26:27], v46 offset:37376
v_mfma_f32_16x16x32_bf16 v[144:147], a[28:31], a[248:251], v[144:147]
ds_read_b128 a[52:55], v22 offset:8192
v_mfma_f32_16x16x32_bf16 v[168:171], a[32:35], a[248:251], v[168:171]
ds_read_b64_tr_b16 a[56:57], v46 offset:40960
s_add_u32 s40, s24, 9437184
s_addc_u32 s41, s25, 0
s_mov_b32 s42, 0x4000
v_mfma_f32_16x16x32_bf16 v[196:199], a[248:251], a[36:39], v[196:199]
buffer_load_dwordx4 v8, s[28:31], s65 offen offset:0 lds
s_mov_b32 s43, 0x20000
v_mfma_f32_16x16x32_bf16 v[200:203], a[40:43], a[36:39], v[200:203]
s_and_b32 s97, s70, 7
s_xor_b32 s97, s97, 3
s_mov_b32 s82, 0x3eb8aa3b
v_mfma_f32_16x16x32_bf16 v[172:175], a[32:35], a[40:43], v[172:175]
s_mul_i32 s66, s97, 196608
s_add_u32 m0, s68, 86016
s_mov_b32 s83, 0xbfb8aa3b
s_lshl_b32 s4, s62, 1
v_mfma_f32_16x16x32_bf16 v[148:151], a[28:31], a[40:43], v[148:151]
ds_read_b64_tr_b16 a[58:59], v46 offset:41472
s_and_b32 s5, s60, 1
v_mfma_f32_16x16x32_bf16 v[120:123], a[40:43], a[4:7], v[120:123]
ds_read_b64_tr_b16 a[64:65], v46 offset:45056
s_add_u32 s4, s4, s5
v_mfma_f32_16x16x32_bf16 v[92:95], a[252:255], a[40:43], v[92:95]
buffer_load_dwordx4 v9, s[32:35], s66 offen offset:0 lds
s_lshl_b32 s4, s4, 11
v_mfma_f32_16x16x32_bf16 v[68:71], a[244:247], a[40:43], v[68:71]
ds_read_b64_tr_b16 a[66:67], v46 offset:45568
v_lshlrev_b32 v250, 4, v1
v_mfma_f32_16x16x32_bf16 v[72:75], a[244:247], a[16:19], v[72:75]
ds_read_b64_tr_b16 a[88:89], v47 offset:36864
v_add_u32 v250, s4, v250
s_lshl_b32 s4, s62, 2
v_mfma_f32_16x16x32_bf16 v[96:99], a[252:255], a[16:19], v[96:99]
ds_read_b64_tr_b16 a[90:91], v47 offset:37376
s_add_u32 s4, s4, s60
v_mfma_f32_16x16x32_bf16 v[124:127], a[16:19], a[4:7], v[124:127]
ds_read_b64_tr_b16 a[92:93], v47 offset:40960
s_lshl_b32 s5, s4, 2
v_mfma_f32_16x16x32_bf16 v[152:155], a[28:31], a[16:19], v[152:155]
buffer_load_dwordx4 v10, s[32:35], s66 offen offset:1024 lds
s_mov_b32 s12, 0x71a48260
v_mfma_f32_16x16x32_bf16 v[176:179], a[32:35], a[16:19], v[176:179]
ds_read_b64_tr_b16 a[94:95], v47 offset:41472
s_mov_b32 s13, 0xb593
s_lshr_b64 s[12:13], s[12:13], s5
v_mfma_f32_16x16x32_bf16 v[204:207], a[16:19], a[36:39], v[204:207]
ds_read_b64_tr_b16 a[96:97], v47 offset:45056
s_and_b32 s5, s12, 15
v_mfma_f32_16x16x32_bf16 v[208:211], a[0:3], a[36:39], v[208:211]
ds_read_b64_tr_b16 a[98:99], v47 offset:45568
s_add_u32 s5, s5, s61
v_mfma_f32_16x16x32_bf16 v[180:183], a[32:35], a[0:3], v[180:183]
ds_read_b128 a[100:103], v22 offset:20480
s_lshl_b32 s5, s5, 7
v_mfma_f32_16x16x32_bf16 v[156:159], a[28:31], a[0:3], v[156:159]
buffer_load_dwordx4 v11, s[32:35], s66 offen offset:2048 lds
v_mfma_f32_16x16x32_bf16 v[128:131], a[0:3], a[4:7], v[128:131]
s_add_u32 s66, s66, 98304
s_add_u32 m0, s68, 98304
v_mfma_f32_16x16x32_bf16 v[100:103], a[252:255], a[0:3], v[100:103]
ds_read_b128 a[76:79], v22 offset:12288
s_cmp_lt_u32 s4, 12
s_cselect_b32 s5, s5, 0x40000000
v_lshl_add_u32 v251, v1, 2, s5
v_mov_b32 v252, 0x40000000
v_mfma_f32_16x16x32_bf16 v[76:79], a[244:247], a[0:3], v[76:79]
ds_read_b128 a[60:63], v22 offset:24576
v_cmp_gt_u32 vcc, 32, v1
v_mfma_f32_16x16x32_bf16 v[80:83], a[244:247], a[44:47], v[80:83]
ds_read_b128 a[104:107], v22 offset:16384
v_mov_b32 v248, 0x3f803f80
v_mfma_f32_16x16x32_bf16 v[104:107], a[252:255], a[44:47], v[104:107]
buffer_load_dwordx4 v9, s[32:35], s66 offen offset:0 lds
v_mov_b32 v249, 0x3f803f80
v_cndmask_b32 v251, v252, v251, vcc
v_mfma_f32_16x16x32_bf16 v[132:135], a[44:47], a[4:7], v[132:135]
ds_read_b128 a[68:71], v22 offset:28672
s_lshr_b32 s6, s60, 1
v_mfma_f32_16x16x32_bf16 v[160:163], a[28:31], a[44:47], v[160:163]
ds_read_b128 a[72:75], v24 offset:8192
s_mul_i32 s6, s6, 6
v_mfma_f32_16x16x32_bf16 v[184:187], a[32:35], a[44:47], v[184:187]
ds_read_b128 a[80:83], v21 offset:256
s_add_u32 s6, s6, s61
v_mfma_f32_16x16x32_bf16 v[212:215], a[44:47], a[36:39], v[212:215]
ds_read_b128 a[108:111], v25 offset:8192
s_add_u32 s4, s6, 0
v_mfma_f32_16x16x32_bf16 v[216:219], a[8:11], a[36:39], v[216:219]
buffer_load_dwordx4 v10, s[32:35], s66 offen offset:1024 lds
s_lshr_b32 s5, s4, 2
s_mul_i32 s86, s5, 294912
v_mfma_f32_16x16x32_bf16 v[188:191], a[32:35], a[8:11], v[188:191]
Q_T0:
s_cbranch_execz Q_T4
s_and_b32 s5, s4, 1
s_mul_i32 s5, s5, 147456
v_mfma_f32_16x16x32_bf16 v[164:167], a[28:31], a[8:11], v[164:167]
s_add_u32 s86, s86, s5
s_and_b32 s4, s4, 2
v_mfma_f32_16x16x32_bf16 v[136:139], a[8:11], a[4:7], v[136:139]
s_lshl_b32 s4, s4, 9
s_add_u32 s86, s86, s4
v_mfma_f32_16x16x32_bf16 v[108:111], a[252:255], a[8:11], v[108:111]
s_add_u32 s4, s6, 1
s_lshr_b32 s5, s4, 2
v_mfma_f32_16x16x32_bf16 v[84:87], a[244:247], a[8:11], v[84:87]
buffer_load_dwordx4 v11, s[32:35], s66 offen offset:2048 lds
v_mfma_f32_16x16x32_bf16 v[112:115], a[252:255], a[12:15], v[112:115]
s_mul_i32 s87, s5, 294912
s_and_b32 s5, s4, 1
v_mfma_f32_16x16x32_bf16 v[140:143], a[12:15], a[4:7], v[140:143]
s_mul_i32 s5, s5, 147456
s_add_u32 s87, s87, s5
v_mfma_f32_16x16x32_bf16 v[192:195], a[32:35], a[12:15], v[192:195]
s_and_b32 s4, s4, 2
v_mfma_f32_16x16x32_bf16 v[220:223], a[12:15], a[36:39], v[220:223]
s_lshl_b32 s4, s4, 9
v_mfma_f32_16x16x32_bf16 v[224:227], a[20:23], a[48:51], v[224:227]
s_add_u32 s87, s87, s4
s_waitcnt vmcnt(16) lgkmcnt(0)
s_barrier
v_mfma_f32_16x16x32_bf16 v[64:67], a[24:27], a[52:55], v[64:67]
s_and_b32 s97, s70, 7
s_xor_b32 s97, s97, 4
v_mfma_f32_16x16x32_bf16 v[88:91], a[56:59], a[52:55], v[88:91]
s_mul_i32 s65, s97, 128
s_add_u32 m0, s67, 28672
v_mfma_f32_16x16x32_bf16 v[116:119], a[52:55], a[64:67], v[116:119]
buffer_load_dwordx4 v2, s[28:31], s65 offen offset:0 lds
v_mfma_f32_16x16x32_bf16 v[144:147], a[88:91], a[52:55], v[144:147]
ds_read_b64_tr_b16 a[84:85], v44 offset:36864
s_add_u32 s4, s6, 2
v_mfma_f32_16x16x32_bf16 v[168:171], a[92:95], a[52:55], v[168:171]
ds_read_b64_tr_b16 a[86:87], v44 offset:37376
s_lshr_b32 s5, s4, 2
v_mfma_f32_16x16x32_bf16 v[196:199], a[52:55], a[96:99], v[196:199]
buffer_load_dwordx4 v3, s[28:31], s65 offen offset:1024 lds
s_mul_i32 s88, s5, 294912
v_mfma_f32_16x16x32_bf16 v[200:203], a[100:103], a[96:99], v[200:203]
ds_read_b128 a[112:115], v23 offset:8192
s_and_b32 s5, s4, 1
v_mfma_f32_16x16x32_bf16 v[172:175], a[92:95], a[100:103], v[172:175]
ds_read_b64_tr_b16 a[116:117], v44 offset:40960
s_mul_i32 s5, s5, 147456
v_mfma_f32_16x16x32_bf16 v[148:151], a[88:91], a[100:103], v[148:151]
ds_read_b64_tr_b16 a[118:119], v44 offset:41472
s_add_u32 s88, s88, s5
v_mfma_f32_16x16x32_bf16 v[120:123], a[100:103], a[64:67], v[120:123]
buffer_load_dwordx4 v4, s[28:31], s65 offen offset:2048 lds
v_mfma_f32_16x16x32_bf16 v[92:95], a[56:59], a[100:103], v[92:95]
ds_read_b64_tr_b16 a[124:125], v44 offset:45056
s_and_b32 s4, s4, 2
v_mfma_f32_16x16x32_bf16 v[68:71], a[24:27], a[100:103], v[68:71]
ds_read_b64_tr_b16 a[126:127], v44 offset:45568
s_lshl_b32 s4, s4, 9
v_mfma_f32_16x16x32_bf16 v[72:75], a[24:27], a[76:79], v[72:75]
ds_read_b64_tr_b16 a[212:213], v45 offset:36864
s_add_u32 s88, s88, s4
v_mfma_f32_16x16x32_bf16 v[96:99], a[56:59], a[76:79], v[96:99]
buffer_load_dwordx4 v5, s[28:31], s65 offen offset:3072 lds
s_add_u32 s4, s6, 3
v_mfma_f32_16x16x32_bf16 v[124:127], a[76:79], a[64:67], v[124:127]
s_add_u32 m0, s67, 32768
ds_read_b64_tr_b16 a[214:215], v45 offset:37376
s_lshr_b32 s5, s4, 2
v_mfma_f32_16x16x32_bf16 v[152:155], a[88:91], a[76:79], v[152:155]
ds_read_b64_tr_b16 a[216:217], v45 offset:40960
s_mul_i32 s89, s5, 294912
v_mfma_f32_16x16x32_bf16 v[176:179], a[92:95], a[76:79], v[176:179]
ds_read_b64_tr_b16 a[218:219], v45 offset:41472
s_and_b32 s5, s4, 1
v_mfma_f32_16x16x32_bf16 v[204:207], a[76:79], a[96:99], v[204:207]
buffer_load_dwordx4 v6, s[28:31], s65 offen offset:0 lds
v_mfma_f32_16x16x32_bf16 v[208:211], a[60:63], a[96:99], v[208:211]
ds_read_b64_tr_b16 a[220:221], v45 offset:45056
s_mul_i32 s5, s5, 147456
v_mfma_f32_16x16x32_bf16 v[180:183], a[92:95], a[60:63], v[180:183]
ds_read_b64_tr_b16 a[222:223], v45 offset:45568
s_add_u32 s89, s89, s5
v_mfma_f32_16x16x32_bf16 v[156:159], a[88:91], a[60:63], v[156:159]
ds_read_b128 a[224:227], v23 offset:20480
s_and_b32 s4, s4, 2
v_mfma_f32_16x16x32_bf16 v[128:131], a[60:63], a[64:67], v[128:131]
buffer_load_dwordx4 v7, s[28:31], s65 offen offset:1024 lds
s_lshl_b32 s4, s4, 9
v_mfma_f32_16x16x32_bf16 v[100:103], a[56:59], a[60:63], v[100:103]
s_add_u32 m0, s69, 28672
ds_read_b128 a[200:203], v23 offset:12288
s_add_u32 s89, s89, s4
v_mfma_f32_16x16x32_bf16 v[76:79], a[24:27], a[60:63], v[76:79]
ds_read_b128 a[120:123], v23 offset:24576
s_add_u32 s4, s6, 4
v_mfma_f32_16x16x32_bf16 v[80:83], a[24:27], a[104:107], v[80:83]
ds_read_b128 a[228:231], v23 offset:16384
s_lshr_b32 s5, s4, 2
v_mfma_f32_16x16x32_bf16 v[104:107], a[56:59], a[104:107], v[104:107]
buffer_load_dwordx4 v8, s[28:31], s65 offen offset:0 lds
v_mfma_f32_16x16x32_bf16 v[132:135], a[104:107], a[64:67], v[132:135]
s_and_b32 s97, s70, 7
s_xor_b32 s97, s97, 4
s_mul_i32 s90, s5, 294912
v_mfma_f32_16x16x32_bf16 v[160:163], a[88:91], a[104:107], v[160:163]
s_mul_i32 s66, s97, 196608
s_add_u32 m0, s68, 110592
s_and_b32 s5, s4, 1
v_mfma_f32_16x16x32_bf16 v[184:187], a[92:95], a[104:107], v[184:187]
ds_read_b128 a[192:195], v23 offset:28672
s_mul_i32 s5, s5, 147456
v_mfma_f32_16x16x32_bf16 v[212:215], a[104:107], a[96:99], v[212:215]
buffer_load_dwordx4 v9, s[32:35], s66 offen offset:0 lds
s_add_u32 s90, s90, s5
v_mfma_f32_16x16x32_bf16 v[216:219], a[68:71], a[96:99], v[216:219]
ds_read_b128 a[196:199], v26 offset:8192
s_and_b32 s4, s4, 2
v_mfma_f32_16x16x32_bf16 v[188:191], a[92:95], a[68:71], v[188:191]
ds_read_b128 a[204:207], v21 offset:320
s_lshl_b32 s4, s4, 9
v_mfma_f32_16x16x32_bf16 v[164:167], a[88:91], a[68:71], v[164:167]
ds_read_b128 a[232:235], v27 offset:8192
s_add_u32 s90, s90, s4
v_mfma_f32_16x16x32_bf16 v[136:139], a[68:71], a[64:67], v[136:139]
buffer_load_dwordx4 v10, s[32:35], s66 offen offset:1024 lds
v_mfma_f32_16x16x32_bf16 v[108:111], a[56:59], a[68:71], v[108:111]
s_add_u32 s4, s6, 5
s_lshr_b32 s5, s4, 2
v_mfma_f32_16x16x32_bf16 v[84:87], a[24:27], a[68:71], v[84:87]
s_mul_i32 s91, s5, 294912
s_and_b32 s5, s4, 1
v_mfma_f32_16x16x32_bf16 v[112:115], a[56:59], a[72:75], v[112:115]
s_mul_i32 s5, s5, 147456
s_add_u32 s91, s91, s5
v_mfma_f32_16x16x32_bf16 v[140:143], a[72:75], a[64:67], v[140:143]
buffer_load_dwordx4 v11, s[32:35], s66 offen offset:2048 lds
v_mfma_f32_16x16x32_bf16 v[192:195], a[92:95], a[72:75], v[192:195]
s_and_b32 s4, s4, 2
s_lshl_b32 s4, s4, 9
v_mfma_f32_16x16x32_bf16 v[220:223], a[72:75], a[96:99], v[220:223]
s_add_u32 s91, s91, s4
v_mfma_f32_16x16x32_bf16 v[224:227], a[80:83], a[108:111], v[224:227]
s_waitcnt vmcnt(13) lgkmcnt(0)
s_barrier
v_mfma_f32_16x16x32_bf16 v[64:67], a[84:87], a[112:115], v[64:67]
s_add_u32 s66, s66, 98304
s_add_u32 m0, s68, 122880
v_mfma_f32_16x16x32_bf16 v[88:91], a[116:119], a[112:115], v[88:91]
ds_read_b64_tr_b16 a[208:209], v46 offset:0
v_and_b32 v252, 15, v1
v_mfma_f32_16x16x32_bf16 v[116:119], a[112:115], a[124:127], v[116:119]
buffer_load_dwordx4 v9, s[32:35], s66 offen offset:0 lds
v_mfma_f32_16x16x32_bf16 v[144:147], a[212:215], a[112:115], v[144:147]
ds_read_b64_tr_b16 a[210:211], v46 offset:512
v_lshrrev_b32 v253, 4, v1
v_mfma_f32_16x16x32_bf16 v[168:171], a[216:219], a[112:115], v[168:171]
ds_read_b128 a[236:239], v13 offset:0
v_lshlrev_b32 v253, 2, v253
v_mfma_f32_16x16x32_bf16 v[196:199], a[112:115], a[220:223], v[196:199]
buffer_load_dwordx4 v10, s[32:35], s66 offen offset:1024 lds
v_mfma_f32_16x16x32_bf16 v[200:203], a[224:227], a[220:223], v[200:203]
ds_read_b64_tr_b16 a[240:241], v46 offset:4096
v_sub_u32 v252, v252, v253
v_mfma_f32_16x16x32_bf16 v[172:175], a[216:219], a[224:227], v[172:175]
ds_read_b64_tr_b16 a[242:243], v46 offset:4608
v_mov_b32 v254, 0xff800000
v_mfma_f32_16x16x32_bf16 v[148:151], a[212:215], a[224:227], v[148:151]
ds_read_b64_tr_b16 a[248:249], v46 offset:8192
s_lshr_b32 s4, s60, 1
v_mfma_f32_16x16x32_bf16 v[120:123], a[224:227], a[124:127], v[120:123]
buffer_load_dwordx4 v11, s[32:35], s66 offen offset:2048 lds
v_mfma_f32_16x16x32_bf16 v[92:95], a[116:119], a[224:227], v[92:95]
s_lshl_b32 s77, s74, 4
s_add_u32 m0, s71, 155648
v_mfma_f32_16x16x32_bf16 v[68:71], a[84:87], a[224:227], v[68:71]
ds_read_b64_tr_b16 a[250:251], v46 offset:8704
s_or_b32 s4, s4, s61
v_mfma_f32_16x16x32_bf16 v[72:75], a[84:87], a[200:203], v[72:75]
ds_read_b64_tr_b16 a[40:41], v47 offset:0
v_mfma_f32_16x16x32_bf16 v[96:99], a[116:119], a[200:203], v[96:99]
buffer_load_dwordx4 v12, s[44:47], s77 offen offset:0 lds
v_mfma_f32_16x16x32_bf16 v[124:127], a[200:203], a[124:127], v[124:127]
ds_read_b64_tr_b16 a[42:43], v47 offset:512
v_mfma_f32_16x16x32_bf16 v[152:155], a[212:215], a[200:203], v[152:155]
ds_read_b64_tr_b16 a[16:17], v47 offset:4096
v_mfma_f32_16x16x32_bf16 v[176:179], a[216:219], a[200:203], v[176:179]
ds_read_b64_tr_b16 a[18:19], v47 offset:4608
v_mfma_f32_16x16x32_bf16 v[204:207], a[200:203], a[220:223], v[204:207]
buffer_load_dwordx4 v0, s[44:47], s77 offen offset:1024 lds
v_mfma_f32_16x16x32_bf16 v[208:211], a[120:123], a[220:223], v[208:211]
s_and_b32 s97, s70, 7
s_xor_b32 s97, s97, 5
v_mfma_f32_16x16x32_bf16 v[180:183], a[216:219], a[120:123], v[180:183]
s_mul_i32 s65, s97, 128
s_add_u32 m0, s67, 57344
v_mfma_f32_16x16x32_bf16 v[156:159], a[212:215], a[120:123], v[156:159]
ds_read_b64_tr_b16 a[0:1], v47 offset:8192
v_mfma_f32_16x16x32_bf16 v[128:131], a[120:123], a[124:127], v[128:131]
buffer_load_dwordx4 v2, s[28:31], s65 offen offset:0 lds
s_cmp_lg_u32 s4, 0
s_cselect_b64 s[8:9], -1, 0
s_mov_b32 s10, s8
s_mov_b32 s11, 0
v_mfma_f32_16x16x32_bf16 v[100:103], a[116:119], a[120:123], v[100:103]
ds_read_b64_tr_b16 a[2:3], v47 offset:8704
v_mov_b32 v244, 0
v_mfma_f32_16x16x32_bf16 v[76:79], a[84:87], a[120:123], v[76:79]
ds_read_b128 a[44:47], v13 offset:12288
v_mov_b32 v245, 0
v_mfma_f32_16x16x32_bf16 v[80:83], a[84:87], a[228:231], v[80:83]
ds_read_b128 a[28:31], v13 offset:4096
v_subrev_u32 v255, 0, v252
v_mfma_f32_16x16x32_bf16 v[104:107], a[116:119], a[228:231], v[104:107]
buffer_load_dwordx4 v3, s[28:31], s65 offen offset:1024 lds
v_mfma_f32_16x16x32_bf16 v[132:135], a[228:231], a[124:127], v[132:135]
ds_read_b128 a[244:247], v13 offset:16384
v_cmp_gt_u32 vcc, 8, v255
v_mfma_f32_16x16x32_bf16 v[160:163], a[212:215], a[228:231], v[160:163]
ds_read_b128 a[8:11], v13 offset:8192
v_mov_b32 v253, 0xffff
v_mfma_f32_16x16x32_bf16 v[184:187], a[216:219], a[228:231], v[184:187]
ds_read_b128 a[252:255], v13 offset:20480
v_add_u32 v255, 16, v252
v_mfma_f32_16x16x32_bf16 v[212:215], a[228:231], a[220:223], v[212:215]
buffer_load_dwordx4 v4, s[28:31], s65 offen offset:2048 lds
v_mfma_f32_16x16x32_bf16 v[216:219], a[192:195], a[220:223], v[216:219]
ds_read_b128 a[4:7], v17 offset:0
v_cndmask_b32 v228, v254, 0, vcc
v_mfma_f32_16x16x32_bf16 v[188:191], a[216:219], a[192:195], v[188:191]
ds_read_b128 a[32:35], v21 offset:384
v_cndmask_b32 v253, 0, v253, vcc
v_mfma_f32_16x16x32_bf16 v[164:167], a[212:215], a[192:195], v[164:167]
ds_read_b128 a[12:15], v19 offset:0
v_cmp_gt_u32 vcc, 8, v255
v_mfma_f32_16x16x32_bf16 v[136:139], a[192:195], a[124:127], v[136:139]
buffer_load_dwordx4 v5, s[28:31], s65 offen offset:3072 lds
v_mfma_f32_16x16x32_bf16 v[108:111], a[116:119], a[192:195], v[108:111]
s_add_u32 m0, s67, 61440
v_or_b32 v244, v244, v253
v_mfma_f32_16x16x32_bf16 v[84:87], a[84:87], a[192:195], v[84:87]
v_add_u32 v255, 8, v252
v_mfma_f32_16x16x32_bf16 v[112:115], a[116:119], a[196:199], v[112:115]
v_cndmask_b32 v232, v254, 0, vcc
v_mfma_f32_16x16x32_bf16 v[140:143], a[196:199], a[124:127], v[140:143]
buffer_load_dwordx4 v6, s[28:31], s65 offen offset:0 lds
v_mfma_f32_16x16x32_bf16 v[192:195], a[216:219], a[196:199], v[192:195]
s_and_b64 vcc, vcc, s[8:9]
v_mfma_f32_16x16x32_bf16 v[220:223], a[196:199], a[220:223], v[220:223]
v_cndmask_b32 v240, v254, 0, vcc
v_mfma_f32_16x16x32_bf16 v[224:227], a[204:207], a[232:235], v[224:227]
s_waitcnt vmcnt(20) lgkmcnt(0)
s_barrier
v_mfma_f32_16x16x32_bf16 v[64:67], a[208:211], a[236:239], v[64:67]
buffer_load_dwordx4 v7, s[28:31], s65 offen offset:1024 lds
v_mfma_f32_16x16x32_bf16 v[88:91], a[240:243], a[236:239], v[88:91]
s_add_u32 m0, s69, 57344
ds_read_b64_tr_b16 a[36:37], v46 offset:12288
v_mfma_f32_16x16x32_bf16 v[116:119], a[236:239], a[248:251], v[116:119]
ds_read_b64_tr_b16 a[38:39], v46 offset:12800
v_cmp_gt_u32 vcc, 8, v255
v_mfma_f32_16x16x32_bf16 v[144:147], a[40:43], a[236:239], v[144:147]
ds_read_b128 a[20:23], v14 offset:0
s_and_b64 vcc, vcc, s[10:11]
v_mfma_f32_16x16x32_bf16 v[168:171], a[16:19], a[236:239], v[168:171]
ds_read_b64_tr_b16 a[48:49], v46 offset:16384
v_cndmask_b32 v236, v254, 0, vcc
v_mfma_f32_16x16x32_bf16 v[196:199], a[236:239], a[0:3], v[196:199]
buffer_load_dwordx4 v8, s[28:31], s65 offen offset:0 lds
v_mfma_f32_16x16x32_bf16 v[200:203], a[44:47], a[0:3], v[200:203]
s_and_b32 s97, s70, 7
s_xor_b32 s97, s97, 5
v_mfma_f32_16x16x32_bf16 v[172:175], a[16:19], a[44:47], v[172:175]
s_mul_i32 s66, s97, 196608
s_add_u32 m0, s68, 73728
v_mfma_f32_16x16x32_bf16 v[148:151], a[40:43], a[44:47], v[148:151]
ds_read_b64_tr_b16 a[50:51], v46 offset:16896
v_subrev_u32 v255, 1, v252
v_mfma_f32_16x16x32_bf16 v[120:123], a[44:47], a[248:251], v[120:123]
ds_read_b64_tr_b16 a[52:53], v46 offset:20480
v_cmp_gt_u32 vcc, 8, v255
v_mfma_f32_16x16x32_bf16 v[92:95], a[240:243], a[44:47], v[92:95]
buffer_load_dwordx4 v9, s[32:35], s66 offen offset:0 lds
v_mfma_f32_16x16x32_bf16 v[68:71], a[208:211], a[44:47], v[68:71]
ds_read_b64_tr_b16 a[54:55], v46 offset:20992
v_mov_b32 v253, 0xffff0000
v_mfma_f32_16x16x32_bf16 v[72:75], a[208:211], a[28:31], v[72:75]
ds_read_b64_tr_b16 a[100:101], v47 offset:12288
v_add_u32 v255, 15, v252
v_mfma_f32_16x16x32_bf16 v[96:99], a[240:243], a[28:31], v[96:99]
ds_read_b64_tr_b16 a[102:103], v47 offset:12800
v_cndmask_b32 v229, v254, 0, vcc
v_mfma_f32_16x16x32_bf16 v[124:127], a[28:31], a[248:251], v[124:127]
ds_read_b64_tr_b16 a[76:77], v47 offset:16384
v_cndmask_b32 v253, 0, v253, vcc
v_mfma_f32_16x16x32_bf16 v[152:155], a[40:43], a[28:31], v[152:155]
buffer_load_dwordx4 v10, s[32:35], s66 offen offset:1024 lds
v_mfma_f32_16x16x32_bf16 v[176:179], a[16:19], a[28:31], v[176:179]
ds_read_b64_tr_b16 a[78:79], v47 offset:16896
v_cmp_gt_u32 vcc, 8, v255
v_mfma_f32_16x16x32_bf16 v[204:207], a[28:31], a[0:3], v[204:207]
ds_read_b64_tr_b16 a[60:61], v47 offset:20480
v_or_b32 v244, v244, v253
v_mfma_f32_16x16x32_bf16 v[208:211], a[244:247], a[0:3], v[208:211]
ds_read_b64_tr_b16 a[62:63], v47 offset:20992
v_add_u32 v255, 7, v252
v_mfma_f32_16x16x32_bf16 v[180:183], a[16:19], a[244:247], v[180:183]
ds_read_b128 a[104:107], v14 offset:12288
v_cndmask_b32 v233, v254, 0, vcc
v_mfma_f32_16x16x32_bf16 v[156:159], a[40:43], a[244:247], v[156:159]
buffer_load_dwordx4 v11, s[32:35], s66 offen offset:2048 lds
v_mfma_f32_16x16x32_bf16 v[128:131], a[244:247], a[248:251], v[128:131]
s_add_u32 s66, s66, 98304
s_add_u32 m0, s68, 86016
v_mfma_f32_16x16x32_bf16 v[100:103], a[240:243], a[244:247], v[100:103]
ds_read_b128 a[88:91], v14 offset:4096
s_and_b64 vcc, vcc, s[8:9]
v_mfma_f32_16x16x32_bf16 v[76:79], a[208:211], a[244:247], v[76:79]
ds_read_b128 a[24:27], v14 offset:16384
v_cndmask_b32 v241, v254, 0, vcc
v_mfma_f32_16x16x32_bf16 v[80:83], a[208:211], a[8:11], v[80:83]
ds_read_b128 a[68:71], v14 offset:8192
v_cmp_gt_u32 vcc, 8, v255
v_mfma_f32_16x16x32_bf16 v[104:107], a[240:243], a[8:11], v[104:107]
buffer_load_dwordx4 v9, s[32:35], s66 offen offset:0 lds
v_mfma_f32_16x16x32_bf16 v[132:135], a[8:11], a[248:251], v[132:135]
ds_read_b128 a[56:59], v14 offset:20480
s_and_b64 vcc, vcc, s[10:11]
v_mfma_f32_16x16x32_bf16 v[160:163], a[40:43], a[8:11], v[160:163]
ds_read_b128 a[64:67], v18 offset:0
v_cndmask_b32 v237, v254, 0, vcc
v_mfma_f32_16x16x32_bf16 v[184:187], a[16:19], a[8:11], v[184:187]
ds_read_b128 a[92:95], v21 offset:448
v_subrev_u32 v255, 2, v252
v_mfma_f32_16x16x32_bf16 v[212:215], a[8:11], a[0:3], v[212:215]
ds_read_b128 a[72:75], v20 offset:0
v_cmp_gt_u32 vcc, 8, v255
v_mfma_f32_16x16x32_bf16 v[216:219], a[252:255], a[0:3], v[216:219]
buffer_load_dwordx4 v10, s[32:35], s66 offen offset:1024 lds
v_mfma_f32_16x16x32_bf16 v[188:191], a[16:19], a[252:255], v[188:191]
v_mov_b32 v253, 0xffff
v_add_u32 v255, 14, v252
v_mfma_f32_16x16x32_bf16 v[164:167], a[40:43], a[252:255], v[164:167]
v_cndmask_b32 v230, v254, 0, vcc
v_mfma_f32_16x16x32_bf16 v[136:139], a[252:255], a[248:251], v[136:139]
v_cndmask_b32 v253, 0, v253, vcc
v_mfma_f32_16x16x32_bf16 v[108:111], a[240:243], a[252:255], v[108:111]
v_mfma_f32_16x16x32_bf16 v[84:87], a[208:211], a[252:255], v[84:87]
buffer_load_dwordx4 v11, s[32:35], s66 offen offset:2048 lds
v_mfma_f32_16x16x32_bf16 v[112:115], a[240:243], a[4:7], v[112:115]
v_cmp_gt_u32 vcc, 8, v255
v_or_b32 v245, v245, v253
v_mfma_f32_16x16x32_bf16 v[140:143], a[4:7], a[248:251], v[140:143]
v_mfma_f32_16x16x32_bf16 v[192:195], a[16:19], a[4:7], v[192:195]
v_add_u32 v255, 6, v252
v_mfma_f32_16x16x32_bf16 v[220:223], a[4:7], a[0:3], v[220:223]
v_cndmask_b32 v234, v254, 0, vcc
v_mfma_f32_16x16x32_bf16 v[224:227], a[32:35], a[12:15], v[224:227]
s_waitcnt vmcnt(13) lgkmcnt(0)
s_barrier
v_mfma_f32_16x16x32_bf16 v[64:67], a[36:39], a[20:23], v[64:67]
s_and_b32 s97, s70, 7
s_xor_b32 s97, s97, 6
v_mfma_f32_16x16x32_bf16 v[88:91], a[48:51], a[20:23], v[88:91]
s_mul_i32 s65, s97, 128
s_add_u32 m0, s67, 0
v_mfma_f32_16x16x32_bf16 v[116:119], a[20:23], a[52:55], v[116:119]
buffer_load_dwordx4 v2, s[28:31], s65 offen offset:0 lds
v_mfma_f32_16x16x32_bf16 v[144:147], a[100:103], a[20:23], v[144:147]
ds_read_b64_tr_b16 a[96:97], v46 offset:24576
s_and_b64 vcc, vcc, s[8:9]
v_mfma_f32_16x16x32_bf16 v[168:171], a[76:79], a[20:23], v[168:171]
ds_read_b64_tr_b16 a[98:99], v46 offset:25088
v_cndmask_b32 v242, v254, 0, vcc
v_mfma_f32_16x16x32_bf16 v[196:199], a[20:23], a[60:63], v[196:199]
buffer_load_dwordx4 v3, s[28:31], s65 offen offset:1024 lds
v_mfma_f32_16x16x32_bf16 v[200:203], a[104:107], a[60:63], v[200:203]
ds_read_b128 a[80:83], v13 offset:28672
v_cmp_gt_u32 vcc, 8, v255
v_mfma_f32_16x16x32_bf16 v[172:175], a[76:79], a[104:107], v[172:175]
ds_read_b64_tr_b16 a[108:109], v46 offset:28672
s_and_b64 vcc, vcc, s[10:11]
v_mfma_f32_16x16x32_bf16 v[148:151], a[100:103], a[104:107], v[148:151]
ds_read_b64_tr_b16 a[110:111], v46 offset:29184
v_cndmask_b32 v238, v254, 0, vcc
v_mfma_f32_16x16x32_bf16 v[120:123], a[104:107], a[52:55], v[120:123]
buffer_load_dwordx4 v4, s[28:31], s65 offen offset:2048 lds
v_mfma_f32_16x16x32_bf16 v[92:95], a[48:51], a[104:107], v[92:95]
ds_read_b64_tr_b16 a[112:113], v46 offset:32768
ds_read_b64_tr_b16 a[128:129], v37 offset:24576
v_mfma_f32_16x16x32_bf16 v[68:71], a[36:39], a[104:107], v[68:71]
ds_read_b64_tr_b16 a[114:115], v46 offset:33280
v_subrev_u32 v255, 3, v252
v_mfma_f32_16x16x32_bf16 v[72:75], a[36:39], a[88:91], v[72:75]
ds_read_b64_tr_b16 a[224:225], v47 offset:24576
v_cmp_gt_u32 vcc, 8, v255
v_mfma_f32_16x16x32_bf16 v[96:99], a[48:51], a[88:91], v[96:99]
buffer_load_dwordx4 v5, s[28:31], s65 offen offset:3072 lds
v_mfma_f32_16x16x32_bf16 v[124:127], a[88:91], a[52:55], v[124:127]
s_add_u32 m0, s67, 4096
ds_read_b64_tr_b16 a[226:227], v47 offset:25088
v_mfma_f32_16x16x32_bf16 v[152:155], a[100:103], a[88:91], v[152:155]
ds_read_b64_tr_b16 a[200:201], v47 offset:28672
v_mov_b32 v253, 0xffff0000
v_mfma_f32_16x16x32_bf16 v[176:179], a[76:79], a[88:91], v[176:179]
ds_read_b64_tr_b16 a[202:203], v47 offset:29184
v_add_u32 v255, 13, v252
v_mfma_f32_16x16x32_bf16 v[204:207], a[88:91], a[60:63], v[204:207]
buffer_load_dwordx4 v6, s[28:31], s65 offen offset:0 lds
v_mfma_f32_16x16x32_bf16 v[208:211], a[24:27], a[60:63], v[208:211]
ds_read_b64_tr_b16 a[120:121], v47 offset:32768
ds_read_b64_tr_b16 a[132:133], v39 offset:24576
v_mfma_f32_16x16x32_bf16 v[180:183], a[76:79], a[24:27], v[180:183]
ds_read_b64_tr_b16 a[122:123], v47 offset:33280
v_cndmask_b32 v231, v254, 0, vcc
v_mfma_f32_16x16x32_bf16 v[156:159], a[100:103], a[24:27], v[156:159]
ds_read_b128 a[228:231], v13 offset:40960
v_cndmask_b32 v253, 0, v253, vcc
v_mfma_f32_16x16x32_bf16 v[128:131], a[24:27], a[52:55], v[128:131]
buffer_load_dwordx4 v7, s[28:31], s65 offen offset:1024 lds
v_mfma_f32_16x16x32_bf16 v[100:103], a[48:51], a[24:27], v[100:103]
s_add_u32 m0, s69, 0
ds_read_b128 a[212:215], v13 offset:32768
v_mfma_f32_16x16x32_bf16 v[76:79], a[36:39], a[24:27], v[76:79]
ds_read_b128 a[84:87], v13 offset:45056
v_cmp_gt_u32 vcc, 8, v255
v_mfma_f32_16x16x32_bf16 v[80:83], a[36:39], a[68:71], v[80:83]
ds_read_b128 a[192:195], v13 offset:36864
v_or_b32 v245, v245, v253
v_mfma_f32_16x16x32_bf16 v[104:107], a[48:51], a[68:71], v[104:107]
buffer_load_dwordx4 v8, s[28:31], s65 offen offset:0 lds
v_mfma_f32_16x16x32_bf16 v[132:135], a[68:71], a[52:55], v[132:135]
s_and_b32 s97, s70, 7
s_xor_b32 s97, s97, 6
v_mfma_f32_16x16x32_bf16 v[160:163], a[100:103], a[68:71], v[160:163]
s_mul_i32 s66, s97, 196608
s_add_u32 m0, s68, 98304
v_mfma_f32_16x16x32_bf16 v[184:187], a[76:79], a[68:71], v[184:187]
ds_read_b128 a[116:119], v22 offset:0
ds_read_b64_tr_b16 a[136:137], v41 offset:24576
v_mfma_f32_16x16x32_bf16 v[212:215], a[68:71], a[60:63], v[212:215]
buffer_load_dwordx4 v9, s[32:35], s66 offen offset:0 lds
v_add_u32 v255, 5, v252
v_mfma_f32_16x16x32_bf16 v[216:219], a[56:59], a[60:63], v[216:219]
ds_read_b128 a[124:127], v17 offset:28672
v_cndmask_b32 v235, v254, 0, vcc
v_mfma_f32_16x16x32_bf16 v[188:191], a[76:79], a[56:59], v[188:191]
ds_read_b128 a[216:219], v21 offset:512
s_and_b64 vcc, vcc, s[8:9]
v_mfma_f32_16x16x32_bf16 v[164:167], a[100:103], a[56:59], v[164:167]
ds_read_b128 a[196:199], v19 offset:28672
v_cndmask_b32 v243, v254, 0, vcc
v_mfma_f32_16x16x32_bf16 v[136:139], a[56:59], a[52:55], v[136:139]
buffer_load_dwordx4 v10, s[32:35], s66 offen offset:1024 lds
v_mfma_f32_16x16x32_bf16 v[108:111], a[48:51], a[56:59], v[108:111]
v_cmp_gt_u32 vcc, 8, v255
s_nop 1
s_and_b64 vcc, vcc, s[10:11]
v_mfma_f32_16x16x32_bf16 v[84:87], a[36:39], a[56:59], v[84:87]
v_cndmask_b32 v239, v254, 0, vcc
v_mfma_f32_16x16x32_bf16 v[112:115], a[48:51], a[64:67], v[112:115]
ds_read_b64_tr_b16 a[140:141], v43 offset:24576
v_mfma_f32_16x16x32_bf16 v[140:143], a[64:67], a[52:55], v[140:143]
buffer_load_dwordx4 v11, s[32:35], s66 offen offset:2048 lds
v_mfma_f32_16x16x32_bf16 v[192:195], a[76:79], a[64:67], v[192:195]
v_not_b32 v246, v244
v_mfma_f32_16x16x32_bf16 v[220:223], a[64:67], a[60:63], v[220:223]
v_not_b32 v247, v245
v_mfma_f32_16x16x32_bf16 v[224:227], a[92:95], a[72:75], v[224:227]
s_waitcnt lgkmcnt(1)
s_barrier
s_waitcnt lgkmcnt(0)
v_mfma_f32_16x16x32_bf16 v[64:67], a[96:99], a[80:83], v[64:67]
s_add_u32 s66, s66, 98304
s_add_u32 m0, s68, 110592
v_mfma_f32_16x16x32_bf16 v[88:91], a[108:111], a[80:83], v[88:91]
ds_read_b64_tr_b16 a[220:221], v46 offset:36864
s_and_b32 s7, s72, 30
v_mfma_f32_16x16x32_bf16 v[116:119], a[80:83], a[112:115], v[116:119]
buffer_load_dwordx4 v9, s[32:35], s66 offen offset:0 lds
v_mfma_f32_16x16x32_bf16 v[144:147], a[224:227], a[80:83], v[144:147]
ds_read_b64_tr_b16 a[222:223], v46 offset:37376
s_mul_i32 s4, s7, 684
v_mfma_f32_16x16x32_bf16 v[168:171], a[200:203], a[80:83], v[168:171]
ds_read_b128 a[204:207], v14 offset:28672
s_add_u32 s5, s4, 1197
v_mfma_f32_16x16x32_bf16 v[196:199], a[80:83], a[120:123], v[196:199]
ds_read_b64_tr_b16 a[232:233], v46 offset:40960
s_lshr_b32 s4, s4, 11
v_mfma_f32_16x16x32_bf16 v[200:203], a[228:231], a[120:123], v[200:203]
ds_read_b64_tr_b16 a[234:235], v46 offset:41472
s_lshr_b32 s5, s5, 11
v_mfma_f32_16x16x32_bf16 v[172:175], a[200:203], a[228:231], v[172:175]
ds_read_b64_tr_b16 a[236:237], v46 offset:45056
s_and_b32 s27, s63, 1
v_mfma_f32_16x16x32_bf16 v[148:151], a[224:227], a[228:231], v[148:151]
ds_read_b64_tr_b16 a[238:239], v46 offset:45568
s_lshl_b32 s27, s27, 2
v_mfma_f32_16x16x32_bf16 v[120:123], a[228:231], a[112:115], v[120:123]
buffer_load_dwordx4 v10, s[32:35], s66 offen offset:1024 lds
v_mfma_f32_16x16x32_bf16 v[92:95], a[108:111], a[228:231], v[92:95]
ds_read_b64_tr_b16 a[44:45], v47 offset:36864
s_add_u32 s27, s27, s60
v_mfma_f32_16x16x32_bf16 v[68:71], a[96:99], a[228:231], v[68:71]
ds_read_b64_tr_b16 a[46:47], v47 offset:37376
s_lshl_b32 s27, 1, s27
v_mfma_f32_16x16x32_bf16 v[72:75], a[96:99], a[212:215], v[72:75]
ds_read_b64_tr_b16 a[28:29], v47 offset:40960
s_or_b32 s27, s27, 7
v_mfma_f32_16x16x32_bf16 v[96:99], a[108:111], a[212:215], v[96:99]
ds_read_b64_tr_b16 a[30:31], v47 offset:41472
v_mfma_f32_16x16x32_bf16 v[124:127], a[212:215], a[112:115], v[124:127]
ds_read_b64_tr_b16 a[244:245], v47 offset:45056
v_mfma_f32_16x16x32_bf16 v[152:155], a[224:227], a[212:215], v[152:155]
ds_read_b64_tr_b16 a[246:247], v47 offset:45568
v_mfma_f32_16x16x32_bf16 v[176:179], a[200:203], a[212:215], v[176:179]
ds_read_b128 a[8:11], v14 offset:40960
s_cmp_lg_u32 s4, s5
s_cselect_b32 s6, 0x101, 1
s_mul_i32 s27, s27, s6
s_lshl_b32 s4, s4, 3
v_mfma_f32_16x16x32_bf16 v[204:207], a[212:215], a[120:123], v[204:207]
buffer_load_dwordx4 v11, s[32:35], s66 offen offset:2048 lds
s_lshl_b32 s5, s5, 3
v_mfma_f32_16x16x32_bf16 v[208:211], a[84:87], a[120:123], v[208:211]
s_add_u32 s77, s77, 16384
s_add_u32 m0, s71, 155648
v_and_b32 v50, 7, v1
v_mfma_f32_16x16x32_bf16 v[180:183], a[200:203], a[84:87], v[180:183]
ds_read_b128 a[40:43], v14 offset:32768
v_and_b32 v53, 8, v1
v_mfma_f32_16x16x32_bf16 v[156:159], a[224:227], a[84:87], v[156:159]
ds_read_b128 a[208:211], v14 offset:45056
v_add_u32 v51, s4, v50
v_mfma_f32_16x16x32_bf16 v[128:131], a[84:87], a[112:115], v[128:131]
ds_read_b128 a[252:255], v14 offset:36864
v_add_u32 v52, s5, v50
v_mfma_f32_16x16x32_bf16 v[100:103], a[108:111], a[84:87], v[100:103]
ds_read_b128 a[240:243], v23 offset:0
v_cmp_eq_u32 vcc, 0, v53
v_mfma_f32_16x16x32_bf16 v[76:79], a[96:99], a[84:87], v[76:79]
ds_read_b128 a[248:251], v18 offset:28672
s_mul_i32 s4, s7, 748
v_mfma_f32_16x16x32_bf16 v[80:83], a[96:99], a[192:195], v[80:83]
ds_read_b128 a[16:19], v21 offset:576
s_add_u32 s5, s4, 1309
v_mfma_f32_16x16x32_bf16 v[104:107], a[108:111], a[192:195], v[104:107]
buffer_load_dwordx4 v12, s[44:47], s77 offen offset:0 lds
v_cndmask_b32 v51, v52, v51, vcc
v_mfma_f32_16x16x32_bf16 v[132:135], a[192:195], a[112:115], v[132:135]
ds_read_b128 a[4:7], v20 offset:28672
s_lshr_b32 s4, s4, 11
v_mfma_f32_16x16x32_bf16 v[160:163], a[224:227], a[192:195], v[160:163]
s_lshr_b32 s5, s5, 11
s_lshl_b32 s7, s60, 3
v_mfma_f32_16x16x32_bf16 v[184:187], a[200:203], a[192:195], v[184:187]
s_lshr_b32 s7, 0x60380e03, s7
s_and_b32 s7, s7, 0xff
v_mfma_f32_16x16x32_bf16 v[212:215], a[192:195], a[120:123], v[212:215]
s_cmp_lg_u32 s4, s5
s_cselect_b32 s6, 0x101, 1
v_mfma_f32_16x16x32_bf16 v[216:219], a[116:119], a[120:123], v[216:219]
s_mul_i32 s7, s7, s6
v_mfma_f32_16x16x32_bf16 v[188:191], a[200:203], a[116:119], v[188:191]
s_lshl_b32 s7, s7, 16
v_mfma_f32_16x16x32_bf16 v[164:167], a[224:227], a[116:119], v[164:167]
s_or_b32 s27, s27, s7
v_mfma_f32_16x16x32_bf16 v[136:139], a[116:119], a[112:115], v[136:139]
buffer_load_dwordx4 v0, s[44:47], s77 offen offset:1024 lds
v_mfma_f32_16x16x32_bf16 v[108:111], a[108:111], a[116:119], v[108:111]
s_mul_i32 s4, s4, 14
s_mul_i32 s5, s5, 14
v_mfma_f32_16x16x32_bf16 v[84:87], a[96:99], a[116:119], v[84:87]
s_and_b32 s6, s63, 1
v_mfma_f32_16x16x32_bf16 v[112:115], a[108:111], a[124:127], v[112:115]
s_mul_i32 s6, s6, 7
v_mfma_f32_16x16x32_bf16 v[140:143], a[124:127], a[112:115], v[140:143]
s_add_u32 s6, s6, 88
v_mfma_f32_16x16x32_bf16 v[192:195], a[200:203], a[124:127], v[192:195]
s_add_u32 s4, s4, s6
v_mfma_f32_16x16x32_bf16 v[220:223], a[124:127], a[120:123], v[220:223]
s_add_u32 s5, s5, s6
v_mfma_f32_16x16x32_bf16 v[224:227], a[216:219], a[196:199], v[224:227]
s_waitcnt vmcnt(18) lgkmcnt(0)
s_barrier
v_mfma_f32_16x16x32_bf16 v[64:67], a[220:223], a[204:207], v[64:67]
s_and_b32 s97, s70, 7
Q_T1:
s_cbranch_execz Q_Tret
s_xor_b32 s97, s97, 7
v_mfma_f32_16x16x32_bf16 v[88:91], a[232:235], a[204:207], v[88:91]
s_mul_i32 s65, s97, 128
s_add_u32 m0, s67, 28672
v_mfma_f32_16x16x32_bf16 v[116:119], a[204:207], a[236:239], v[116:119]
buffer_load_dwordx4 v2, s[28:31], s65 offen offset:0 lds
v_mfma_f32_16x16x32_bf16 v[144:147], a[44:47], a[204:207], v[144:147]
ds_read_b64_tr_b16 a[0:1], v44 offset:36864
v_min_u32 v50, 6, v50
v_mfma_f32_16x16x32_bf16 v[168:171], a[28:31], a[204:207], v[168:171]
ds_read_b64_tr_b16 a[2:3], v44 offset:37376
v_add_u32 v52, s4, v50
v_mfma_f32_16x16x32_bf16 v[196:199], a[204:207], a[244:247], v[196:199]
buffer_load_dwordx4 v3, s[28:31], s65 offen offset:1024 lds
v_mfma_f32_16x16x32_bf16 v[200:203], a[8:11], a[244:247], v[200:203]
ds_read_b128 a[32:35], v22 offset:8192
v_add_u32 v53, s5, v50
v_mfma_f32_16x16x32_bf16 v[172:175], a[28:31], a[8:11], v[172:175]
ds_read_b64_tr_b16 a[12:13], v44 offset:40960
v_cndmask_b32 v52, v53, v52, vcc
v_mfma_f32_16x16x32_bf16 v[148:151], a[44:47], a[8:11], v[148:151]
ds_read_b64_tr_b16 a[14:15], v44 offset:41472
v_cmp_gt_u32 vcc, 16, v1
v_mfma_f32_16x16x32_bf16 v[120:123], a[8:11], a[236:239], v[120:123]
buffer_load_dwordx4 v4, s[28:31], s65 offen offset:2048 lds
v_mfma_f32_16x16x32_bf16 v[92:95], a[232:235], a[8:11], v[92:95]
ds_read_b64_tr_b16 a[20:21], v44 offset:45056
s_xor_b32 s7, s63, 1
v_mfma_f32_16x16x32_bf16 v[68:71], a[220:223], a[8:11], v[68:71]
ds_read_b64_tr_b16 a[22:23], v44 offset:45568
s_and_b32 s6, s7, 1
v_mfma_f32_16x16x32_bf16 v[72:75], a[220:223], a[40:43], v[72:75]
ds_read_b64_tr_b16 a[104:105], v45 offset:36864
s_and_b32 s5, s7, 6
v_mfma_f32_16x16x32_bf16 v[96:99], a[232:235], a[40:43], v[96:99]
buffer_load_dwordx4 v5, s[28:31], s65 offen offset:3072 lds
v_mfma_f32_16x16x32_bf16 v[124:127], a[40:43], a[236:239], v[124:127]
s_add_u32 m0, s67, 32768
ds_read_b64_tr_b16 a[106:107], v45 offset:37376
s_mul_i32 s4, s6, 6
v_mfma_f32_16x16x32_bf16 v[152:155], a[44:47], a[40:43], v[152:155]
ds_read_b64_tr_b16 a[88:89], v45 offset:40960
s_add_u32 s4, s4, s64
v_mfma_f32_16x16x32_bf16 v[176:179], a[28:31], a[40:43], v[176:179]
ds_read_b64_tr_b16 a[90:91], v45 offset:41472
s_add_u32 s6, s6, s64
v_mfma_f32_16x16x32_bf16 v[204:207], a[40:43], a[244:247], v[204:207]
buffer_load_dwordx4 v6, s[28:31], s65 offen offset:0 lds
v_mfma_f32_16x16x32_bf16 v[208:211], a[208:211], a[244:247], v[208:211]
ds_read_b64_tr_b16 a[24:25], v45 offset:45056
v_mfma_f32_16x16x32_bf16 v[180:183], a[28:31], a[208:211], v[180:183]
ds_read_b64_tr_b16 a[26:27], v45 offset:45568
v_mfma_f32_16x16x32_bf16 v[156:159], a[44:47], a[208:211], v[156:159]
ds_read_b128 a[68:71], v22 offset:20480
v_mfma_f32_16x16x32_bf16 v[128:131], a[208:211], a[236:239], v[128:131]
buffer_load_dwordx4 v7, s[28:31], s65 offen offset:1024 lds
v_mfma_f32_16x16x32_bf16 v[100:103], a[232:235], a[208:211], v[100:103]
s_add_u32 m0, s69, 28672
ds_read_b128 a[100:103], v22 offset:12288
v_mfma_f32_16x16x32_bf16 v[76:79], a[220:223], a[208:211], v[76:79]
ds_read_b128 a[36:39], v22 offset:24576
v_mfma_f32_16x16x32_bf16 v[80:83], a[220:223], a[252:255], v[80:83]
ds_read_b128 a[56:59], v22 offset:16384
v_mfma_f32_16x16x32_bf16 v[104:107], a[232:235], a[252:255], v[104:107]
buffer_load_dwordx4 v8, s[28:31], s65 offen offset:0 lds
v_mfma_f32_16x16x32_bf16 v[132:135], a[252:255], a[236:239], v[132:135]
s_and_b32 s97, s70, 7
s_xor_b32 s97, s97, 7
s_cmp_ge_u32 s6, 6
s_cselect_b32 s6, 6, 0
s_addc_u32 s5, s5, 0
s_sub_u32 s4, s4, s6
s_lshl_b32 s4, s4, 3
s_add_u32 s4, s4, s5
v_cndmask_b32 v51, v52, v51, vcc
v_mfma_f32_16x16x32_bf16 v[160:163], a[44:47], a[252:255], v[160:163]
s_mul_i32 s66, s97, 196608
s_add_u32 m0, s68, 122880
v_mfma_f32_16x16x32_bf16 v[184:187], a[28:31], a[252:255], v[184:187]
ds_read_b128 a[48:51], v22 offset:28672
v_mov_b32 v50, s98
v_mfma_f32_16x16x32_bf16 v[212:215], a[252:255], a[244:247], v[212:215]
buffer_load_dwordx4 v9, s[32:35], s66 offen offset:0 lds
v_mov_b32 v53, s4
v_mfma_f32_16x16x32_bf16 v[216:219], a[240:243], a[244:247], v[216:219]
ds_read_b128 a[52:55], v24 offset:8192
v_cmp_gt_u32 vcc, 48, v1
v_mfma_f32_16x16x32_bf16 v[188:191], a[28:31], a[240:243], v[188:191]
ds_read_b128 a[76:79], v21 offset:640
v_cndmask_b32 v50, v50, v53, vcc
v_mfma_f32_16x16x32_bf16 v[164:167], a[44:47], a[240:243], v[164:167]
ds_read_b128 a[64:67], v25 offset:8192
v_cmp_gt_u32 vcc, 32, v1
v_mfma_f32_16x16x32_bf16 v[136:139], a[240:243], a[236:239], v[136:139]
buffer_load_dwordx4 v10, s[32:35], s66 offen offset:1024 lds
v_mfma_f32_16x16x32_bf16 v[108:111], a[232:235], a[240:243], v[108:111]
v_cndmask_b32 v50, v50, v51, vcc
v_lshlrev_b32 v30, 7, v50
v_mfma_f32_16x16x32_bf16 v[84:87], a[220:223], a[240:243], v[84:87]
v_and_b32 v48, 31, v50
v_lshrrev_b32 v50, 5, v50
v_mfma_f32_16x16x32_bf16 v[112:115], a[232:235], a[248:251], v[112:115]
v_lshlrev_b32 v49, 3, v50
v_mfma_f32_16x16x32_bf16 v[140:143], a[248:251], a[236:239], v[140:143]
buffer_load_dwordx4 v11, s[32:35], s66 offen offset:2048 lds
v_mfma_f32_16x16x32_bf16 v[192:195], a[28:31], a[248:251], v[192:195]
buffer_load_dwordx2 v[28:29], v49, s[56:59], 0 offen sc1
v_mfma_f32_16x16x32_bf16 v[220:223], a[248:251], a[244:247], v[220:223]
v_mfma_f32_16x16x32_bf16 v[224:227], a[16:19], a[4:7], v[224:227]
s_waitcnt vmcnt(11) lgkmcnt(0)
s_barrier
v_mfma_f32_16x16x32_bf16 v[64:67], a[0:3], a[32:35], v[64:67]
s_add_u32 s66, s66, 98304
s_add_u32 m0, s68, 73728
v_mfma_f32_16x16x32_bf16 v[88:91], a[12:15], a[32:35], v[88:91]
ds_read_b64_tr_b16 a[60:61], v46 offset:0
v_mfma_f32_16x16x32_bf16 v[116:119], a[32:35], a[20:23], v[116:119]
buffer_load_dwordx4 v9, s[32:35], s66 offen offset:0 lds
v_mfma_f32_16x16x32_bf16 v[144:147], a[104:107], a[32:35], v[144:147]
ds_read_b64_tr_b16 a[62:63], v46 offset:512
v_mfma_f32_16x16x32_bf16 v[168:171], a[88:91], a[32:35], v[168:171]
ds_read_b128 a[92:95], v23 offset:8192
v_mfma_f32_16x16x32_bf16 v[196:199], a[32:35], a[24:27], v[196:199]
ds_read_b64_tr_b16 a[72:73], v46 offset:4096
v_mfma_f32_16x16x32_bf16 v[200:203], a[68:71], a[24:27], v[200:203]
ds_read_b64_tr_b16 a[74:75], v46 offset:4608
v_mfma_f32_16x16x32_bf16 v[172:175], a[88:91], a[68:71], v[172:175]
ds_read_b64_tr_b16 a[80:81], v46 offset:8192
v_mfma_f32_16x16x32_bf16 v[148:151], a[104:107], a[68:71], v[148:151]
ds_read_b64_tr_b16 a[82:83], v46 offset:8704
v_mfma_f32_16x16x32_bf16 v[120:123], a[68:71], a[20:23], v[120:123]
ds_read_b64_tr_b16 a[228:229], v47 offset:0
ds_read_b64_tr_b16 a[130:131], v37 offset:24576
v_mfma_f32_16x16x32_bf16 v[92:95], a[12:15], a[68:71], v[92:95]
ds_read_b64_tr_b16 a[230:231], v47 offset:512
v_mfma_f32_16x16x32_bf16 v[68:71], a[0:3], a[68:71], v[68:71]
ds_read_b64_tr_b16 a[212:213], v47 offset:4096
v_mfma_f32_16x16x32_bf16 v[72:75], a[0:3], a[100:103], v[72:75]
ds_read_b64_tr_b16 a[214:215], v47 offset:4608
v_mfma_f32_16x16x32_bf16 v[96:99], a[12:15], a[100:103], v[96:99]
ds_read_b64_tr_b16 a[84:85], v47 offset:8192
v_mfma_f32_16x16x32_bf16 v[124:127], a[100:103], a[20:23], v[124:127]
ds_read_b64_tr_b16 a[86:87], v47 offset:8704
v_mfma_f32_16x16x32_bf16 v[152:155], a[104:107], a[100:103], v[152:155]
buffer_load_dwordx4 v10, s[32:35], s66 offen offset:1024 lds
v_mfma_f32_16x16x32_bf16 v[176:179], a[88:91], a[100:103], v[176:179]
ds_read_b128 a[192:195], v23 offset:20480
v_mfma_f32_16x16x32_bf16 v[204:207], a[100:103], a[24:27], v[204:207]
ds_read_b128 a[224:227], v23 offset:12288
v_mfma_f32_16x16x32_bf16 v[208:211], a[36:39], a[24:27], v[208:211]
ds_read_b128 a[96:99], v23 offset:24576
ds_read_b64_tr_b16 a[134:135], v39 offset:24576
v_mfma_f32_16x16x32_bf16 v[180:183], a[88:91], a[36:39], v[180:183]
ds_read_b128 a[116:119], v23 offset:16384
v_mfma_f32_16x16x32_bf16 v[156:159], a[104:107], a[36:39], v[156:159]
ds_read_b128 a[108:111], v23 offset:28672
v_mfma_f32_16x16x32_bf16 v[128:131], a[36:39], a[20:23], v[128:131]
ds_read_b128 a[112:115], v26 offset:8192
v_mfma_f32_16x16x32_bf16 v[100:103], a[12:15], a[36:39], v[100:103]
ds_read_b128 a[200:203], v21 offset:704
v_mfma_f32_16x16x32_bf16 v[76:79], a[0:3], a[36:39], v[76:79]
ds_read_b128 a[124:127], v27 offset:8192
v_mfma_f32_16x16x32_bf16 v[80:83], a[0:3], a[56:59], v[80:83]
ds_read_b128 a[120:123], v21 offset:768
v_mfma_f32_16x16x32_bf16 v[104:107], a[12:15], a[56:59], v[104:107]
v_mfma_f32_16x16x32_bf16 v[132:135], a[56:59], a[20:23], v[132:135]
v_mfma_f32_16x16x32_bf16 v[160:163], a[104:107], a[56:59], v[160:163]
ds_read_b64_tr_b16 a[138:139], v41 offset:24576
v_mfma_f32_16x16x32_bf16 v[184:187], a[88:91], a[56:59], v[184:187]
buffer_load_dwordx4 v11, s[32:35], s66 offen offset:2048 lds
v_mfma_f32_16x16x32_bf16 v[212:215], a[56:59], a[24:27], v[212:215]
v_mfma_f32_16x16x32_bf16 v[216:219], a[48:51], a[24:27], v[216:219]
v_mfma_f32_16x16x32_bf16 v[188:191], a[88:91], a[48:51], v[188:191]
v_mfma_f32_16x16x32_bf16 v[164:167], a[104:107], a[48:51], v[164:167]
v_mfma_f32_16x16x32_bf16 v[136:139], a[48:51], a[20:23], v[136:139]
v_mfma_f32_16x16x32_bf16 v[108:111], a[12:15], a[48:51], v[108:111]
v_mfma_f32_16x16x32_bf16 v[84:87], a[0:3], a[48:51], v[84:87]
v_mfma_f32_16x16x32_bf16 v[112:115], a[12:15], a[52:55], v[112:115]
ds_read_b64_tr_b16 a[142:143], v43 offset:24576
v_mfma_f32_16x16x32_bf16 v[140:143], a[52:55], a[20:23], v[140:143]
v_mfma_f32_16x16x32_bf16 v[192:195], a[88:91], a[52:55], v[192:195]
v_mfma_f32_16x16x32_bf16 v[220:223], a[52:55], a[24:27], v[220:223]
v_mfma_f32_16x16x32_bf16 v[224:227], a[76:79], a[64:67], v[224:227]
s_waitcnt vmcnt(3) lgkmcnt(1)
s_barrier
s_waitcnt lgkmcnt(0)
s_mov_b32 s4, 0
Q_tag:
v_cmp_eq_u32 vcc, 0, v29
s_nop 1
s_cmp_eq_u64 vcc, 0
s_cbranch_scc1 Q_tagok
buffer_load_dwordx2 v[28:29], v49, s[56:59], 0 offen sc1
s_add_u32 s4, s4, 1
s_waitcnt vmcnt(0)
s_cmp_lt_u32 s4, 0x8000
s_cbranch_scc1 Q_tag
Q_tagok:
v_lshrrev_b32 v28, v48, v28
v_and_b32 v28, 1, v28
v_or_b32 v29, 2, v28
v_mfma_f32_16x16x32_bf16 v[64:67], a[60:63], a[92:95], v[64:67]
s_lshl_b32 s77, s75, 4
s_add_u32 m0, s71, 57344
v_mfma_f32_16x16x32_bf16 v[88:91], a[72:75], a[92:95], v[88:91]
ds_read_b128 a[216:219], v19 offset:0
v_mfma_f32_16x16x32_bf16 v[116:119], a[92:95], a[80:83], v[116:119]
buffer_load_dwordx4 v12, s[44:47], s77 offen offset:0 lds
v_mfma_f32_16x16x32_bf16 v[144:147], a[228:231], a[92:95], v[144:147]
ds_read_b64_tr_b16 a[196:197], v46 offset:16384
v_mfma_f32_16x16x32_bf16 v[168:171], a[212:215], a[92:95], v[168:171]
ds_read_b64_tr_b16 a[198:199], v46 offset:16896
v_mfma_f32_16x16x32_bf16 v[196:199], a[92:95], a[84:87], v[196:199]
buffer_load_dwordx4 v0, s[44:47], s77 offen offset:1024 lds
v_mfma_f32_16x16x32_bf16 v[200:203], a[192:195], a[84:87], v[200:203]
s_add_u32 s77, s77, 16384
s_add_u32 m0, s71, 65536
v_mfma_f32_16x16x32_bf16 v[172:175], a[212:215], a[192:195], v[172:175]
ds_read_b128 a[204:207], v17 offset:0
v_mfma_f32_16x16x32_bf16 v[148:151], a[228:231], a[192:195], v[148:151]
ds_read_b64_tr_b16 a[8:9], v46 offset:20480
v_mfma_f32_16x16x32_bf16 v[120:123], a[192:195], a[80:83], v[120:123]
buffer_load_dwordx4 v12, s[44:47], s77 offen offset:0 lds
v_mfma_f32_16x16x32_bf16 v[92:95], a[72:75], a[192:195], v[92:95]
ds_read_b64_tr_b16 a[10:11], v46 offset:20992
v_mfma_f32_16x16x32_bf16 v[68:71], a[60:63], a[192:195], v[68:71]
ds_read_b64_tr_b16 a[40:41], v47 offset:16384
v_mfma_f32_16x16x32_bf16 v[72:75], a[60:63], a[224:227], v[72:75]
ds_read_b64_tr_b16 a[42:43], v47 offset:16896
v_mfma_f32_16x16x32_bf16 v[96:99], a[72:75], a[224:227], v[96:99]
buffer_load_dwordx4 v0, s[44:47], s77 offen offset:1024 lds
v_mfma_f32_16x16x32_bf16 v[124:127], a[224:227], a[80:83], v[124:127]
s_lshl_b32 s77, s76, 4
s_add_u32 m0, s71, 73728
v_mfma_f32_16x16x32_bf16 v[152:155], a[228:231], a[224:227], v[152:155]
ds_read_b64_tr_b16 a[208:209], v47 offset:20480
v_mfma_f32_16x16x32_bf16 v[176:179], a[212:215], a[224:227], v[176:179]
ds_read_b64_tr_b16 a[210:211], v47 offset:20992
v_mfma_f32_16x16x32_bf16 v[204:207], a[224:227], a[84:87], v[204:207]
buffer_load_dwordx4 v12, s[48:51], s77 offen offset:0 lds
v_mfma_f32_16x16x32_bf16 v[208:211], a[96:99], a[84:87], v[208:211]
ds_read_b64_tr_b16 a[252:253], v46 offset:12288
v_mfma_f32_16x16x32_bf16 v[180:183], a[212:215], a[96:99], v[180:183]
ds_read_b64_tr_b16 a[254:255], v46 offset:12800
v_mfma_f32_16x16x32_bf16 v[156:159], a[228:231], a[96:99], v[156:159]
ds_read_b128 a[44:47], v13 offset:0
v_mfma_f32_16x16x32_bf16 v[128:131], a[96:99], a[80:83], v[128:131]
buffer_load_dwordx4 v0, s[48:51], s77 offen offset:1024 lds
v_mfma_f32_16x16x32_bf16 v[100:103], a[72:75], a[96:99], v[100:103]
s_add_u32 s77, s77, 16384
s_add_u32 m0, s71, 98304
v_mfma_f32_16x16x32_bf16 v[76:79], a[60:63], a[96:99], v[76:79]
ds_read_b64_tr_b16 a[220:221], v47 offset:12288
v_mfma_f32_16x16x32_bf16 v[80:83], a[60:63], a[116:119], v[80:83]
ds_read_b64_tr_b16 a[222:223], v47 offset:12800
v_mfma_f32_16x16x32_bf16 v[104:107], a[72:75], a[116:119], v[104:107]
buffer_load_dwordx4 v12, s[48:51], s77 offen offset:0 lds
v_mfma_f32_16x16x32_bf16 v[132:135], a[116:119], a[80:83], v[132:135]
ds_read_b128 a[240:243], v21 offset:832
v_mfma_f32_16x16x32_bf16 v[160:163], a[228:231], a[116:119], v[160:163]
ds_read_b128 a[232:235], v20 offset:0
v_mfma_f32_16x16x32_bf16 v[184:187], a[212:215], a[116:119], v[184:187]
ds_read_b64_tr_b16 a[236:237], v46 offset:28672
v_mfma_f32_16x16x32_bf16 v[212:215], a[116:119], a[84:87], v[212:215]
buffer_load_dwordx4 v0, s[48:51], s77 offen offset:1024 lds
v_mfma_f32_16x16x32_bf16 v[216:219], a[108:111], a[84:87], v[216:219]
s_lshl_b32 s77, s78, 4
s_add_u32 m0, s71, 155648
v_mfma_f32_16x16x32_bf16 v[188:191], a[212:215], a[108:111], v[188:191]
ds_read_b64_tr_b16 a[238:239], v46 offset:29184
v_mfma_f32_16x16x32_bf16 v[164:167], a[228:231], a[108:111], v[164:167]
ds_read_b128 a[28:31], v18 offset:0
v_mfma_f32_16x16x32_bf16 v[136:139], a[108:111], a[80:83], v[136:139]
buffer_load_dwordx4 v12, s[48:51], s77 offen offset:0 lds
v_mfma_f32_16x16x32_bf16 v[108:111], a[72:75], a[108:111], v[108:111]
ds_read_b64_tr_b16 a[248:249], v46 offset:32768
v_mfma_f32_16x16x32_bf16 v[84:87], a[60:63], a[108:111], v[84:87]
ds_read_b64_tr_b16 a[250:251], v46 offset:33280
v_mfma_f32_16x16x32_bf16 v[112:115], a[72:75], a[112:115], v[112:115]
ds_read_b64_tr_b16 a[244:245], v47 offset:28672
v_mfma_f32_16x16x32_bf16 v[140:143], a[112:115], a[80:83], v[140:143]
buffer_load_dwordx4 v0, s[48:51], s77 offen offset:1024 lds
v_mfma_f32_16x16x32_bf16 v[192:195], a[212:215], a[112:115], v[192:195]
ds_read_b64_tr_b16 a[246:247], v47 offset:29184
v_mfma_f32_16x16x32_bf16 v[220:223], a[112:115], a[84:87], v[220:223]
ds_read_b64_tr_b16 a[16:17], v47 offset:32768
v_mfma_f32_16x16x32_bf16 v[224:227], a[200:203], a[124:127], v[224:227]
ds_read_b64_tr_b16 a[18:19], v47 offset:33280
s_waitcnt vmcnt(10) lgkmcnt(6)
s_barrier
v_mfma_f32_16x16x32_bf16 v[224:227], a[120:123], a[216:219], v[224:227]
s_add_u32 s77, s77, 16384
s_add_u32 m0, s71, 106496
v_mfma_f32_16x16x32_bf16 v[112:115], a[196:199], a[204:207], v[112:115]
ds_read_b64_tr_b16 a[4:5], v46 offset:24576
ds_read_b64_tr_b16 a[6:7], v46 offset:25088
v_mfma_f32_16x16x32_bf16 v[140:143], a[204:207], a[8:11], v[140:143]
buffer_load_dwordx4 v12, s[48:51], s77 offen offset:0 lds
v_mfma_f32_16x16x32_bf16 v[192:195], a[40:43], a[204:207], v[192:195]
ds_read_b128 a[32:35], v14 offset:0
ds_read_b64_tr_b16 a[68:69], v47 offset:24576
v_mfma_f32_16x16x32_bf16 v[220:223], a[204:207], a[208:211], v[220:223]
ds_read_b64_tr_b16 a[70:71], v47 offset:25088
ds_read_b128 a[100:103], v21 offset:896
v_mfma_f32_16x16x32_bf16 v[64:67], a[252:255], a[44:47], v[64:67]
ds_read_b128 a[36:39], v19 offset:28672
ds_read_b64_tr_b16 a[56:57], v46 offset:40960
v_mfma_f32_16x16x32_bf16 v[88:91], a[196:199], a[44:47], v[88:91]
ds_read_b64_tr_b16 a[58:59], v46 offset:41472
ds_read_b128 a[104:107], v17 offset:28672
v_mfma_f32_16x16x32_bf16 v[116:119], a[44:47], a[8:11], v[116:119]
ds_read_b64_tr_b16 a[0:1], v46 offset:45056
ds_read_b64_tr_b16 a[2:3], v46 offset:45568
v_mfma_f32_16x16x32_bf16 v[144:147], a[220:223], a[44:47], v[144:147]
ds_read_b64_tr_b16 a[48:49], v47 offset:40960
ds_read_b64_tr_b16 a[50:51], v47 offset:41472
v_mfma_f32_16x16x32_bf16 v[168:171], a[40:43], a[44:47], v[168:171]
ds_read_b64_tr_b16 a[12:13], v47 offset:45056
ds_read_b64_tr_b16 a[14:15], v47 offset:45568
v_mfma_f32_16x16x32_bf16 v[196:199], a[44:47], a[208:211], v[196:199]
ds_read_b64_tr_b16 a[20:21], v46 offset:36864
ds_read_b64_tr_b16 a[22:23], v46 offset:37376
v_mfma_f32_16x16x32_bf16 v[224:227], a[240:243], a[232:235], v[224:227]
ds_read_b128 a[88:91], v13 offset:28672
ds_read_b64_tr_b16 a[52:53], v47 offset:36864
v_mfma_f32_16x16x32_bf16 v[112:115], a[236:239], a[28:31], v[112:115]
buffer_load_dwordx4 v0, s[48:51], s77 offen offset:1024 lds
s_waitcnt lgkmcnt(12)
v_mfma_f32_16x16x32_bf16 v[140:143], a[28:31], a[248:251], v[140:143]
s_lshl_b32 s77, s79, 4
s_add_u32 m0, s71, 114688
v_mfma_f32_16x16x32_bf16 v[192:195], a[244:247], a[28:31], v[192:195]
ds_read_b64_tr_b16 a[54:55], v47 offset:37376
ds_read_b128 a[24:27], v21 offset:960
s_lshl_b32 s14, s2, 13
v_mfma_f32_16x16x32_bf16 v[220:223], a[28:31], a[16:19], v[220:223]
ds_read_b128 a[76:79], v20 offset:28672
ds_read_b64_tr_b16 a[64:65], v44 offset:40960
v_mfma_f32_16x16x32_bf16 v[64:67], a[4:7], a[32:35], v[64:67]
ds_read_b64_tr_b16 a[66:67], v44 offset:41472
ds_read_b128 a[92:95], v18 offset:28672
v_mfma_f32_16x16x32_bf16 v[88:91], a[236:239], a[32:35], v[88:91]
ds_read_b64_tr_b16 a[192:193], v44 offset:45056
ds_read_b64_tr_b16 a[194:195], v44 offset:45568
v_mfma_f32_16x16x32_bf16 v[116:119], a[32:35], a[248:251], v[116:119]
ds_read_b64_tr_b16 a[224:225], v45 offset:40960
ds_read_b64_tr_b16 a[226:227], v45 offset:41472
v_mfma_f32_16x16x32_bf16 v[144:147], a[68:71], a[32:35], v[144:147]
ds_read_b64_tr_b16 a[96:97], v45 offset:45056
ds_read_b64_tr_b16 a[98:99], v45 offset:45568
s_lshl_b32 s15, s60, 11
v_mfma_f32_16x16x32_bf16 v[168:171], a[244:247], a[32:35], v[168:171]
ds_read_b64_tr_b16 a[116:117], v44 offset:36864
ds_read_b64_tr_b16 a[118:119], v44 offset:37376
v_mfma_f32_16x16x32_bf16 v[196:199], a[32:35], a[16:19], v[196:199]
ds_read_b128 a[228:231], v14 offset:28672
ds_read_b64_tr_b16 a[60:61], v45 offset:36864
v_mfma_f32_16x16x32_bf16 v[224:227], a[100:103], a[36:39], v[224:227]
ds_read_b64_tr_b16 a[62:63], v45 offset:37376
ds_read_b128 a[108:111], v13 offset:4096
s_waitcnt lgkmcnt(14)
v_mfma_f32_16x16x32_bf16 v[112:115], a[56:59], a[104:107], v[112:115]
buffer_load_dwordx4 v12, s[48:51], s77 offen offset:0 lds
v_mfma_f32_16x16x32_bf16 v[140:143], a[104:107], a[0:3], v[140:143]
ds_read_b128 a[72:75], v14 offset:4096
ds_read_b128 a[80:83], v13 offset:32768
s_add_u32 s14, s14, s15
v_mfma_f32_16x16x32_bf16 v[192:195], a[48:51], a[104:107], v[192:195]
ds_read_b128 a[212:215], v14 offset:32768
ds_read_b128 a[112:115], v13 offset:8192
v_mfma_f32_16x16x32_bf16 v[220:223], a[104:107], a[12:15], v[220:223]
ds_read_b128 a[84:87], v14 offset:8192
ds_read_b128 a[200:203], v13 offset:36864
v_mfma_f32_16x16x32_bf16 v[64:67], a[20:23], a[88:91], v[64:67]
ds_read_b128 a[124:127], v14 offset:36864
ds_read_b128 a[120:123], v13 offset:12288
v_mfma_f32_16x16x32_bf16 v[88:91], a[56:59], a[88:91], v[88:91]
ds_read_b128 a[216:219], v14 offset:12288
ds_read_b128 a[204:207], v13 offset:40960
v_mfma_f32_16x16x32_bf16 v[116:119], a[88:91], a[0:3], v[116:119]
ds_read_b128 a[44:47], v14 offset:40960
ds_read_b128 a[240:243], v13 offset:16384
s_add_u32 s14, s14, 32768
v_mfma_f32_16x16x32_bf16 v[144:147], a[52:55], a[88:91], v[144:147]
ds_read_b128 a[232:235], v14 offset:16384
ds_read_b128 a[28:31], v13 offset:45056
v_mfma_f32_16x16x32_bf16 v[168:171], a[48:51], a[88:91], v[168:171]
ds_read_b128 a[32:35], v14 offset:45056
ds_read_b128 a[100:103], v13 offset:20480
v_mfma_f32_16x16x32_bf16 v[196:199], a[88:91], a[12:15], v[196:199]
ds_read_b128 a[36:39], v14 offset:20480
ds_read_b128 a[104:107], v22 offset:0
v_mfma_f32_16x16x32_bf16 v[224:227], a[24:27], a[76:79], v[224:227]
buffer_load_dwordx4 v0, s[48:51], s77 offen offset:1024 lds
s_waitcnt lgkmcnt(12)
v_mfma_f32_16x16x32_bf16 v[112:115], a[64:67], a[92:95], v[112:115]
ds_read_b128 a[88:91], v23 offset:0
v_lshl_add_u32 v3, v1, 4, s14
v_mfma_f32_16x16x32_bf16 v[140:143], a[92:95], a[192:195], v[140:143]
v_mov_b32 v4, -1
v_mov_b32 v5, -1
v_mfma_f32_16x16x32_bf16 v[192:195], a[224:227], a[92:95], v[192:195]
v_mov_b32 v6, -1
v_mfma_f32_16x16x32_bf16 v[220:223], a[92:95], a[96:99], v[220:223]
v_mfma_f32_16x16x32_bf16 v[64:67], a[116:119], a[228:231], v[64:67]
v_mfma_f32_16x16x32_bf16 v[88:91], a[64:67], a[228:231], v[88:91]
v_mov_b32 v7, -1
v_mfma_f32_16x16x32_bf16 v[116:119], a[228:231], a[192:195], v[116:119]
v_mfma_f32_16x16x32_bf16 v[144:147], a[60:63], a[228:231], v[144:147]
v_mfma_f32_16x16x32_bf16 v[168:171], a[224:227], a[228:231], v[168:171]
v_mfma_f32_16x16x32_bf16 v[196:199], a[228:231], a[96:99], v[196:199]
s_waitcnt vmcnt(10) lgkmcnt(0)
s_barrier
v_mfma_f32_16x16x32_bf16 v[72:75], a[252:255], a[108:111], v[72:75]
s_add_u32 s77, s77, 16384
s_add_u32 m0, s71, 0
s_nop 0
buffer_load_dwordx4 v12, s[48:51], s77 offen offset:0 lds
v_cvt_pk_bf16_f32 v64, v64, v65
v_mfma_f32_16x16x32_bf16 v[72:75], a[4:7], a[72:75], v[72:75]
v_cvt_pk_bf16_f32 v112, v112, v113
v_cvt_pk_bf16_f32 v65, v66, v67
v_cvt_pk_bf16_f32 v113, v114, v115
v_mfma_f32_16x16x32_bf16 v[72:75], a[20:23], a[80:83], v[72:75]
buffer_load_dwordx4 v0, s[48:51], s77 offen offset:1024 lds
ds_read_b64_tr_b16 a[144:145], v32 offset:57344
v_cvt_pk_bf16_f32 v66, v88, v89
v_mfma_f32_16x16x32_bf16 v[72:75], a[116:119], a[212:215], v[72:75]
s_lshl_b32 s77, s80, 4
s_add_u32 m0, s71, 8192
v_cvt_pk_bf16_f32 v67, v90, v91
v_mfma_f32_16x16x32_bf16 v[96:99], a[196:199], a[108:111], v[96:99]
buffer_load_dwordx4 v12, s[48:51], s77 offen offset:0 lds
ds_read_b64_tr_b16 a[148:149], v33 offset:57344
v_cvt_pk_bf16_f32 v144, v144, v145
v_cvt_pk_bf16_f32 v192, v192, v193
v_mfma_f32_16x16x16_bf16 v[88:91], v[66:67], v[64:65], v[228:231]
v_cvt_pk_bf16_f32 v50, v116, v117
v_cvt_pk_bf16_f32 v51, v118, v119
v_mfma_f32_16x16x16_bf16 v[116:119], v[112:113], v[64:65], v[236:239]
v_cvt_pk_bf16_f32 v145, v146, v147
v_cvt_pk_bf16_f32 v193, v194, v195
v_cvt_pk_bf16_f32 v146, v168, v169
v_mfma_f32_16x16x32_bf16 v[96:99], a[236:239], a[72:75], v[96:99]
v_cvt_pk_bf16_f32 v147, v170, v171
v_cvt_pk_bf16_f32 v58, v196, v197
v_cvt_pk_bf16_f32 v59, v198, v199
v_mfma_f32_16x16x16_bf16 v[168:171], v[146:147], v[144:145], v[228:231]
v_max_f32 v88, v88, v116
v_max_f32 v89, v89, v117
v_mfma_f32_16x16x16_bf16 v[196:199], v[192:193], v[144:145], v[236:239]
v_max_f32 v90, v90, v118
v_max_f32 v91, v91, v119
v_max3_f32 v116, v88, v89, v90
v_mfma_f32_16x16x32_bf16 v[96:99], a[56:59], a[80:83], v[96:99]
v_max_f32 v116, v116, v91
v_mul_f32 v224, 0x3fb8aa3b, v224
v_min_f32 v224, 0x42700000, v224
v_mfma_f32_16x16x32_bf16 v[96:99], a[64:67], a[212:215], v[96:99]
buffer_load_dwordx4 v0, s[48:51], s77 offen offset:1024 lds
ds_read_b64_tr_b16 a[152:153], v34 offset:57344
v_max_f32 v168, v168, v196
v_mfma_f32_16x16x32_bf16 v[124:127], a[108:111], a[8:11], v[124:127]
s_add_u32 s77, s77, 16384
s_add_u32 m0, s71, 16384
v_max_f32 v169, v169, v197
v_mfma_f32_16x16x32_bf16 v[124:127], a[72:75], a[248:251], v[124:127]
buffer_load_dwordx4 v12, s[48:51], s77 offen offset:0 lds
ds_read_b64_tr_b16 a[156:157], v35 offset:57344
v_max_f32 v170, v170, v198
v_mfma_f32_16x16x32_bf16 v[124:127], a[80:83], a[0:3], v[124:127]
v_max_f32 v171, v171, v199
v_max3_f32 v196, v168, v169, v170
v_max_f32 v196, v196, v171
v_mfma_f32_16x16x32_bf16 v[124:127], a[212:215], a[192:195], v[124:127]
v_exp_f32 v224, v224
v_cvt_pk_bf16_f32 v48, v140, v141
v_mfma_f32_16x16x32_bf16 v[152:155], a[220:223], a[108:111], v[152:155]
buffer_load_dwordx4 v0, s[48:51], s77 offen offset:1024 lds
ds_read_b64_tr_b16 a[146:147], v36 offset:0
buffer_store_dword v224, v251, s[40:43], 0 offen sc1
v_mfma_f32_16x16x32_bf16 v[152:155], a[68:71], a[72:75], v[152:155]
s_lshl_b32 s77, s81, 4
s_add_u32 m0, s71, 24576
v_permlane32_swap_b32 v116, v196
v_mfma_f32_16x16x32_bf16 v[152:155], a[52:55], a[80:83], v[152:155]
buffer_load_dwordx4 v12, s[48:51], s77 offen offset:0 lds
ds_read_b64_tr_b16 a[150:151], v38 offset:0
v_max_f32 v117, v116, v196
v_max_f32 v116, v116, v196
v_mfma_f32_16x16x32_bf16 v[152:155], a[60:63], a[212:215], v[152:155]
v_cvt_pk_bf16_f32 v49, v142, v143
v_cvt_pk_bf16_f32 v56, v220, v221
v_permlane16_swap_b32 v116, v117
v_mfma_f32_16x16x32_bf16 v[176:179], a[40:43], a[108:111], v[176:179]
buffer_load_dwordx4 v0, s[48:51], s77 offen offset:1024 lds
v_max_f32 v116, v116, v117
v_mul_f32 v196, s82, v116
v_mfma_f32_16x16x32_bf16 v[176:179], a[244:247], a[72:75], v[176:179]
s_add_u32 s77, s77, 16384
s_add_u32 m0, s71, 32768
ds_read_b64_tr_b16 a[154:155], v40 offset:0
v_mul_f32 v116, s82, v116
v_cvt_pk_bf16_f32 v57, v222, v223
v_mfma_f32_16x16x32_bf16 v[176:179], a[48:51], a[80:83], v[176:179]
v_permlane32_swap_b32 v116, v196
v_fma_f32 v88, v88, s82, -v116
v_fma_f32 v89, v89, s82, -v116
v_mfma_f32_16x16x32_bf16 v[176:179], a[224:227], a[212:215], v[176:179]
buffer_load_dwordx4 v12, s[48:51], s77 offen offset:0 lds
ds_read_b64_tr_b16 a[158:159], v42 offset:0
v_fma_f32 v90, v90, s82, -v116
v_fma_f32 v91, v91, s82, -v116
v_mfma_f32_16x16x32_bf16 v[204:207], a[108:111], a[208:211], v[204:207]
v_exp_f32 v88, v88
v_exp_f32 v89, v89
v_mfma_f32_16x16x32_bf16 v[204:207], a[72:75], a[16:19], v[204:207]
buffer_load_dwordx4 v0, s[48:51], s77 offen offset:1024 lds
v_exp_f32 v90, v90
v_mfma_f32_16x16x32_bf16 v[204:207], a[80:83], a[12:15], v[204:207]
v_exp_f32 v91, v91
v_fma_f32 v168, v168, s82, -v196
v_fma_f32 v169, v169, s82, -v196
v_mfma_f32_16x16x32_bf16 v[204:207], a[212:215], a[96:99], v[204:207]
v_fma_f32 v170, v170, s82, -v196
v_fma_f32 v171, v171, s82, -v196
v_cvt_pk_bf16_f32 v118, v88, v89
v_cvt_pk_bf16_f32 v119, v90, v91
v_exp_f32 v168, v168
v_exp_f32 v169, v169
v_mfma_f32_16x16x16_bf16 v[252:255], v[248:249], v[118:119], 0
v_exp_f32 v170, v170
v_exp_f32 v171, v171
v_and_b32 v88, v118, v246
v_and_b32 v89, v119, v247
v_and_b32 v90, v118, v244
v_and_b32 v91, v119, v245
v_cvt_pk_bf16_f32 v198, v168, v169
v_cvt_pk_bf16_f32 v199, v170, v171
v_mfma_f32_16x16x32_bf16 v[116:119], v[48:51], v[88:91], 0
v_and_b32 v168, v198, v246
v_and_b32 v169, v199, v247
v_mfma_f32_16x16x16_bf16 v[224:227], v[248:249], v[198:199], 0
v_and_b32 v170, v198, v244
v_and_b32 v171, v199, v245
s_nop 1
v_mfma_f32_16x16x32_bf16 v[196:199], v[56:59], v[168:171], 0
s_waitcnt vmcnt(17)
s_waitcnt lgkmcnt(0)
v_mfma_f32_16x16x32_bf16 v[80:83], a[252:255], a[112:115], v[80:83]
s_lshl_b32 s77, s18, 4
s_add_u32 m0, s71, 40960
v_cvt_pk_bf16_f32 v72, v72, v73
v_mfma_f32_16x16x32_bf16 v[80:83], a[4:7], a[84:87], v[80:83]
v_cvt_pk_bf16_f32 v73, v74, v75
v_cvt_pk_bf16_f32 v74, v96, v97
v_cvt_pk_bf16_f32 v75, v98, v99
v_mfma_f32_16x16x32_bf16 v[80:83], a[20:23], a[200:203], v[80:83]
buffer_load_dwordx4 v12, s[48:51], s77 offen offset:0 lds
ds_read_b64_tr_b16 a[160:161], v36 offset:8192
v_cvt_pk_bf16_f32 v152, v152, v153
v_cvt_pk_bf16_f32 v52, v124, v125
v_mfma_f32_16x16x16_bf16 v[96:99], v[74:75], v[72:73], v[228:231]
v_cvt_pk_bf16_f32 v53, v126, v127
v_cvt_pk_bf16_f32 v153, v154, v155
v_mfma_f32_16x16x16_bf16 v[124:127], v[66:67], v[72:73], v[232:235]
v_cvt_pk_bf16_f32 v154, v176, v177
v_cvt_pk_bf16_f32 v155, v178, v179
Q_T2:
s_cbranch_execz Q_Tret
v_cvt_pk_bf16_f32 v60, v204, v205
v_cvt_pk_bf16_f32 v61, v206, v207
v_mfma_f32_16x16x16_bf16 v[176:179], v[154:155], v[152:153], v[228:231]
v_rcp_f32 v252, v252
s_nop 1
v_max_f32 v96, v96, v124
v_mfma_f32_16x16x16_bf16 v[204:207], v[146:147], v[152:153], v[232:235]
v_max_f32 v97, v97, v125
v_max_f32 v98, v98, v126
v_max_f32 v99, v99, v127
v_mfma_f32_16x16x32_bf16 v[80:83], a[116:119], a[124:127], v[80:83]
v_max3_f32 v124, v96, v97, v98
v_max_f32 v124, v124, v99
v_mul_f32 v116, v116, v252
v_mfma_f32_16x16x32_bf16 v[104:107], a[196:199], a[112:115], v[104:107]
buffer_load_dwordx4 v0, s[48:51], s77 offen offset:1024 lds
ds_read_b64_tr_b16 a[164:165], v38 offset:8192
v_max_f32 v176, v176, v204
v_mfma_f32_16x16x32_bf16 v[104:107], a[236:239], a[84:87], v[104:107]
s_add_u32 s77, s77, 16384
s_add_u32 m0, s71, 49152
v_max_f32 v177, v177, v205
v_mfma_f32_16x16x32_bf16 v[104:107], a[56:59], a[200:203], v[104:107]
v_max_f32 v178, v178, v206
v_max_f32 v179, v179, v207
v_max3_f32 v204, v176, v177, v178
v_mfma_f32_16x16x32_bf16 v[104:107], a[64:67], a[124:127], v[104:107]
buffer_load_dwordx4 v12, s[48:51], s77 offen offset:0 lds
ds_read_b64_tr_b16 a[168:169], v40 offset:8192
v_max_f32 v204, v204, v179
v_mfma_f32_16x16x32_bf16 v[132:135], a[112:115], a[8:11], v[132:135]
v_mul_f32 v117, v117, v252
v_mul_f32 v118, v118, v252
v_permlane32_swap_b32 v124, v204
v_mfma_f32_16x16x32_bf16 v[132:135], a[84:87], a[248:251], v[132:135]
ds_read_b64_tr_b16 a[172:173], v42 offset:8192
v_max_f32 v125, v124, v204
v_mul_f32 v119, v119, v252
v_max_f32 v124, v124, v204
v_mfma_f32_16x16x32_bf16 v[132:135], a[200:203], a[0:3], v[132:135]
buffer_load_dwordx4 v0, s[48:51], s77 offen offset:1024 lds
v_rcp_f32 v224, v224
v_mfma_f32_16x16x32_bf16 v[132:135], a[124:127], a[192:195], v[132:135]
s_lshl_b32 s77, s19, 4
s_add_u32 m0, s71, 57344
v_cvt_pk_bf16_f32 v88, v116, v117
v_mfma_f32_16x16x32_bf16 v[160:163], a[220:223], a[112:115], v[160:163]
ds_read_b64_tr_b16 a[162:163], v36 offset:32768
v_permlane16_swap_b32 v124, v125
v_cvt_pk_bf16_f32 v89, v118, v119
v_mfma_f32_16x16x32_bf16 v[160:163], a[68:71], a[84:87], v[160:163]
buffer_load_dwordx4 v12, s[48:51], s77 offen offset:0 lds
v_max_f32 v124, v124, v125
v_mfma_f32_16x16x32_bf16 v[160:163], a[52:55], a[200:203], v[160:163]
ds_read_b64_tr_b16 a[166:167], v38 offset:32768
v_mul_f32 v204, s82, v124
v_mul_f32 v196, v196, v224
v_mul_f32 v197, v197, v224
v_mfma_f32_16x16x32_bf16 v[160:163], a[60:63], a[124:127], v[160:163]
buffer_load_dwordx4 v0, s[48:51], s77 offen offset:1024 lds
v_mul_f32 v198, v198, v224
v_mul_f32 v199, v199, v224
v_mfma_f32_16x16x32_bf16 v[184:187], a[40:43], a[112:115], v[184:187]
s_add_u32 s77, s77, 16384
s_add_u32 m0, s71, 65536
v_mul_f32 v124, s82, v124
v_cvt_pk_bf16_f32 v90, v196, v197
v_mfma_f32_16x16x32_bf16 v[184:187], a[244:247], a[84:87], v[184:187]
ds_read_b64_tr_b16 a[170:171], v40 offset:32768
v_cvt_pk_bf16_f32 v91, v198, v199
buffer_store_dwordx4 v[88:91], v250, s[36:39], s86 offen sc1
v_mfma_f32_16x16x32_bf16 v[184:187], a[48:51], a[200:203], v[184:187]
buffer_load_dwordx4 v12, s[48:51], s77 offen offset:0 lds
v_permlane32_swap_b32 v124, v204
v_mfma_f32_16x16x32_bf16 v[184:187], a[224:227], a[124:127], v[184:187]
ds_read_b64_tr_b16 a[174:175], v42 offset:32768
v_fma_f32 v96, v96, s82, -v124
v_fma_f32 v97, v97, s82, -v124
v_fma_f32 v98, v98, s82, -v124
v_fma_f32 v99, v99, s82, -v124
v_mfma_f32_16x16x32_bf16 v[212:215], a[112:115], a[208:211], v[212:215]
v_exp_f32 v96, v96
v_exp_f32 v97, v97
v_mfma_f32_16x16x32_bf16 v[212:215], a[84:87], a[16:19], v[212:215]
buffer_load_dwordx4 v0, s[48:51], s77 offen offset:1024 lds
v_exp_f32 v98, v98
v_mfma_f32_16x16x32_bf16 v[212:215], a[200:203], a[12:15], v[212:215]
v_exp_f32 v99, v99
v_fma_f32 v176, v176, s82, -v204
v_fma_f32 v177, v177, s82, -v204
v_mfma_f32_16x16x32_bf16 v[212:215], a[124:127], a[96:99], v[212:215]
v_fma_f32 v178, v178, s82, -v204
v_fma_f32 v179, v179, s82, -v204
v_cvt_pk_bf16_f32 v126, v96, v97
v_cvt_pk_bf16_f32 v127, v98, v99
v_exp_f32 v176, v176
v_exp_f32 v177, v177
v_mfma_f32_16x16x16_bf16 v[64:67], v[248:249], v[126:127], 0
v_exp_f32 v178, v178
v_exp_f32 v179, v179
v_and_b32 v96, v126, v246
v_and_b32 v97, v127, v247
v_and_b32 v98, v126, v244
v_and_b32 v99, v127, v245
v_cvt_pk_bf16_f32 v206, v176, v177
v_cvt_pk_bf16_f32 v207, v178, v179
v_mfma_f32_16x16x32_bf16 v[124:127], v[50:53], v[96:99], 0
v_and_b32 v176, v206, v246
v_and_b32 v177, v207, v247
v_mfma_f32_16x16x16_bf16 v[144:147], v[248:249], v[206:207], 0
v_and_b32 v178, v206, v244
v_and_b32 v179, v207, v245
s_nop 1
v_mfma_f32_16x16x32_bf16 v[204:207], v[58:61], v[176:179], 0
s_waitcnt vmcnt(22)
s_waitcnt lgkmcnt(0)
v_mfma_f32_16x16x32_bf16 v[68:71], a[252:255], a[120:123], v[68:71]
v_cvt_pk_bf16_f32 v80, v80, v81
v_cvt_pk_bf16_f32 v81, v82, v83
v_cvt_pk_bf16_f32 v82, v104, v105
v_mfma_f32_16x16x32_bf16 v[68:71], a[4:7], a[216:219], v[68:71]
v_cvt_pk_bf16_f32 v83, v106, v107
v_cvt_pk_bf16_f32 v160, v160, v161
v_cvt_pk_bf16_f32 v54, v132, v133
v_mfma_f32_16x16x16_bf16 v[104:107], v[82:83], v[80:81], v[228:231]
v_cvt_pk_bf16_f32 v55, v134, v135
v_cvt_pk_bf16_f32 v161, v162, v163
v_mfma_f32_16x16x16_bf16 v[132:135], v[74:75], v[80:81], v[232:235]
v_cvt_pk_bf16_f32 v162, v184, v185
v_cvt_pk_bf16_f32 v163, v186, v187
v_cvt_pk_bf16_f32 v62, v212, v213
v_cvt_pk_bf16_f32 v63, v214, v215
v_mfma_f32_16x16x16_bf16 v[184:187], v[162:163], v[160:161], v[228:231]
v_rcp_f32 v64, v64
s_nop 1
v_max_f32 v104, v104, v132
v_mfma_f32_16x16x16_bf16 v[212:215], v[154:155], v[160:161], v[232:235]
v_max_f32 v105, v105, v133
v_max_f32 v106, v106, v134
v_max_f32 v107, v107, v135
v_mfma_f32_16x16x32_bf16 v[68:71], a[20:23], a[204:207], v[68:71]
ds_read_b64_tr_b16 a[176:177], v37 offset:24576
v_max3_f32 v132, v104, v105, v106
v_max_f32 v132, v132, v107
v_mul_f32 v124, v124, v64
v_mfma_f32_16x16x32_bf16 v[68:71], a[116:119], a[44:47], v[68:71]
v_max_f32 v184, v184, v212
v_max_f32 v185, v185, v213
v_max_f32 v186, v186, v214
v_mfma_f32_16x16x32_bf16 v[92:95], a[196:199], a[120:123], v[92:95]
ds_read_b64_tr_b16 a[180:181], v39 offset:24576
v_max_f32 v187, v187, v215
v_max3_f32 v212, v184, v185, v186
v_max_f32 v212, v212, v187
v_mfma_f32_16x16x32_bf16 v[92:95], a[236:239], a[216:219], v[92:95]
v_mul_f32 v125, v125, v64
v_mul_f32 v126, v126, v64
v_permlane32_swap_b32 v132, v212
v_mfma_f32_16x16x32_bf16 v[92:95], a[56:59], a[204:207], v[92:95]
v_max_f32 v133, v132, v212
v_max_f32 v132, v132, v212
v_mul_f32 v127, v127, v64
v_mfma_f32_16x16x32_bf16 v[92:95], a[64:67], a[44:47], v[92:95]
ds_read_b64_tr_b16 a[184:185], v41 offset:24576
v_rcp_f32 v144, v144
v_permlane16_swap_b32 v132, v133
v_mfma_f32_16x16x32_bf16 v[120:123], a[120:123], a[8:11], v[120:123]
v_max_f32 v132, v132, v133
v_mul_f32 v212, s82, v132
v_mul_f32 v132, s82, v132
v_mfma_f32_16x16x32_bf16 v[120:123], a[216:219], a[248:251], v[120:123]
ds_read_b64_tr_b16 a[188:189], v43 offset:24576
v_cvt_pk_bf16_f32 v96, v124, v125
v_cvt_pk_bf16_f32 v97, v126, v127
v_permlane32_swap_b32 v132, v212
v_mfma_f32_16x16x32_bf16 v[120:123], a[204:207], a[0:3], v[120:123]
v_fma_f32 v104, v104, s82, -v132
v_fma_f32 v105, v105, s82, -v132
v_fma_f32 v106, v106, s82, -v132
v_mfma_f32_16x16x32_bf16 v[120:123], a[44:47], a[192:195], v[120:123]
v_fma_f32 v107, v107, s82, -v132
v_exp_f32 v104, v104
v_exp_f32 v105, v105
v_mfma_f32_16x16x32_bf16 v[148:151], a[220:223], a[120:123], v[148:151]
ds_read_b64_tr_b16 a[178:179], v36 offset:40960
v_exp_f32 v106, v106
v_exp_f32 v107, v107
v_mfma_f32_16x16x32_bf16 v[148:151], a[68:71], a[216:219], v[148:151]
v_fma_f32 v184, v184, s82, -v212
v_fma_f32 v185, v185, s82, -v212
v_fma_f32 v186, v186, s82, -v212
v_mfma_f32_16x16x32_bf16 v[148:151], a[52:55], a[204:207], v[148:151]
ds_read_b64_tr_b16 a[182:183], v38 offset:40960
v_fma_f32 v187, v187, s82, -v212
v_cvt_pk_bf16_f32 v134, v104, v105
v_cvt_pk_bf16_f32 v135, v106, v107
v_mfma_f32_16x16x32_bf16 v[148:151], a[60:63], a[44:47], v[148:151]
v_exp_f32 v184, v184
v_exp_f32 v185, v185
v_mfma_f32_16x16x16_bf16 v[72:75], v[248:249], v[134:135], 0
v_exp_f32 v186, v186
v_exp_f32 v187, v187
v_mfma_f32_16x16x32_bf16 v[172:175], a[40:43], a[120:123], v[172:175]
v_and_b32 v104, v134, v246
v_and_b32 v105, v135, v247
v_and_b32 v106, v134, v244
v_mfma_f32_16x16x32_bf16 v[172:175], a[244:247], a[216:219], v[172:175]
ds_read_b64_tr_b16 a[186:187], v40 offset:40960
v_and_b32 v107, v135, v245
v_cvt_pk_bf16_f32 v214, v184, v185
v_cvt_pk_bf16_f32 v215, v186, v187
v_mfma_f32_16x16x32_bf16 v[132:135], v[52:55], v[104:107], 0
v_and_b32 v184, v214, v246
v_and_b32 v185, v215, v247
v_mfma_f32_16x16x16_bf16 v[152:155], v[248:249], v[214:215], 0
v_and_b32 v186, v214, v244
v_and_b32 v187, v215, v245
v_rcp_f32 v72, v72
v_mul_f32 v204, v204, v144
v_mfma_f32_16x16x32_bf16 v[212:215], v[60:63], v[184:187], 0
v_mul_f32 v132, v132, v72
v_mul_f32 v133, v133, v72
v_mul_f32 v134, v134, v72
v_mfma_f32_16x16x32_bf16 v[172:175], a[48:51], a[204:207], v[172:175]
v_mul_f32 v135, v135, v72
v_rcp_f32 v152, v152
v_mfma_f32_16x16x32_bf16 v[172:175], a[224:227], a[44:47], v[172:175]
ds_read_b64_tr_b16 a[190:191], v42 offset:40960
v_cvt_pk_bf16_f32 v104, v132, v133
v_cvt_pk_bf16_f32 v105, v134, v135
v_mul_f32 v205, v205, v144
v_mul_f32 v206, v206, v144
v_mfma_f32_16x16x32_bf16 v[200:203], a[120:123], a[208:211], v[200:203]
v_mul_f32 v207, v207, v144
v_cvt_pk_bf16_f32 v98, v204, v205
v_cvt_pk_bf16_f32 v99, v206, v207
v_mfma_f32_16x16x32_bf16 v[200:203], a[216:219], a[16:19], v[200:203]
buffer_store_dwordx4 v[96:99], v250, s[36:39], s88 offen sc1
v_mul_f32 v212, v212, v152
v_mfma_f32_16x16x32_bf16 v[200:203], a[204:207], a[12:15], v[200:203]
v_mul_f32 v213, v213, v152
v_mul_f32 v214, v214, v152
v_mul_f32 v215, v215, v152
v_cvt_pk_bf16_f32 v106, v212, v213
v_mfma_f32_16x16x32_bf16 v[200:203], a[44:47], a[96:99], v[200:203]
v_cvt_pk_bf16_f32 v107, v214, v215
buffer_store_dwordx4 v[104:107], v250, s[36:39], s90 offen sc1
s_waitcnt lgkmcnt(0)
v_mfma_f32_16x16x32_bf16 v[76:79], a[252:255], a[240:243], v[76:79]
v_cvt_pk_bf16_f32 v68, v68, v69
v_cvt_pk_bf16_f32 v69, v70, v71
v_mfma_f32_16x16x32_bf16 v[76:79], a[4:7], a[232:235], v[76:79]
v_cvt_pk_bf16_f32 v70, v92, v93
v_cvt_pk_bf16_f32 v71, v94, v95
v_mfma_f32_16x16x32_bf16 v[76:79], a[20:23], a[28:31], v[76:79]
v_cvt_pk_bf16_f32 v148, v148, v149
v_cvt_pk_bf16_f32 v50, v120, v121
v_mfma_f32_16x16x16_bf16 v[92:95], v[70:71], v[68:69], v[228:231]
v_cvt_pk_bf16_f32 v51, v122, v123
v_cvt_pk_bf16_f32 v149, v150, v151
v_mfma_f32_16x16x16_bf16 v[120:123], v[112:113], v[68:69], v[240:243]
v_cvt_pk_bf16_f32 v150, v172, v173
v_cvt_pk_bf16_f32 v151, v174, v175
v_mfma_f32_16x16x32_bf16 v[76:79], a[116:119], a[32:35], v[76:79]
v_cvt_pk_bf16_f32 v58, v200, v201
v_cvt_pk_bf16_f32 v59, v202, v203
v_mfma_f32_16x16x16_bf16 v[172:175], v[150:151], v[148:149], v[228:231]
s_nop 1
v_max_f32 v92, v92, v120
v_mfma_f32_16x16x16_bf16 v[200:203], v[192:193], v[148:149], v[240:243]
v_max_f32 v93, v93, v121
v_max_f32 v94, v94, v122
v_mfma_f32_16x16x32_bf16 v[100:103], a[196:199], a[240:243], v[100:103]
v_max_f32 v95, v95, v123
v_max3_f32 v120, v92, v93, v94
v_mfma_f32_16x16x32_bf16 v[100:103], a[236:239], a[232:235], v[100:103]
v_max_f32 v120, v120, v95
s_nop 0
v_max_f32 v172, v172, v200
v_mfma_f32_16x16x32_bf16 v[100:103], a[56:59], a[28:31], v[100:103]
v_max_f32 v173, v173, v201
v_max_f32 v174, v174, v202
v_mfma_f32_16x16x32_bf16 v[100:103], a[64:67], a[32:35], v[100:103]
v_max_f32 v175, v175, v203
v_max3_f32 v200, v172, v173, v174
v_mfma_f32_16x16x32_bf16 v[128:131], a[240:243], a[8:11], v[128:131]
v_max_f32 v200, v200, v175
s_nop 1
v_permlane32_swap_b32 v120, v200
v_mfma_f32_16x16x32_bf16 v[128:131], a[232:235], a[248:251], v[128:131]
v_max_f32 v121, v120, v200
v_max_f32 v120, v120, v200
v_mfma_f32_16x16x32_bf16 v[128:131], a[28:31], a[0:3], v[128:131]
s_nop 0
v_permlane16_swap_b32 v120, v121
v_mfma_f32_16x16x32_bf16 v[128:131], a[32:35], a[192:195], v[128:131]
v_max_f32 v120, v120, v121
v_mul_f32 v200, s82, v120
v_mfma_f32_16x16x32_bf16 v[156:159], a[220:223], a[240:243], v[156:159]
v_mul_f32 v120, s82, v120
s_nop 1
v_permlane32_swap_b32 v120, v200
v_mfma_f32_16x16x32_bf16 v[156:159], a[68:71], a[232:235], v[156:159]
v_fma_f32 v92, v92, s82, -v120
v_fma_f32 v93, v93, s82, -v120
v_mfma_f32_16x16x32_bf16 v[156:159], a[52:55], a[28:31], v[156:159]
v_fma_f32 v94, v94, s82, -v120
v_fma_f32 v95, v95, s82, -v120
v_mfma_f32_16x16x32_bf16 v[156:159], a[60:63], a[32:35], v[156:159]
v_exp_f32 v92, v92
v_mfma_f32_16x16x32_bf16 v[180:183], a[40:43], a[240:243], v[180:183]
v_exp_f32 v93, v93
v_mfma_f32_16x16x32_bf16 v[180:183], a[244:247], a[232:235], v[180:183]
v_exp_f32 v94, v94
v_exp_f32 v95, v95
v_mfma_f32_16x16x32_bf16 v[180:183], a[48:51], a[28:31], v[180:183]
v_fma_f32 v172, v172, s82, -v200
v_fma_f32 v173, v173, s82, -v200
v_mfma_f32_16x16x32_bf16 v[180:183], a[224:227], a[32:35], v[180:183]
v_fma_f32 v174, v174, s82, -v200
v_fma_f32 v175, v175, s82, -v200
v_mfma_f32_16x16x32_bf16 v[208:211], a[240:243], a[208:211], v[208:211]
v_cvt_pk_bf16_f32 v122, v92, v93
v_cvt_pk_bf16_f32 v123, v94, v95
v_mfma_f32_16x16x32_bf16 v[208:211], a[232:235], a[16:19], v[208:211]
v_exp_f32 v172, v172
v_exp_f32 v173, v173
v_mfma_f32_16x16x16_bf16 v[80:83], v[248:249], v[122:123], 0
v_exp_f32 v174, v174
v_mfma_f32_16x16x32_bf16 v[208:211], a[28:31], a[12:15], v[208:211]
v_exp_f32 v175, v175
v_mfma_f32_16x16x32_bf16 v[208:211], a[32:35], a[96:99], v[208:211]
v_and_b32 v92, v122, v246
v_and_b32 v93, v123, v247
v_and_b32 v94, v122, v244
v_and_b32 v95, v123, v245
v_cvt_pk_bf16_f32 v202, v172, v173
v_cvt_pk_bf16_f32 v203, v174, v175
v_mfma_f32_16x16x32_bf16 v[120:123], v[48:51], v[92:95], 0
v_and_b32 v172, v202, v246
v_and_b32 v173, v203, v247
v_mfma_f32_16x16x16_bf16 v[160:163], v[248:249], v[202:203], 0
v_and_b32 v174, v202, v244
v_and_b32 v175, v203, v245
s_nop 1
v_mfma_f32_16x16x32_bf16 v[200:203], v[56:59], v[172:175], 0
s_waitcnt vmcnt(0)
s_barrier
s_cmp_lg_u32 s60, 0
s_cbranch_scc1 Q_fa
s_mov_b32 exec_lo, 0
s_brev_b32 exec_hi, 1
buffer_store_dword v28, v30, s[20:23], 0 offen sc1
s_mov_b64 exec, -1
Q_fa:
v_mfma_f32_16x16x32_bf16 v[84:87], a[252:255], a[100:103], v[84:87]
v_cvt_pk_bf16_f32 v76, v76, v77
v_cvt_pk_bf16_f32 v77, v78, v79
v_cvt_pk_bf16_f32 v78, v100, v101
v_mfma_f32_16x16x32_bf16 v[84:87], a[4:7], a[36:39], v[84:87]
v_cvt_pk_bf16_f32 v79, v102, v103
v_cvt_pk_bf16_f32 v156, v156, v157
v_cvt_pk_bf16_f32 v52, v128, v129
v_mfma_f32_16x16x16_bf16 v[100:103], v[78:79], v[76:77], v[228:231]
v_cvt_pk_bf16_f32 v53, v130, v131
v_cvt_pk_bf16_f32 v157, v158, v159
v_mfma_f32_16x16x16_bf16 v[128:131], v[70:71], v[76:77], v[232:235]
buffer_store_dwordx4 v[4:7], v3, s[20:23], 0 offen offset:0 sc1
v_mfma_f32_16x16x32_bf16 v[84:87], a[20:23], a[104:107], v[84:87]
v_cvt_pk_bf16_f32 v158, v180, v181
v_cvt_pk_bf16_f32 v159, v182, v183
v_cvt_pk_bf16_f32 v60, v208, v209
v_cvt_pk_bf16_f32 v61, v210, v211
v_mfma_f32_16x16x16_bf16 v[180:183], v[158:159], v[156:157], v[228:231]
v_rcp_f32 v80, v80
v_max_f32 v100, v100, v128
v_mfma_f32_16x16x16_bf16 v[208:211], v[150:151], v[156:157], v[232:235]
v_max_f32 v101, v101, v129
v_max_f32 v102, v102, v130
v_max_f32 v103, v103, v131
v_mfma_f32_16x16x32_bf16 v[84:87], a[116:119], a[88:91], v[84:87]
v_max3_f32 v128, v100, v101, v102
v_max_f32 v128, v128, v103
v_mul_f32 v120, v120, v80
v_mfma_f32_16x16x32_bf16 v[108:111], a[196:199], a[100:103], v[108:111]
v_max_f32 v180, v180, v208
v_max_f32 v181, v181, v209
v_max_f32 v182, v182, v210
v_mfma_f32_16x16x32_bf16 v[108:111], a[236:239], a[36:39], v[108:111]
v_max_f32 v183, v183, v211
v_max3_f32 v208, v180, v181, v182
v_max_f32 v208, v208, v183
v_mfma_f32_16x16x32_bf16 v[108:111], a[56:59], a[104:107], v[108:111]
v_mul_f32 v121, v121, v80
v_mul_f32 v122, v122, v80
v_permlane32_swap_b32 v128, v208
v_mfma_f32_16x16x32_bf16 v[108:111], a[64:67], a[88:91], v[108:111]
v_max_f32 v129, v128, v208
v_mul_f32 v123, v123, v80
v_max_f32 v128, v128, v208
v_mfma_f32_16x16x32_bf16 v[136:139], a[100:103], a[8:11], v[136:139]
v_rcp_f32 v160, v160
v_cvt_pk_bf16_f32 v92, v120, v121
v_mfma_f32_16x16x32_bf16 v[136:139], a[36:39], a[248:251], v[136:139]
v_permlane16_swap_b32 v128, v129
v_cvt_pk_bf16_f32 v93, v122, v123
v_mfma_f32_16x16x32_bf16 v[136:139], a[104:107], a[0:3], v[136:139]
v_max_f32 v128, v128, v129
v_mul_f32 v208, s82, v128
v_mul_f32 v200, v200, v160
v_mfma_f32_16x16x32_bf16 v[136:139], a[88:91], a[192:195], v[136:139]
v_mul_f32 v201, v201, v160
v_mul_f32 v202, v202, v160
v_mul_f32 v203, v203, v160
v_mfma_f32_16x16x32_bf16 v[164:167], a[220:223], a[100:103], v[164:167]
v_mul_f32 v128, s82, v128
v_cvt_pk_bf16_f32 v94, v200, v201
v_cvt_pk_bf16_f32 v95, v202, v203
v_mfma_f32_16x16x32_bf16 v[164:167], a[68:71], a[36:39], v[164:167]
buffer_store_dwordx4 v[92:95], v250, s[36:39], s87 offen sc1
v_mfma_f32_16x16x32_bf16 v[164:167], a[52:55], a[104:107], v[164:167]
v_permlane32_swap_b32 v128, v208
v_fma_f32 v100, v100, s82, -v128
v_mfma_f32_16x16x32_bf16 v[164:167], a[60:63], a[88:91], v[164:167]
v_fma_f32 v101, v101, s82, -v128
v_fma_f32 v102, v102, s82, -v128
v_fma_f32 v103, v103, s82, -v128
v_mfma_f32_16x16x32_bf16 v[188:191], a[40:43], a[100:103], v[188:191]
v_exp_f32 v100, v100
v_exp_f32 v101, v101
v_mfma_f32_16x16x32_bf16 v[188:191], a[244:247], a[36:39], v[188:191]
v_exp_f32 v102, v102
v_exp_f32 v103, v103
v_mfma_f32_16x16x32_bf16 v[188:191], a[48:51], a[104:107], v[188:191]
v_fma_f32 v180, v180, s82, -v208
buffer_store_dwordx4 v[4:7], v3, s[20:23], 0 offen offset:1024 sc1
v_mfma_f32_16x16x32_bf16 v[188:191], a[224:227], a[88:91], v[188:191]
v_fma_f32 v181, v181, s82, -v208
v_fma_f32 v182, v182, s82, -v208
v_fma_f32 v183, v183, s82, -v208
v_mfma_f32_16x16x32_bf16 v[216:219], a[100:103], a[208:211], v[216:219]
v_cvt_pk_bf16_f32 v130, v100, v101
v_cvt_pk_bf16_f32 v131, v102, v103
v_mfma_f32_16x16x32_bf16 v[216:219], a[36:39], a[16:19], v[216:219]
v_exp_f32 v180, v180
v_exp_f32 v181, v181
v_mfma_f32_16x16x16_bf16 v[68:71], v[248:249], v[130:131], 0
v_exp_f32 v182, v182
v_mfma_f32_16x16x32_bf16 v[216:219], a[104:107], a[12:15], v[216:219]
v_exp_f32 v183, v183
v_mfma_f32_16x16x32_bf16 v[216:219], a[88:91], a[96:99], v[216:219]
v_and_b32 v100, v130, v246
v_and_b32 v101, v131, v247
v_and_b32 v102, v130, v244
v_and_b32 v103, v131, v245
v_cvt_pk_bf16_f32 v210, v180, v181
v_cvt_pk_bf16_f32 v211, v182, v183
v_mfma_f32_16x16x32_bf16 v[128:131], v[50:53], v[100:103], 0
v_and_b32 v180, v210, v246
v_and_b32 v181, v211, v247
v_mfma_f32_16x16x16_bf16 v[148:151], v[248:249], v[210:211], 0
v_and_b32 v182, v210, v244
v_and_b32 v183, v211, v245
s_nop 1
v_mfma_f32_16x16x32_bf16 v[208:211], v[58:61], v[180:183], 0
s_mov_b32 exec_lo, s27
s_mov_b32 exec_hi, 1
buffer_load_dword v16, v30, s[20:23], 0 offen sc1
s_mov_b64 exec, -1
v_lshlrev_b32 v22, 4, v1
s_xor_b32 s4, s72, 1
s_mul_i32 s4, s4, 294912
v_add_u32 v8, s4, v22
v_cvt_pk_bf16_f32 v84, v84, v85
v_cvt_pk_bf16_f32 v85, v86, v87
v_cvt_pk_bf16_f32 v86, v108, v109
v_cvt_pk_bf16_f32 v87, v110, v111
v_cvt_pk_bf16_f32 v164, v164, v165
v_cvt_pk_bf16_f32 v54, v136, v137
v_mfma_f32_16x16x16_bf16 v[108:111], v[86:87], v[84:85], v[228:231]
v_cvt_pk_bf16_f32 v55, v138, v139
v_cvt_pk_bf16_f32 v165, v166, v167
v_mfma_f32_16x16x16_bf16 v[136:139], v[78:79], v[84:85], v[232:235]
v_cvt_pk_bf16_f32 v166, v188, v189
v_cvt_pk_bf16_f32 v167, v190, v191
v_cvt_pk_bf16_f32 v62, v216, v217
v_cvt_pk_bf16_f32 v63, v218, v219
v_mfma_f32_16x16x16_bf16 v[188:191], v[166:167], v[164:165], v[228:231]
v_rcp_f32 v68, v68
v_rcp_f32 v148, v148
v_mfma_f32_16x16x16_bf16 v[216:219], v[158:159], v[164:165], v[232:235]
v_max_f32 v108, v108, v136
v_max_f32 v109, v109, v137
v_max_f32 v110, v110, v138
v_max_f32 v111, v111, v139
v_max3_f32 v136, v108, v109, v110
v_max_f32 v136, v136, v111
v_mul_f32 v128, v128, v68
v_mul_f32 v129, v129, v68
v_max_f32 v188, v188, v216
v_max_f32 v189, v189, v217
v_max_f32 v190, v190, v218
v_max_f32 v191, v191, v219
v_max3_f32 v216, v188, v189, v190
v_max_f32 v216, v216, v191
v_mul_f32 v130, v130, v68
v_mul_f32 v131, v131, v68
v_permlane32_swap_b32 v136, v216
v_max_f32 v137, v136, v216
v_max_f32 v136, v136, v216
v_cvt_pk_bf16_f32 v100, v128, v129
v_cvt_pk_bf16_f32 v101, v130, v131
v_permlane16_swap_b32 v136, v137
v_max_f32 v136, v136, v137
v_mul_f32 v216, s82, v136
v_mul_f32 v136, s82, v136
v_mul_f32 v208, v208, v148
v_mul_f32 v209, v209, v148
v_permlane32_swap_b32 v136, v216
v_fma_f32 v108, v108, s82, -v136
v_fma_f32 v109, v109, s82, -v136
v_fma_f32 v110, v110, s82, -v136
v_fma_f32 v111, v111, s82, -v136
v_exp_f32 v108, v108
v_exp_f32 v109, v109
v_exp_f32 v110, v110
v_exp_f32 v111, v111
v_fma_f32 v188, v188, s82, -v216
v_fma_f32 v189, v189, s82, -v216
v_fma_f32 v190, v190, s82, -v216
v_fma_f32 v191, v191, s82, -v216
v_cvt_pk_bf16_f32 v138, v108, v109
v_cvt_pk_bf16_f32 v139, v110, v111
v_exp_f32 v188, v188
v_exp_f32 v189, v189
v_mfma_f32_16x16x16_bf16 v[76:79], v[248:249], v[138:139], 0
v_exp_f32 v190, v190
v_exp_f32 v191, v191
v_and_b32 v108, v138, v246
v_and_b32 v109, v139, v247
v_and_b32 v110, v138, v244
v_and_b32 v111, v139, v245
v_cvt_pk_bf16_f32 v218, v188, v189
v_cvt_pk_bf16_f32 v219, v190, v191
v_mfma_f32_16x16x32_bf16 v[136:139], v[52:55], v[108:111], 0
v_and_b32 v188, v218, v246
v_and_b32 v189, v219, v247
v_mfma_f32_16x16x16_bf16 v[156:159], v[248:249], v[218:219], 0
v_and_b32 v190, v218, v244
v_and_b32 v191, v219, v245
v_rcp_f32 v76, v76
v_mul_f32 v210, v210, v148
v_mfma_f32_16x16x32_bf16 v[216:219], v[60:63], v[188:191], 0
v_mul_f32 v136, v136, v76
v_mul_f32 v137, v137, v76
v_mul_f32 v138, v138, v76
v_mul_f32 v139, v139, v76
v_rcp_f32 v156, v156
v_cvt_pk_bf16_f32 v108, v136, v137
v_cvt_pk_bf16_f32 v109, v138, v139
v_mul_f32 v211, v211, v148
v_cvt_pk_bf16_f32 v102, v208, v209
v_cvt_pk_bf16_f32 v103, v210, v211
buffer_store_dwordx4 v[100:103], v250, s[36:39], s89 offen sc1
v_mul_f32 v216, v216, v156
v_mul_f32 v217, v217, v156
v_mul_f32 v218, v218, v156
v_mul_f32 v219, v219, v156
v_cvt_pk_bf16_f32 v110, v216, v217
v_cvt_pk_bf16_f32 v111, v218, v219
buffer_store_dwordx4 v[108:111], v250, s[36:39], s91 offen sc1
s_waitcnt vmcnt(2)
s_mov_b32 exec_lo, s27
s_mov_b32 exec_hi, 1
s_mov_b32 s4, 0
Q_pa:
v_and_b32 v16, 1, v16
v_cmp_ne_u32 vcc, v28, v16
s_nop 1
s_cmp_eq_u64 vcc, 0
s_cbranch_scc1 Q_pa_ok
buffer_load_dword v16, v30, s[20:23], 0 offen sc1
s_add_u32 s4, s4, 1
s_waitcnt vmcnt(0)
s_cmp_lt_u32 s4, 0x8000
s_cbranch_scc1 Q_pa
Q_pa_ok:
s_mov_b64 exec, -1
v_and_b32 v23, 15, v1
s_lshl_b32 s4, s72, 9
v_lshl_add_u32 v27, v23, 2, s4
v_xor_b32 v26, 512, v27
buffer_load_dwordx4 a[0:3], v8, s[36:39], s74 offen offset:0 sc1
buffer_load_dwordx4 a[4:7], v8, s[36:39], s75 offen offset:0 sc1
buffer_load_dwordx4 a[8:11], v8, s[36:39], s74 offen offset:1024 sc1
buffer_load_dwordx4 a[12:15], v8, s[36:39], s75 offen offset:1024 sc1
buffer_load_dword v44, v26, s[40:43], 0 offen offset:0 sc1
buffer_load_dword v46, v26, s[40:43], 0 offen offset:256 sc1
buffer_load_dwordx4 a[16:19], v8, s[36:39], s76 offen offset:0 sc1
buffer_load_dwordx4 a[20:23], v8, s[36:39], s78 offen offset:0 sc1
buffer_load_dwordx4 a[24:27], v8, s[36:39], s76 offen offset:1024 sc1
buffer_load_dwordx4 a[28:31], v8, s[36:39], s78 offen offset:1024 sc1
ds_read_b64_tr_b16 a[192:193], v36 offset:49152
ds_read_b64_tr_b16 a[196:197], v38 offset:49152
ds_read_b64_tr_b16 a[200:201], v40 offset:49152
ds_read_b64_tr_b16 a[204:205], v42 offset:49152
ds_read_b64_tr_b16 a[194:195], v32 offset:0
ds_read_b64_tr_b16 a[198:199], v33 offset:0
ds_read_b64_tr_b16 a[202:203], v34 offset:0
ds_read_b64_tr_b16 a[206:207], v35 offset:0
ds_read_b64_tr_b16 a[208:209], v32 offset:8192
ds_read_b64_tr_b16 a[212:213], v33 offset:8192
ds_read_b64_tr_b16 a[216:217], v34 offset:8192
ds_read_b64_tr_b16 a[220:221], v35 offset:8192
ds_read_b64_tr_b16 a[210:211], v32 offset:16384
ds_read_b64_tr_b16 a[214:215], v33 offset:16384
ds_read_b64_tr_b16 a[218:219], v34 offset:16384
ds_read_b64_tr_b16 a[222:223], v35 offset:16384
ds_read_b64_tr_b16 a[224:225], v32 offset:24576
ds_read_b64_tr_b16 a[228:229], v33 offset:24576
ds_read_b64_tr_b16 a[232:233], v34 offset:24576
ds_read_b64_tr_b16 a[236:237], v35 offset:24576
ds_read_b64_tr_b16 a[226:227], v32 offset:32768
ds_read_b64_tr_b16 a[230:231], v33 offset:32768
ds_read_b64_tr_b16 a[234:235], v34 offset:32768
ds_read_b64_tr_b16 a[238:239], v35 offset:32768
ds_read_b64_tr_b16 a[240:241], v32 offset:40960
ds_read_b64_tr_b16 a[244:245], v33 offset:40960
ds_read_b64_tr_b16 a[248:249], v34 offset:40960
ds_read_b64_tr_b16 a[252:253], v35 offset:40960
ds_read_b64_tr_b16 a[242:243], v32 offset:49152
ds_read_b64_tr_b16 a[246:247], v33 offset:49152
ds_read_b64_tr_b16 a[250:251], v34 offset:49152
ds_read_b64_tr_b16 a[254:255], v35 offset:49152
ds_read_b64_tr_b16 a[112:113], v32 offset:57344
ds_read_b64_tr_b16 a[116:117], v33 offset:57344
ds_read_b64_tr_b16 a[120:121], v34 offset:57344
ds_read_b64_tr_b16 a[124:125], v35 offset:57344
ds_read_b64_tr_b16 a[114:115], v36 offset:0
ds_read_b64_tr_b16 a[118:119], v38 offset:0
ds_read_b64_tr_b16 a[122:123], v40 offset:0
ds_read_b64_tr_b16 a[126:127], v42 offset:0
s_waitcnt lgkmcnt(0)
s_mul_i32 s4, s72, 294912
v_add_u32 v10, s4, v22
v_add_u32 v9, 147456, v8
v_add_u32 v11, 147456, v10
s_lshl_b32 s4, s2, 13
s_lshl_b32 s5, s60, 11
s_add_u32 s4, s4, s5
s_add_u32 s4, s4, 32768
v_add_u32 v14, s4, v22
v_xor_b32 v15, 0x2000, v14
Q_T3:
s_cbranch_execz Q_Tret
s_add_u32 s14, s71, 155648
v_mov_b32 v60, s14
v_mov_b32 v61, 0
ds_write_b32 v60, v61
s_waitcnt vmcnt(10) lgkmcnt(0)
s_barrier
s_cmp_lg_u32 s60, 0
s_cbranch_scc1 Q_fb
s_mov_b32 exec_lo, 0
s_brev_b32 exec_hi, 1
buffer_store_dword v29, v30, s[20:23], 0 offen sc1
s_mov_b64 exec, -1
Q_fb:
s_waitcnt vmcnt(8)
v_mfma_f32_16x16x32_bf16 v[64:67], a[128:131], a[0:3], 0
buffer_load_dwordx4 a[32:35], v8, s[36:39], s79 offen offset:0 sc1
v_mfma_f32_16x16x32_bf16 v[64:67], a[144:147], a[4:7], v[64:67]
buffer_load_dword v48, v27, s[40:43], 0 offen offset:0 sc1
v_mfma_f32_16x16x32_bf16 v[68:71], a[132:135], a[0:3], 0
buffer_load_dwordx4 a[36:39], v8, s[36:39], s80 offen offset:0 sc1
buffer_load_dword v50, v27, s[40:43], 0 offen offset:256 sc1
v_mfma_f32_16x16x32_bf16 v[68:71], a[148:151], a[4:7], v[68:71]
buffer_load_dword v45, v26, s[40:43], 0 offen offset:128 sc1
buffer_load_dword v47, v26, s[40:43], 0 offen offset:384 sc1
v_mfma_f32_16x16x32_bf16 v[72:75], a[136:139], a[0:3], 0
buffer_load_dwordx4 a[40:43], v8, s[36:39], s81 offen offset:0 sc1
v_mfma_f32_16x16x32_bf16 v[72:75], a[152:155], a[4:7], v[72:75]
buffer_load_dword v49, v27, s[40:43], 0 offen offset:128 sc1
v_mfma_f32_16x16x32_bf16 v[76:79], a[140:143], a[0:3], 0
buffer_load_dword v51, v27, s[40:43], 0 offen offset:384 sc1
v_lshrrev_b32 v24, 4, v1
v_mfma_f32_16x16x32_bf16 v[76:79], a[156:159], a[4:7], v[76:79]
v_and_b32 v25, 2, v24
v_xor_b32 v25, v25, v23
v_lshl_add_u32 v25, v24, 4, v25
s_waitcnt vmcnt(15)
s_waitcnt vmcnt(13)
v_mfma_f32_16x16x32_bf16 v[80:83], a[128:131], a[8:11], 0
buffer_load_dwordx4 a[44:47], v8, s[36:39], s18 offen offset:0 sc1
v_mfma_f32_16x16x32_bf16 v[80:83], a[144:147], a[12:15], v[80:83]
v_mul_f32 v64, v64, v44
v_mul_f32 v65, v65, v44
v_mfma_f32_16x16x32_bf16 v[84:87], a[132:135], a[8:11], 0
v_mul_f32 v66, v66, v44
v_mul_f32 v67, v67, v44
v_mul_f32 v68, v68, v44
buffer_load_dwordx4 a[48:51], v8, s[36:39], s19 offen offset:0 sc1
v_mfma_f32_16x16x32_bf16 v[84:87], a[148:151], a[12:15], v[84:87]
v_mul_f32 v69, v69, v44
v_mul_f32 v70, v70, v44
v_mul_f32 v71, v71, v44
v_mfma_f32_16x16x32_bf16 v[88:91], a[136:139], a[8:11], 0
buffer_load_dwordx4 a[52:55], v8, s[36:39], s79 offen offset:1024 sc1
v_mfma_f32_16x16x32_bf16 v[88:91], a[152:155], a[12:15], v[88:91]
v_mul_f32 v72, v72, v44
v_mul_f32 v73, v73, v44
v_mul_f32 v74, v74, v44
v_mfma_f32_16x16x32_bf16 v[92:95], a[140:143], a[8:11], 0
v_mul_f32 v75, v75, v44
v_mul_f32 v76, v76, v44
v_mul_f32 v77, v77, v44
v_mfma_f32_16x16x32_bf16 v[92:95], a[156:159], a[12:15], v[92:95]
v_mul_f32 v78, v78, v44
v_mul_f32 v79, v79, v44
s_waitcnt vmcnt(14)
v_mfma_f32_16x16x32_bf16 v[64:67], a[160:163], a[16:19], v[64:67]
buffer_load_dwordx4 a[56:59], v8, s[36:39], s80 offen offset:1024 sc1
v_mfma_f32_16x16x32_bf16 v[64:67], a[176:179], a[20:23], v[64:67]
v_mul_f32 v80, v80, v46
v_mul_f32 v81, v81, v46
v_mfma_f32_16x16x32_bf16 v[68:71], a[164:167], a[16:19], v[68:71]
v_mul_f32 v82, v82, v46
v_mul_f32 v83, v83, v46
v_mul_f32 v84, v84, v46
buffer_load_dwordx4 a[60:63], v8, s[36:39], s81 offen offset:1024 sc1
v_mfma_f32_16x16x32_bf16 v[68:71], a[180:183], a[20:23], v[68:71]
v_mul_f32 v85, v85, v46
v_mul_f32 v86, v86, v46
v_mul_f32 v87, v87, v46
v_mfma_f32_16x16x32_bf16 v[72:75], a[168:171], a[16:19], v[72:75]
buffer_load_dwordx4 a[64:67], v8, s[36:39], s18 offen offset:1024 sc1
v_mfma_f32_16x16x32_bf16 v[72:75], a[184:187], a[20:23], v[72:75]
v_mul_f32 v88, v88, v46
v_mul_f32 v89, v89, v46
v_mul_f32 v90, v90, v46
v_mfma_f32_16x16x32_bf16 v[76:79], a[172:175], a[16:19], v[76:79]
v_mul_f32 v91, v91, v46
v_mul_f32 v92, v92, v46
v_mul_f32 v93, v93, v46
v_mfma_f32_16x16x32_bf16 v[76:79], a[188:191], a[20:23], v[76:79]
v_mul_f32 v94, v94, v46
v_mul_f32 v95, v95, v46
s_waitcnt vmcnt(15)
v_mfma_f32_16x16x32_bf16 v[80:83], a[160:163], a[24:27], v[80:83]
buffer_load_dwordx4 a[68:71], v8, s[36:39], s19 offen offset:1024 sc1
v_mfma_f32_16x16x32_bf16 v[80:83], a[176:179], a[28:31], v[80:83]
v_lshl_add_u32 v18, v25, 4, s71
v_xor_b32 v19, 64, v18
v_mfma_f32_16x16x32_bf16 v[84:87], a[164:167], a[24:27], v[84:87]
buffer_load_dwordx4 a[72:75], v10, s[36:39], s74 offen offset:0 sc1
v_xor_b32 v20, 128, v18
v_xor_b32 v21, 192, v18
v_and_b32 v22, 7, v1
v_mfma_f32_16x16x32_bf16 v[84:87], a[180:183], a[28:31], v[84:87]
v_lshrrev_b32 v23, 3, v1
s_and_b32 s4, s60, 1
s_lshl_b32 s4, s4, 3
v_mfma_f32_16x16x32_bf16 v[88:91], a[168:171], a[24:27], v[88:91]
buffer_load_dwordx4 a[76:79], v10, s[36:39], s75 offen offset:0 sc1
v_mfma_f32_16x16x32_bf16 v[88:91], a[184:187], a[28:31], v[88:91]
v_add_u32 v23, s4, v23
s_lshl_b32 s5, s72, 1
v_mfma_f32_16x16x32_bf16 v[92:95], a[172:175], a[24:27], v[92:95]
s_lshr_b32 s6, s60, 1
s_add_u32 s5, s5, s6
s_lshl_b32 s5, s5, 15
v_mfma_f32_16x16x32_bf16 v[92:95], a[188:191], a[28:31], v[92:95]
s_lshl_b32 s7, s73, 7
s_add_u32 s5, s5, s7
v_lshl_add_u32 v13, v22, 4, s5
s_waitcnt vmcnt(15)
v_mfma_f32_16x16x32_bf16 v[64:67], a[192:195], a[32:35], v[64:67]
buffer_load_dwordx4 a[80:83], v10, s[36:39], s74 offen offset:1024 sc1
v_mfma_f32_16x16x32_bf16 v[64:67], a[208:211], a[36:39], v[64:67]
v_lshl_add_u32 v13, v23, 11, v13
s_lshl_b32 s8, s72, 9
v_mfma_f32_16x16x32_bf16 v[68:71], a[196:199], a[32:35], v[68:71]
s_lshl_b32 s9, s6, 8
s_add_u32 s8, s8, s9
v_lshl_add_u32 v56, v23, 2, s8
v_mfma_f32_16x16x32_bf16 v[68:71], a[212:215], a[36:39], v[68:71]
v_lshlrev_b32 v24, 1, v22
v_xor_b32 v23, v23, v24
v_lshlrev_b32 v23, 4, v23
v_mfma_f32_16x16x32_bf16 v[72:75], a[200:203], a[32:35], v[72:75]
buffer_load_dwordx4 a[84:87], v10, s[36:39], s75 offen offset:1024 sc1
v_mfma_f32_16x16x32_bf16 v[72:75], a[216:219], a[36:39], v[72:75]
v_and_b32 v24, 3, v22
v_lshl_add_u32 v23, v24, 9, v23
v_mfma_f32_16x16x32_bf16 v[76:79], a[204:207], a[32:35], v[76:79]
v_lshrrev_b32 v22, 2, v22
v_lshl_add_u32 v23, v22, 13, v23
s_lshl_b32 s6, s6, 14
v_mfma_f32_16x16x32_bf16 v[76:79], a[220:223], a[36:39], v[76:79]
v_add_u32 v17, s6, v23
v_add_u32 v2, 0x10000, v17
v_add_u32 v3, 0x10000, v18
s_waitcnt vmcnt(10)
v_mfma_f32_16x16x32_bf16 v[64:67], a[224:227], a[40:43], v[64:67]
buffer_load_dwordx4 a[88:91], v10, s[36:39], s76 offen offset:0 sc1
v_mfma_f32_16x16x32_bf16 v[64:67], a[240:243], a[44:47], v[64:67]
v_add_u32 v4, 0x10000, v19
v_add_u32 v5, 0x10000, v20
v_mfma_f32_16x16x32_bf16 v[68:71], a[228:231], a[40:43], v[68:71]
v_add_u32 v6, 0x10000, v21
v_and_b32 v7, 3, v1
v_lshlrev_b32 v7, 11, v7
v_mfma_f32_16x16x32_bf16 v[68:71], a[244:247], a[44:47], v[68:71]
v_add_u32 v7, 155648, v7
s_add_u32 s4, s71, 155648
v_mov_b32 v12, s4
v_mfma_f32_16x16x32_bf16 v[72:75], a[232:235], a[40:43], v[72:75]
buffer_load_dwordx4 a[92:95], v10, s[36:39], s78 offen offset:0 sc1
s_mov_b32 exec_lo, s27
s_mov_b32 exec_hi, 1
buffer_load_dword v16, v30, s[20:23], 0 offen sc1
s_mov_b64 exec, -1
v_mfma_f32_16x16x32_bf16 v[72:75], a[248:251], a[44:47], v[72:75]
buffer_load_dword v54, v56, s[40:43], 0 offen offset:0 sc1
v_mfma_f32_16x16x32_bf16 v[76:79], a[236:239], a[40:43], v[76:79]
buffer_load_dword v55, v56, s[40:43], 0 offen offset:128 sc1
v_mfma_f32_16x16x32_bf16 v[76:79], a[252:255], a[44:47], v[76:79]
s_waitcnt vmcnt(13)
v_mfma_f32_16x16x32_bf16 v[64:67], a[112:115], a[48:51], v[64:67]
buffer_load_dwordx4 a[96:99], v10, s[36:39], s76 offen offset:1024 sc1
v_mfma_f32_16x16x32_bf16 v[68:71], a[116:119], a[48:51], v[68:71]
v_mfma_f32_16x16x32_bf16 v[72:75], a[120:123], a[48:51], v[72:75]
v_mfma_f32_16x16x32_bf16 v[76:79], a[124:127], a[48:51], v[76:79]
v_mfma_f32_16x16x32_bf16 v[80:83], a[192:195], a[52:55], v[80:83]
buffer_load_dwordx4 a[100:103], v10, s[36:39], s78 offen offset:1024 sc1
v_mfma_f32_16x16x32_bf16 v[84:87], a[196:199], a[52:55], v[84:87]
v_mfma_f32_16x16x32_bf16 v[88:91], a[200:203], a[52:55], v[88:91]
v_mfma_f32_16x16x32_bf16 v[92:95], a[204:207], a[52:55], v[92:95]
s_waitcnt vmcnt(13)
v_mfma_f32_16x16x32_bf16 v[80:83], a[208:211], a[56:59], v[80:83]
buffer_load_dwordx4 a[104:107], v10, s[36:39], s79 offen offset:0 sc1
v_mfma_f32_16x16x32_bf16 v[80:83], a[224:227], a[60:63], v[80:83]
ds_write_b128 v18, v[64:67] offset:0
v_mfma_f32_16x16x32_bf16 v[84:87], a[212:215], a[56:59], v[84:87]
ds_write_b128 v19, v[68:71] offset:1024
v_mfma_f32_16x16x32_bf16 v[84:87], a[228:231], a[60:63], v[84:87]
ds_write_b128 v20, v[72:75] offset:8192
ds_write_b128 v21, v[76:79] offset:9216
v_mfma_f32_16x16x32_bf16 v[88:91], a[216:219], a[56:59], v[88:91]
buffer_load_dwordx4 a[108:111], v10, s[36:39], s80 offen offset:0 sc1
v_mfma_f32_16x16x32_bf16 v[88:91], a[232:235], a[60:63], v[88:91]
v_mfma_f32_16x16x32_bf16 v[92:95], a[220:223], a[56:59], v[92:95]
v_mfma_f32_16x16x32_bf16 v[92:95], a[236:239], a[60:63], v[92:95]
s_waitcnt vmcnt(13)
v_mfma_f32_16x16x32_bf16 v[80:83], a[240:243], a[64:67], v[80:83]
buffer_load_dwordx4 a[0:3], v10, s[36:39], s81 offen offset:0 sc1
v_mfma_f32_16x16x32_bf16 v[80:83], a[112:115], a[68:71], v[80:83]
v_mfma_f32_16x16x32_bf16 v[84:87], a[244:247], a[64:67], v[84:87]
v_mfma_f32_16x16x32_bf16 v[84:87], a[116:119], a[68:71], v[84:87]
v_mfma_f32_16x16x32_bf16 v[88:91], a[248:251], a[64:67], v[88:91]
buffer_load_dwordx4 a[4:7], v10, s[36:39], s18 offen offset:0 sc1
v_mfma_f32_16x16x32_bf16 v[88:91], a[120:123], a[68:71], v[88:91]
v_mfma_f32_16x16x32_bf16 v[92:95], a[252:255], a[64:67], v[92:95]
v_mfma_f32_16x16x32_bf16 v[92:95], a[124:127], a[68:71], v[92:95]
s_waitcnt vmcnt(13)
v_mfma_f32_16x16x32_bf16 v[128:131], a[128:131], a[72:75], 0
buffer_load_dwordx4 a[8:11], v10, s[36:39], s19 offen offset:0 sc1
v_mfma_f32_16x16x32_bf16 v[128:131], a[144:147], a[76:79], v[128:131]
ds_write_b128 v18, v[80:83] offset:16384
v_mfma_f32_16x16x32_bf16 v[132:135], a[132:135], a[72:75], 0
ds_write_b128 v19, v[84:87] offset:17408
v_mfma_f32_16x16x32_bf16 v[132:135], a[148:151], a[76:79], v[132:135]
ds_write_b128 v20, v[88:91] offset:24576
ds_write_b128 v21, v[92:95] offset:25600
s_waitcnt vmcnt(9)
s_mov_b32 exec_lo, s27
s_mov_b32 exec_hi, 1
s_mov_b32 s4, 0
Q_pb:
v_and_b32 v16, 3, v16
v_cmp_ne_u32 vcc, v29, v16
s_nop 1
s_cmp_eq_u64 vcc, 0
s_cbranch_scc1 Q_pb_ok
buffer_load_dword v16, v30, s[20:23], 0 offen sc1
s_add_u32 s4, s4, 1
s_waitcnt vmcnt(0)
s_cmp_lt_u32 s4, 0x8000
s_cbranch_scc1 Q_pb
Q_pb_ok:
s_mov_b64 exec, -1
v_mfma_f32_16x16x32_bf16 v[136:139], a[136:139], a[72:75], 0
buffer_load_dwordx4 a[12:15], v9, s[36:39], s74 offen offset:0 sc1
v_mfma_f32_16x16x32_bf16 v[136:139], a[152:155], a[76:79], v[136:139]
v_mov_b32 v192, 1
v_mfma_f32_16x16x32_bf16 v[140:143], a[140:143], a[72:75], 0
ds_write_b32 v12, v192
v_mfma_f32_16x16x32_bf16 v[140:143], a[156:159], a[76:79], v[140:143]
v_mfma_f32_16x16x32_bf16 v[144:147], a[128:131], a[80:83], 0
buffer_load_dwordx4 a[16:19], v9, s[36:39], s75 offen offset:0 sc1
v_mfma_f32_16x16x32_bf16 v[144:147], a[144:147], a[84:87], v[144:147]
v_mul_f32 v128, v128, v48
v_mul_f32 v129, v129, v48
v_mfma_f32_16x16x32_bf16 v[148:151], a[132:135], a[80:83], 0
v_mul_f32 v130, v130, v48
v_mul_f32 v131, v131, v48
v_mul_f32 v132, v132, v48
v_mfma_f32_16x16x32_bf16 v[148:151], a[148:151], a[84:87], v[148:151]
v_mul_f32 v133, v133, v48
v_mul_f32 v134, v134, v48
v_mul_f32 v135, v135, v48
v_mfma_f32_16x16x32_bf16 v[152:155], a[136:139], a[80:83], 0
buffer_load_dwordx4 a[20:23], v9, s[36:39], s74 offen offset:1024 sc1
v_mfma_f32_16x16x32_bf16 v[152:155], a[152:155], a[84:87], v[152:155]
v_mul_f32 v136, v136, v48
v_mul_f32 v137, v137, v48
v_mul_f32 v138, v138, v48
v_mfma_f32_16x16x32_bf16 v[156:159], a[140:143], a[80:83], 0
v_mul_f32 v139, v139, v48
v_mul_f32 v140, v140, v48
v_mul_f32 v141, v141, v48
v_mfma_f32_16x16x32_bf16 v[156:159], a[156:159], a[84:87], v[156:159]
v_mul_f32 v142, v142, v48
v_mul_f32 v143, v143, v48
v_mfma_f32_16x16x32_bf16 v[128:131], a[160:163], a[88:91], v[128:131]
buffer_load_dwordx4 a[24:27], v9, s[36:39], s75 offen offset:1024 sc1
v_mfma_f32_16x16x32_bf16 v[128:131], a[176:179], a[92:95], v[128:131]
v_mul_f32 v144, v144, v50
v_mul_f32 v145, v145, v50
v_mfma_f32_16x16x32_bf16 v[132:135], a[164:167], a[88:91], v[132:135]
v_mul_f32 v146, v146, v50
v_mul_f32 v147, v147, v50
v_mul_f32 v148, v148, v50
v_mfma_f32_16x16x32_bf16 v[132:135], a[180:183], a[92:95], v[132:135]
v_mul_f32 v149, v149, v50
v_mul_f32 v150, v150, v50
v_mul_f32 v151, v151, v50
v_mfma_f32_16x16x32_bf16 v[136:139], a[168:171], a[88:91], v[136:139]
buffer_load_dwordx4 a[28:31], v9, s[36:39], s76 offen offset:0 sc1
v_mfma_f32_16x16x32_bf16 v[136:139], a[184:187], a[92:95], v[136:139]
v_mul_f32 v152, v152, v50
v_mul_f32 v153, v153, v50
v_mul_f32 v154, v154, v50
v_mfma_f32_16x16x32_bf16 v[140:143], a[172:175], a[88:91], v[140:143]
v_mul_f32 v155, v155, v50
v_mul_f32 v156, v156, v50
v_mul_f32 v157, v157, v50
v_mfma_f32_16x16x32_bf16 v[140:143], a[188:191], a[92:95], v[140:143]
v_mul_f32 v158, v158, v50
v_mul_f32 v159, v159, v50
s_waitcnt vmcnt(10)
v_mfma_f32_16x16x32_bf16 v[144:147], a[160:163], a[96:99], v[144:147]
buffer_load_dwordx4 a[32:35], v9, s[36:39], s78 offen offset:0 sc1
v_mfma_f32_16x16x32_bf16 v[144:147], a[176:179], a[100:103], v[144:147]
ds_read_b32 v192, v7
v_mfma_f32_16x16x32_bf16 v[148:151], a[164:167], a[96:99], v[148:151]
v_mfma_f32_16x16x32_bf16 v[148:151], a[180:183], a[100:103], v[148:151]
v_mfma_f32_16x16x32_bf16 v[152:155], a[168:171], a[96:99], v[152:155]
buffer_load_dwordx4 a[36:39], v9, s[36:39], s76 offen offset:1024 sc1
v_mfma_f32_16x16x32_bf16 v[152:155], a[184:187], a[100:103], v[152:155]
v_mfma_f32_16x16x32_bf16 v[156:159], a[172:175], a[96:99], v[156:159]
v_mfma_f32_16x16x32_bf16 v[156:159], a[188:191], a[100:103], v[156:159]
s_waitcnt vmcnt(10)
v_mfma_f32_16x16x32_bf16 v[128:131], a[192:195], a[104:107], v[128:131]
buffer_load_dwordx4 a[40:43], v9, s[36:39], s78 offen offset:1024 sc1
v_mfma_f32_16x16x32_bf16 v[128:131], a[208:211], a[108:111], v[128:131]
s_waitcnt lgkmcnt(0)
v_mfma_f32_16x16x32_bf16 v[132:135], a[196:199], a[104:107], v[132:135]
Q_c0:
v_cmp_gt_u32 vcc, 1, v192
s_nop 1
s_cmp_eq_u64 vcc, 0
s_cbranch_scc1 Q_c0_ok
ds_read_b32 v192, v7
s_waitcnt lgkmcnt(0)
s_branch Q_c0
Q_c0_ok:
v_mfma_f32_16x16x32_bf16 v[132:135], a[212:215], a[108:111], v[132:135]
ds_read_b128 v[64:67], v17 offset:0
ds_read_b128 v[68:71], v17 offset:256
v_mfma_f32_16x16x32_bf16 v[136:139], a[200:203], a[104:107], v[136:139]
buffer_load_dwordx4 a[44:47], v9, s[36:39], s79 offen offset:0 sc1
v_mfma_f32_16x16x32_bf16 v[136:139], a[216:219], a[108:111], v[136:139]
ds_read_b128 v[72:75], v17 offset:2048
ds_read_b128 v[76:79], v17 offset:2304
v_mfma_f32_16x16x32_bf16 v[140:143], a[204:207], a[104:107], v[140:143]
ds_read_b128 v[80:83], v17 offset:4096
ds_read_b128 v[84:87], v17 offset:4352
v_mfma_f32_16x16x32_bf16 v[140:143], a[220:223], a[108:111], v[140:143]
ds_read_b128 v[88:91], v17 offset:6144
ds_read_b128 v[92:95], v17 offset:6400
s_waitcnt vmcnt(10)
v_mfma_f32_16x16x32_bf16 v[128:131], a[224:227], a[0:3], v[128:131]
buffer_load_dwordx4 a[48:51], v9, s[36:39], s80 offen offset:0 sc1
v_mfma_f32_16x16x32_bf16 v[128:131], a[240:243], a[4:7], v[128:131]
v_mfma_f32_16x16x32_bf16 v[132:135], a[228:231], a[0:3], v[132:135]
v_mfma_f32_16x16x32_bf16 v[132:135], a[244:247], a[4:7], v[132:135]
v_mfma_f32_16x16x32_bf16 v[136:139], a[232:235], a[0:3], v[136:139]
buffer_load_dwordx4 a[52:55], v9, s[36:39], s81 offen offset:0 sc1
v_mfma_f32_16x16x32_bf16 v[136:139], a[248:251], a[4:7], v[136:139]
s_waitcnt lgkmcnt(0)
v_add_f32 v64, v64, v72
v_mfma_f32_16x16x32_bf16 v[140:143], a[236:239], a[0:3], v[140:143]
v_add_f32 v65, v65, v73
v_add_f32 v66, v66, v74
v_add_f32 v67, v67, v75
v_mfma_f32_16x16x32_bf16 v[140:143], a[252:255], a[4:7], v[140:143]
v_add_f32 v68, v68, v76
v_add_f32 v69, v69, v77
v_add_f32 v70, v70, v78
s_waitcnt vmcnt(10)
v_mfma_f32_16x16x32_bf16 v[128:131], a[112:115], a[8:11], v[128:131]
buffer_load_dwordx4 a[56:59], v9, s[36:39], s18 offen offset:0 sc1
v_mfma_f32_16x16x32_bf16 v[132:135], a[116:119], a[8:11], v[132:135]
v_add_f32 v54, 1.0, v54
v_mfma_f32_16x16x32_bf16 v[136:139], a[120:123], a[8:11], v[136:139]
v_add_f32 v55, 1.0, v55
v_rcp_f32 v54, v54
v_mfma_f32_16x16x32_bf16 v[140:143], a[124:127], a[8:11], v[140:143]
v_rcp_f32 v55, v55
v_add_f32 v71, v71, v79
v_mfma_f32_16x16x32_bf16 v[96:99], a[128:131], a[12:15], 0
buffer_load_dwordx4 a[60:63], v9, s[36:39], s19 offen offset:0 sc1
v_mfma_f32_16x16x32_bf16 v[100:103], a[132:135], a[12:15], 0
v_add_f32 v80, v80, v88
v_add_f32 v81, v81, v89
v_mfma_f32_16x16x32_bf16 v[104:107], a[136:139], a[12:15], 0
v_add_f32 v82, v82, v90
v_add_f32 v83, v83, v91
v_add_f32 v84, v84, v92
v_mfma_f32_16x16x32_bf16 v[108:111], a[140:143], a[12:15], 0
v_add_f32 v85, v85, v93
v_add_f32 v86, v86, v94
v_add_f32 v87, v87, v95
s_waitcnt vmcnt(10)
v_mfma_f32_16x16x32_bf16 v[96:99], a[144:147], a[16:19], v[96:99]
buffer_load_dwordx4 a[64:67], v9, s[36:39], s79 offen offset:1024 sc1
v_mfma_f32_16x16x32_bf16 v[100:103], a[148:151], a[16:19], v[100:103]
v_add_f32 v64, v64, v80
v_add_f32 v65, v65, v81
v_mfma_f32_16x16x32_bf16 v[104:107], a[152:155], a[16:19], v[104:107]
v_add_f32 v66, v66, v82
v_add_f32 v67, v67, v83
v_add_f32 v68, v68, v84
v_mfma_f32_16x16x32_bf16 v[108:111], a[156:159], a[16:19], v[108:111]
v_add_f32 v69, v69, v85
v_add_f32 v70, v70, v86
v_add_f32 v71, v71, v87
v_mfma_f32_16x16x32_bf16 v[112:115], a[128:131], a[20:23], 0
buffer_load_dwordx4 a[68:71], v9, s[36:39], s80 offen offset:1024 sc1
v_mfma_f32_16x16x32_bf16 v[116:119], a[132:135], a[20:23], 0
v_mul_f32 v96, v96, v45
v_mul_f32 v97, v97, v45
v_mfma_f32_16x16x32_bf16 v[120:123], a[136:139], a[20:23], 0
v_mul_f32 v98, v98, v45
v_mul_f32 v99, v99, v45
v_mul_f32 v100, v100, v45
v_mfma_f32_16x16x32_bf16 v[124:127], a[140:143], a[20:23], 0
v_mul_f32 v101, v101, v45
v_mul_f32 v102, v102, v45
v_mul_f32 v103, v103, v45
s_waitcnt vmcnt(10)
v_mfma_f32_16x16x32_bf16 v[112:115], a[144:147], a[24:27], v[112:115]
buffer_load_dwordx4 a[72:75], v9, s[36:39], s81 offen offset:1024 sc1
v_mfma_f32_16x16x32_bf16 v[116:119], a[148:151], a[24:27], v[116:119]
v_mul_f32 v104, v104, v45
v_mul_f32 v105, v105, v45
v_mul_f32 v106, v106, v45
v_mfma_f32_16x16x32_bf16 v[120:123], a[152:155], a[24:27], v[120:123]
v_mul_f32 v107, v107, v45
v_mul_f32 v108, v108, v45
v_mul_f32 v109, v109, v45
v_mfma_f32_16x16x32_bf16 v[124:127], a[156:159], a[24:27], v[124:127]
v_mul_f32 v110, v110, v45
v_mul_f32 v111, v111, v45
v_mfma_f32_16x16x32_bf16 v[96:99], a[160:163], a[28:31], v[96:99]
buffer_load_dwordx4 a[76:79], v9, s[36:39], s18 offen offset:1024 sc1
v_mfma_f32_16x16x32_bf16 v[100:103], a[164:167], a[28:31], v[100:103]
v_mul_f32 v112, v112, v47
v_mul_f32 v113, v113, v47
v_mfma_f32_16x16x32_bf16 v[104:107], a[168:171], a[28:31], v[104:107]
v_mul_f32 v114, v114, v47
v_mul_f32 v115, v115, v47
v_mul_f32 v116, v116, v47
v_mfma_f32_16x16x32_bf16 v[108:111], a[172:175], a[28:31], v[108:111]
v_mul_f32 v117, v117, v47
v_mul_f32 v118, v118, v47
v_mul_f32 v119, v119, v47
s_waitcnt vmcnt(10)
v_mfma_f32_16x16x32_bf16 v[96:99], a[176:179], a[32:35], v[96:99]
buffer_load_dwordx4 a[80:83], v9, s[36:39], s19 offen offset:1024 sc1
v_mfma_f32_16x16x32_bf16 v[100:103], a[180:183], a[32:35], v[100:103]
v_mul_f32 v120, v120, v47
v_mul_f32 v121, v121, v47
v_mul_f32 v122, v122, v47
v_mfma_f32_16x16x32_bf16 v[104:107], a[184:187], a[32:35], v[104:107]
v_mul_f32 v123, v123, v47
v_mul_f32 v124, v124, v47
v_mul_f32 v125, v125, v47
v_mfma_f32_16x16x32_bf16 v[108:111], a[188:191], a[32:35], v[108:111]
v_mul_f32 v126, v126, v47
v_mul_f32 v127, v127, v47
v_mfma_f32_16x16x32_bf16 v[112:115], a[160:163], a[36:39], v[112:115]
buffer_load_dwordx4 a[84:87], v10, s[36:39], s79 offen offset:1024 sc1
v_mfma_f32_16x16x32_bf16 v[116:119], a[164:167], a[36:39], v[116:119]
v_cvt_pk_bf16_f32 v64, v64, v65
v_cvt_pk_bf16_f32 v65, v66, v67
v_mfma_f32_16x16x32_bf16 v[120:123], a[168:171], a[36:39], v[120:123]
v_cvt_pk_bf16_f32 v66, v68, v69
v_cvt_pk_bf16_f32 v67, v70, v71
v_mfma_f32_16x16x32_bf16 v[124:127], a[172:175], a[36:39], v[124:127]
buffer_store_dwordx4 v[64:67], v15, s[20:23], 0 offen offset:0 sc1
ds_write_b128 v3, v[128:131] offset:0
s_waitcnt vmcnt(11)
v_mfma_f32_16x16x32_bf16 v[112:115], a[176:179], a[40:43], v[112:115]
buffer_load_dwordx4 a[88:91], v10, s[36:39], s80 offen offset:1024 sc1
v_mfma_f32_16x16x32_bf16 v[116:119], a[180:183], a[40:43], v[116:119]
ds_write_b128 v4, v[132:135] offset:1024
v_mfma_f32_16x16x32_bf16 v[120:123], a[184:187], a[40:43], v[120:123]
ds_write_b128 v5, v[136:139] offset:8192
v_mfma_f32_16x16x32_bf16 v[124:127], a[188:191], a[40:43], v[124:127]
ds_write_b128 v6, v[140:143] offset:9216
v_mfma_f32_16x16x32_bf16 v[96:99], a[192:195], a[44:47], v[96:99]
buffer_load_dwordx4 a[92:95], v10, s[36:39], s81 offen offset:1024 sc1
v_mfma_f32_16x16x32_bf16 v[100:103], a[196:199], a[44:47], v[100:103]
v_mfma_f32_16x16x32_bf16 v[104:107], a[200:203], a[44:47], v[104:107]
v_mfma_f32_16x16x32_bf16 v[108:111], a[204:207], a[44:47], v[108:111]
s_waitcnt vmcnt(11)
v_mfma_f32_16x16x32_bf16 v[96:99], a[208:211], a[48:51], v[96:99]
buffer_load_dwordx4 a[96:99], v10, s[36:39], s18 offen offset:1024 sc1
v_mfma_f32_16x16x32_bf16 v[96:99], a[224:227], a[52:55], v[96:99]
v_mfma_f32_16x16x32_bf16 v[100:103], a[212:215], a[48:51], v[100:103]
v_mfma_f32_16x16x32_bf16 v[100:103], a[228:231], a[52:55], v[100:103]
v_mfma_f32_16x16x32_bf16 v[104:107], a[216:219], a[48:51], v[104:107]
buffer_load_dwordx4 a[100:103], v10, s[36:39], s19 offen offset:1024 sc1
v_mfma_f32_16x16x32_bf16 v[104:107], a[232:235], a[52:55], v[104:107]
v_mfma_f32_16x16x32_bf16 v[108:111], a[220:223], a[48:51], v[108:111]
v_mfma_f32_16x16x32_bf16 v[108:111], a[236:239], a[52:55], v[108:111]
s_waitcnt vmcnt(11)
v_mfma_f32_16x16x32_bf16 v[96:99], a[240:243], a[56:59], v[96:99]
buffer_load_dwordx4 a[104:107], v11, s[36:39], s74 offen offset:0 sc1
v_mfma_f32_16x16x32_bf16 v[96:99], a[112:115], a[60:63], v[96:99]
v_mfma_f32_16x16x32_bf16 v[100:103], a[244:247], a[56:59], v[100:103]
v_mfma_f32_16x16x32_bf16 v[100:103], a[116:119], a[60:63], v[100:103]
v_mfma_f32_16x16x32_bf16 v[104:107], a[248:251], a[56:59], v[104:107]
buffer_load_dwordx4 a[108:111], v11, s[36:39], s75 offen offset:0 sc1
v_mfma_f32_16x16x32_bf16 v[104:107], a[120:123], a[60:63], v[104:107]
v_mfma_f32_16x16x32_bf16 v[108:111], a[252:255], a[56:59], v[108:111]
v_mfma_f32_16x16x32_bf16 v[108:111], a[124:127], a[60:63], v[108:111]
s_waitcnt vmcnt(11)
v_mfma_f32_16x16x32_bf16 v[112:115], a[192:195], a[64:67], v[112:115]
buffer_load_dwordx4 a[0:3], v11, s[36:39], s74 offen offset:1024 sc1
v_mfma_f32_16x16x32_bf16 v[112:115], a[208:211], a[68:71], v[112:115]
v_mfma_f32_16x16x32_bf16 v[116:119], a[196:199], a[64:67], v[116:119]
v_mfma_f32_16x16x32_bf16 v[116:119], a[212:215], a[68:71], v[116:119]
v_mfma_f32_16x16x32_bf16 v[120:123], a[200:203], a[64:67], v[120:123]
buffer_load_dwordx4 a[4:7], v11, s[36:39], s75 offen offset:1024 sc1
v_mfma_f32_16x16x32_bf16 v[120:123], a[216:219], a[68:71], v[120:123]
ds_write_b128 v18, v[96:99] offset:32768
v_mfma_f32_16x16x32_bf16 v[124:127], a[204:207], a[64:67], v[124:127]
ds_write_b128 v19, v[100:103] offset:33792
v_mfma_f32_16x16x32_bf16 v[124:127], a[220:223], a[68:71], v[124:127]
ds_write_b128 v20, v[104:107] offset:40960
ds_write_b128 v21, v[108:111] offset:41984
s_waitcnt vmcnt(11)
v_mfma_f32_16x16x32_bf16 v[112:115], a[224:227], a[72:75], v[112:115]
buffer_load_dwordx4 a[8:11], v11, s[36:39], s76 offen offset:0 sc1
v_mfma_f32_16x16x32_bf16 v[112:115], a[240:243], a[76:79], v[112:115]
v_mfma_f32_16x16x32_bf16 v[116:119], a[228:231], a[72:75], v[116:119]
v_mfma_f32_16x16x32_bf16 v[116:119], a[244:247], a[76:79], v[116:119]
v_mfma_f32_16x16x32_bf16 v[120:123], a[232:235], a[72:75], v[120:123]
buffer_load_dwordx4 a[12:15], v11, s[36:39], s78 offen offset:0 sc1
v_mfma_f32_16x16x32_bf16 v[120:123], a[248:251], a[76:79], v[120:123]
v_mfma_f32_16x16x32_bf16 v[124:127], a[236:239], a[72:75], v[124:127]
v_mfma_f32_16x16x32_bf16 v[124:127], a[252:255], a[76:79], v[124:127]
s_waitcnt vmcnt(11)
v_mfma_f32_16x16x32_bf16 v[112:115], a[112:115], a[80:83], v[112:115]
buffer_load_dwordx4 a[16:19], v11, s[36:39], s76 offen offset:1024 sc1
v_mfma_f32_16x16x32_bf16 v[116:119], a[116:119], a[80:83], v[116:119]
v_mfma_f32_16x16x32_bf16 v[120:123], a[120:123], a[80:83], v[120:123]
v_mfma_f32_16x16x32_bf16 v[124:127], a[124:127], a[80:83], v[124:127]
v_mfma_f32_16x16x32_bf16 v[144:147], a[192:195], a[84:87], v[144:147]
buffer_load_dwordx4 a[20:23], v11, s[36:39], s78 offen offset:1024 sc1
v_mfma_f32_16x16x32_bf16 v[148:151], a[196:199], a[84:87], v[148:151]
s_nop 0
ds_write_b128 v18, v[112:115] offset:49152
v_mfma_f32_16x16x32_bf16 v[152:155], a[200:203], a[84:87], v[152:155]
ds_write_b128 v19, v[116:119] offset:50176
ds_write_b128 v20, v[120:123] offset:57344
v_mfma_f32_16x16x32_bf16 v[156:159], a[204:207], a[84:87], v[156:159]
ds_write_b128 v21, v[124:127] offset:58368
v_mov_b32 v193, 2
ds_write_b32 v12, v193
s_waitcnt vmcnt(10)
v_mfma_f32_16x16x32_bf16 v[144:147], a[208:211], a[88:91], v[144:147]
buffer_load_dwordx4 a[24:27], v11, s[36:39], s79 offen offset:0 sc1
v_mfma_f32_16x16x32_bf16 v[144:147], a[224:227], a[92:95], v[144:147]
v_mfma_f32_16x16x32_bf16 v[148:151], a[212:215], a[88:91], v[148:151]
v_mfma_f32_16x16x32_bf16 v[148:151], a[228:231], a[92:95], v[148:151]
v_mfma_f32_16x16x32_bf16 v[152:155], a[216:219], a[88:91], v[152:155]
buffer_load_dwordx4 a[28:31], v11, s[36:39], s80 offen offset:0 sc1
v_mfma_f32_16x16x32_bf16 v[152:155], a[232:235], a[92:95], v[152:155]
ds_read_b32 v193, v7
v_mfma_f32_16x16x32_bf16 v[156:159], a[220:223], a[88:91], v[156:159]
v_mfma_f32_16x16x32_bf16 v[156:159], a[236:239], a[92:95], v[156:159]
s_waitcnt vmcnt(10)
v_mfma_f32_16x16x32_bf16 v[144:147], a[240:243], a[96:99], v[144:147]
buffer_load_dwordx4 a[32:35], v11, s[36:39], s81 offen offset:0 sc1
buffer_load_dwordx4 v[232:235], v14, s[20:23], 0 offen offset:0 sc1
v_mfma_f32_16x16x32_bf16 v[144:147], a[112:115], a[100:103], v[144:147]
v_mfma_f32_16x16x32_bf16 v[148:151], a[244:247], a[96:99], v[148:151]
v_mfma_f32_16x16x32_bf16 v[148:151], a[116:119], a[100:103], v[148:151]
v_mfma_f32_16x16x32_bf16 v[152:155], a[248:251], a[96:99], v[152:155]
buffer_load_dwordx4 a[36:39], v11, s[36:39], s18 offen offset:0 sc1
v_mfma_f32_16x16x32_bf16 v[152:155], a[120:123], a[100:103], v[152:155]
s_waitcnt lgkmcnt(0)
v_mfma_f32_16x16x32_bf16 v[156:159], a[252:255], a[96:99], v[156:159]
Q_c1:
v_cmp_gt_u32 vcc, 2, v193
s_nop 1
s_cmp_eq_u64 vcc, 0
s_cbranch_scc1 Q_c1_ok
ds_read_b32 v193, v7
s_waitcnt lgkmcnt(0)
s_branch Q_c1
Q_c1_ok:
ds_read_b128 v[96:99], v17 offset:32768
v_mfma_f32_16x16x32_bf16 v[156:159], a[124:127], a[100:103], v[156:159]
ds_read_b128 v[100:103], v17 offset:33024
ds_read_b128 v[104:107], v17 offset:34816
ds_read_b128 v[108:111], v17 offset:35072
ds_read_b128 v[112:115], v17 offset:36864
ds_read_b128 v[116:119], v17 offset:37120
ds_read_b128 v[120:123], v17 offset:38912
ds_read_b128 v[124:127], v17 offset:39168
s_waitcnt vmcnt(11)
v_mfma_f32_16x16x32_bf16 v[160:163], a[128:131], a[104:107], 0
buffer_load_dwordx4 a[40:43], v11, s[36:39], s19 offen offset:0 sc1
v_mfma_f32_16x16x32_bf16 v[160:163], a[144:147], a[108:111], v[160:163]
ds_write_b128 v3, v[144:147] offset:16384
v_mfma_f32_16x16x32_bf16 v[164:167], a[132:135], a[104:107], 0
ds_write_b128 v4, v[148:151] offset:17408
ds_write_b128 v5, v[152:155] offset:24576
v_mfma_f32_16x16x32_bf16 v[164:167], a[148:151], a[108:111], v[164:167]
ds_write_b128 v6, v[156:159] offset:25600
v_mov_b32 v194, 3
ds_write_b32 v12, v194
v_mfma_f32_16x16x32_bf16 v[168:171], a[136:139], a[104:107], 0
buffer_load_dwordx4 a[44:47], v11, s[36:39], s79 offen offset:1024 sc1
v_mfma_f32_16x16x32_bf16 v[168:171], a[152:155], a[108:111], v[168:171]
s_waitcnt lgkmcnt(5)
v_add_f32 v96, v96, v104
v_add_f32 v97, v97, v105
v_add_f32 v98, v98, v106
v_add_f32 v99, v99, v107
v_mfma_f32_16x16x32_bf16 v[172:175], a[140:143], a[104:107], 0
v_add_f32 v100, v100, v108
v_add_f32 v101, v101, v109
v_add_f32 v102, v102, v110
v_add_f32 v103, v103, v111
v_add_f32 v112, v112, v120
v_mfma_f32_16x16x32_bf16 v[172:175], a[156:159], a[108:111], v[172:175]
v_add_f32 v113, v113, v121
v_add_f32 v114, v114, v122
v_add_f32 v115, v115, v123
v_add_f32 v116, v116, v124
v_add_f32 v117, v117, v125
v_add_f32 v118, v118, v126
s_waitcnt vmcnt(11)
v_mfma_f32_16x16x32_bf16 v[176:179], a[128:131], a[0:3], 0
buffer_load_dwordx4 a[48:51], v11, s[36:39], s80 offen offset:1024 sc1
v_mfma_f32_16x16x32_bf16 v[176:179], a[144:147], a[4:7], v[176:179]
v_mul_f32 v160, v160, v49
v_mul_f32 v161, v161, v49
v_add_f32 v119, v119, v127
v_add_f32 v96, v96, v112
v_add_f32 v97, v97, v113
v_add_f32 v98, v98, v114
v_add_f32 v99, v99, v115
v_mfma_f32_16x16x32_bf16 v[180:183], a[132:135], a[0:3], 0
v_mul_f32 v162, v162, v49
v_mul_f32 v163, v163, v49
v_mul_f32 v164, v164, v49
v_add_f32 v100, v100, v116
v_add_f32 v101, v101, v117
v_add_f32 v102, v102, v118
v_add_f32 v103, v103, v119
v_cvt_pk_bf16_f32 v96, v96, v97
v_mfma_f32_16x16x32_bf16 v[180:183], a[148:151], a[4:7], v[180:183]
v_mul_f32 v165, v165, v49
v_mul_f32 v166, v166, v49
v_mul_f32 v167, v167, v49
v_cvt_pk_bf16_f32 v97, v98, v99
v_cvt_pk_bf16_f32 v98, v100, v101
v_cvt_pk_bf16_f32 v99, v102, v103
buffer_store_dwordx4 v[96:99], v15, s[20:23], 0 offen offset:1024 sc1
v_mfma_f32_16x16x32_bf16 v[184:187], a[136:139], a[0:3], 0
buffer_load_dwordx4 a[52:55], v11, s[36:39], s81 offen offset:1024 sc1
v_mfma_f32_16x16x32_bf16 v[184:187], a[152:155], a[4:7], v[184:187]
v_mul_f32 v168, v168, v49
v_mul_f32 v169, v169, v49
v_mul_f32 v170, v170, v49
ds_read_b32 v194, v7
v_mfma_f32_16x16x32_bf16 v[188:191], a[140:143], a[0:3], 0
Q_T4:
s_cbranch_execz Q_Tret
v_mul_f32 v171, v171, v49
v_mul_f32 v172, v172, v49
v_mul_f32 v173, v173, v49
v_mfma_f32_16x16x32_bf16 v[188:191], a[156:159], a[4:7], v[188:191]
v_mul_f32 v174, v174, v49
v_mul_f32 v175, v175, v49
s_waitcnt vmcnt(12)
v_mfma_f32_16x16x32_bf16 v[160:163], a[160:163], a[8:11], v[160:163]
buffer_load_dwordx4 a[56:59], v11, s[36:39], s18 offen offset:1024 sc1
v_mfma_f32_16x16x32_bf16 v[160:163], a[176:179], a[12:15], v[160:163]
v_mul_f32 v176, v176, v51
v_mul_f32 v177, v177, v51
v_mfma_f32_16x16x32_bf16 v[164:167], a[164:167], a[8:11], v[164:167]
v_mul_f32 v178, v178, v51
v_mul_f32 v179, v179, v51
v_mul_f32 v180, v180, v51
v_mfma_f32_16x16x32_bf16 v[164:167], a[180:183], a[12:15], v[164:167]
v_mul_f32 v181, v181, v51
v_mul_f32 v182, v182, v51
v_mul_f32 v183, v183, v51
v_mfma_f32_16x16x32_bf16 v[168:171], a[168:171], a[8:11], v[168:171]
buffer_load_dwordx4 a[60:63], v11, s[36:39], s19 offen offset:1024 sc1
v_mfma_f32_16x16x32_bf16 v[168:171], a[184:187], a[12:15], v[168:171]
v_mul_f32 v184, v184, v51
v_mul_f32 v185, v185, v51
v_mul_f32 v186, v186, v51
s_waitcnt lgkmcnt(0)
v_mfma_f32_16x16x32_bf16 v[172:175], a[172:175], a[8:11], v[172:175]
v_mul_f32 v187, v187, v51
v_mul_f32 v188, v188, v51
v_mul_f32 v189, v189, v51
Q_c2:
v_cmp_gt_u32 vcc, 3, v194
s_nop 1
s_cmp_eq_u64 vcc, 0
s_cbranch_scc1 Q_c2_ok
ds_read_b32 v194, v7
s_waitcnt lgkmcnt(0)
s_branch Q_c2
Q_c2_ok:
ds_read_b128 v[128:131], v2 offset:0
v_mfma_f32_16x16x32_bf16 v[172:175], a[188:191], a[12:15], v[172:175]
v_mul_f32 v190, v190, v51
v_mul_f32 v191, v191, v51
ds_read_b128 v[132:135], v2 offset:256
ds_read_b128 v[136:139], v2 offset:2048
ds_read_b128 v[140:143], v2 offset:2304
ds_read_b128 v[144:147], v2 offset:4096
ds_read_b128 v[148:151], v2 offset:4352
ds_read_b128 v[152:155], v2 offset:6144
ds_read_b128 v[156:159], v2 offset:6400
s_waitcnt vmcnt(12)
v_mfma_f32_16x16x32_bf16 v[176:179], a[160:163], a[16:19], v[176:179]
v_mfma_f32_16x16x32_bf16 v[176:179], a[176:179], a[20:23], v[176:179]
v_mfma_f32_16x16x32_bf16 v[180:183], a[164:167], a[16:19], v[180:183]
v_mfma_f32_16x16x32_bf16 v[180:183], a[180:183], a[20:23], v[180:183]
v_mfma_f32_16x16x32_bf16 v[184:187], a[168:171], a[16:19], v[184:187]
s_waitcnt lgkmcnt(0)
v_add_f32 v128, v128, v136
v_mfma_f32_16x16x32_bf16 v[184:187], a[184:187], a[20:23], v[184:187]
v_add_f32 v129, v129, v137
v_add_f32 v130, v130, v138
v_mfma_f32_16x16x32_bf16 v[188:191], a[172:175], a[16:19], v[188:191]
v_add_f32 v131, v131, v139
v_add_f32 v132, v132, v140
v_add_f32 v133, v133, v141
v_mfma_f32_16x16x32_bf16 v[188:191], a[188:191], a[20:23], v[188:191]
v_add_f32 v134, v134, v142
v_add_f32 v135, v135, v143
v_add_f32 v144, v144, v152
s_waitcnt vmcnt(10)
v_mfma_f32_16x16x32_bf16 v[160:163], a[192:195], a[24:27], v[160:163]
v_add_f32 v145, v145, v153
v_add_f32 v146, v146, v154
v_mfma_f32_16x16x32_bf16 v[160:163], a[208:211], a[28:31], v[160:163]
v_add_f32 v147, v147, v155
v_add_f32 v148, v148, v156
v_mfma_f32_16x16x32_bf16 v[164:167], a[196:199], a[24:27], v[164:167]
v_add_f32 v149, v149, v157
v_add_f32 v150, v150, v158
v_add_f32 v151, v151, v159
v_mfma_f32_16x16x32_bf16 v[164:167], a[212:215], a[28:31], v[164:167]
v_add_f32 v128, v128, v144
v_add_f32 v129, v129, v145
v_add_f32 v130, v130, v146
v_mfma_f32_16x16x32_bf16 v[168:171], a[200:203], a[24:27], v[168:171]
v_add_f32 v131, v131, v147
v_add_f32 v132, v132, v148
v_mfma_f32_16x16x32_bf16 v[168:171], a[216:219], a[28:31], v[168:171]
v_add_f32 v133, v133, v149
v_add_f32 v134, v134, v150
v_mfma_f32_16x16x32_bf16 v[172:175], a[204:207], a[24:27], v[172:175]
v_add_f32 v135, v135, v151
s_waitcnt vmcnt(8)
v_mfma_f32_16x16x32_bf16 v[172:175], a[220:223], a[28:31], v[172:175]
s_waitcnt vmcnt(7)
v_mfma_f32_16x16x32_bf16 v[160:163], a[224:227], a[32:35], v[160:163]
s_mov_b32 s4, 0
Q_r0:
v_max3_u32 v22, v232, v233, v234
v_max_u32 v22, v22, v235
v_cmp_eq_u32 vcc, -1, v22
s_nop 1
s_cmp_eq_u64 vcc, 0
s_cbranch_scc1 Q_r0_ok
buffer_load_dwordx4 v[232:235], v14, s[20:23], 0 offen offset:0 sc1
s_add_u32 s4, s4, 1
s_waitcnt vmcnt(0)
s_cmp_lt_u32 s4, 0x2000
s_cbranch_scc1 Q_r0
Q_r0_ok:
v_mfma_f32_16x16x32_bf16 v[160:163], a[240:243], a[36:39], v[160:163]
v_lshlrev_b32 v224, 16, v232
v_and_b32 v225, 0xffff0000, v232
v_mfma_f32_16x16x32_bf16 v[164:167], a[228:231], a[32:35], v[164:167]
v_lshlrev_b32 v226, 16, v233
v_and_b32 v227, 0xffff0000, v233
v_mfma_f32_16x16x32_bf16 v[164:167], a[244:247], a[36:39], v[164:167]
v_lshlrev_b32 v228, 16, v234
v_mfma_f32_16x16x32_bf16 v[168:171], a[232:235], a[32:35], v[168:171]
v_and_b32 v229, 0xffff0000, v234
v_lshlrev_b32 v230, 16, v235
v_mfma_f32_16x16x32_bf16 v[168:171], a[248:251], a[36:39], v[168:171]
v_and_b32 v231, 0xffff0000, v235
v_add_f32 v128, v128, v224
v_mfma_f32_16x16x32_bf16 v[172:175], a[236:239], a[32:35], v[172:175]
v_add_f32 v129, v129, v225
v_add_f32 v130, v130, v226
v_add_f32 v131, v131, v227
v_mfma_f32_16x16x32_bf16 v[172:175], a[252:255], a[36:39], v[172:175]
v_add_f32 v132, v132, v228
v_add_f32 v133, v133, v229
v_add_f32 v134, v134, v230
s_waitcnt vmcnt(5)
v_mfma_f32_16x16x32_bf16 v[160:163], a[112:115], a[40:43], v[160:163]
v_add_f32 v135, v135, v231
v_mul_f32 v128, v128, v54
v_mfma_f32_16x16x32_bf16 v[164:167], a[116:119], a[40:43], v[164:167]
v_mul_f32 v129, v129, v54
v_mul_f32 v130, v130, v54
v_mfma_f32_16x16x32_bf16 v[168:171], a[120:123], a[40:43], v[168:171]
v_mul_f32 v131, v131, v54
v_mul_f32 v132, v132, v54
v_mul_f32 v133, v133, v54
v_mfma_f32_16x16x32_bf16 v[172:175], a[124:127], a[40:43], v[172:175]
v_mul_f32 v134, v134, v54
v_mul_f32 v135, v135, v54
v_cvt_pk_bf16_f32 v128, v128, v129
v_mfma_f32_16x16x32_bf16 v[176:179], a[192:195], a[44:47], v[176:179]
buffer_load_dwordx4 v[248:251], v14, s[20:23], 0 offen offset:1024 sc1
v_mfma_f32_16x16x32_bf16 v[180:183], a[196:199], a[44:47], v[180:183]
v_cvt_pk_bf16_f32 v129, v130, v131
v_cvt_pk_bf16_f32 v130, v132, v133
v_mfma_f32_16x16x32_bf16 v[184:187], a[200:203], a[44:47], v[184:187]
v_cvt_pk_bf16_f32 v131, v134, v135
v_mfma_f32_16x16x32_bf16 v[188:191], a[204:207], a[44:47], v[188:191]
buffer_store_dwordx4 v[128:131], v13, s[52:55], 0 offen offset:0 sc1
s_waitcnt vmcnt(4)
v_mfma_f32_16x16x32_bf16 v[176:179], a[208:211], a[48:51], v[176:179]
ds_write_b128 v3, v[160:163] offset:32768
v_mfma_f32_16x16x32_bf16 v[176:179], a[224:227], a[52:55], v[176:179]
ds_write_b128 v4, v[164:167] offset:33792
v_mfma_f32_16x16x32_bf16 v[180:183], a[212:215], a[48:51], v[180:183]
ds_write_b128 v5, v[168:171] offset:40960
v_mfma_f32_16x16x32_bf16 v[180:183], a[228:231], a[52:55], v[180:183]
ds_write_b128 v6, v[172:175] offset:41984
v_mfma_f32_16x16x32_bf16 v[184:187], a[216:219], a[48:51], v[184:187]
v_mfma_f32_16x16x32_bf16 v[184:187], a[232:235], a[52:55], v[184:187]
v_mfma_f32_16x16x32_bf16 v[188:191], a[220:223], a[48:51], v[188:191]
v_mfma_f32_16x16x32_bf16 v[188:191], a[236:239], a[52:55], v[188:191]
s_waitcnt vmcnt(2)
v_mfma_f32_16x16x32_bf16 v[176:179], a[240:243], a[56:59], v[176:179]
v_mfma_f32_16x16x32_bf16 v[176:179], a[112:115], a[60:63], v[176:179]
v_mfma_f32_16x16x32_bf16 v[180:183], a[244:247], a[56:59], v[180:183]
v_mfma_f32_16x16x32_bf16 v[180:183], a[116:119], a[60:63], v[180:183]
v_mfma_f32_16x16x32_bf16 v[184:187], a[248:251], a[56:59], v[184:187]
v_mfma_f32_16x16x32_bf16 v[184:187], a[120:123], a[60:63], v[184:187]
v_mfma_f32_16x16x32_bf16 v[188:191], a[252:255], a[56:59], v[188:191]
v_mfma_f32_16x16x32_bf16 v[188:191], a[124:127], a[60:63], v[188:191]
s_nop 1
ds_write_b128 v3, v[176:179] offset:49152
s_nop 0
ds_write_b128 v4, v[180:183] offset:50176
s_nop 0
ds_write_b128 v5, v[184:187] offset:57344
s_nop 0
ds_write_b128 v6, v[188:191] offset:58368
s_waitcnt lgkmcnt(0)
s_barrier
ds_read_b128 v[160:163], v2 offset:32768
ds_read_b128 v[164:167], v2 offset:33024
ds_read_b128 v[168:171], v2 offset:34816
ds_read_b128 v[172:175], v2 offset:35072
ds_read_b128 v[176:179], v2 offset:36864
ds_read_b128 v[180:183], v2 offset:37120
ds_read_b128 v[184:187], v2 offset:38912
ds_read_b128 v[188:191], v2 offset:39168
s_waitcnt vmcnt(1)
s_mov_b32 s4, 0
Q_r1:
v_max3_u32 v22, v248, v249, v250
v_max_u32 v22, v22, v251
v_cmp_eq_u32 vcc, -1, v22
s_nop 1
s_cmp_eq_u64 vcc, 0
s_cbranch_scc1 Q_r1_ok
buffer_load_dwordx4 v[248:251], v14, s[20:23], 0 offen offset:1024 sc1
s_add_u32 s4, s4, 1
s_waitcnt vmcnt(0)
s_cmp_lt_u32 s4, 0x2000
s_cbranch_scc1 Q_r1
Q_r1_ok:
v_lshlrev_b32 v240, 16, v248
v_and_b32 v241, 0xffff0000, v248
v_lshlrev_b32 v242, 16, v249
v_and_b32 v243, 0xffff0000, v249
v_lshlrev_b32 v244, 16, v250
v_and_b32 v245, 0xffff0000, v250
v_lshlrev_b32 v246, 16, v251
v_and_b32 v247, 0xffff0000, v251
s_waitcnt lgkmcnt(0)
v_pk_add_f32 v[160:161], v[160:161], v[168:169]
v_pk_add_f32 v[162:163], v[162:163], v[170:171]
v_pk_add_f32 v[164:165], v[164:165], v[172:173]
v_pk_add_f32 v[166:167], v[166:167], v[174:175]
v_pk_add_f32 v[176:177], v[176:177], v[184:185]
v_pk_add_f32 v[178:179], v[178:179], v[186:187]
v_pk_add_f32 v[180:181], v[180:181], v[188:189]
v_pk_add_f32 v[182:183], v[182:183], v[190:191]
v_pk_add_f32 v[160:161], v[160:161], v[176:177]
v_pk_add_f32 v[162:163], v[162:163], v[178:179]
v_pk_add_f32 v[164:165], v[164:165], v[180:181]
v_pk_add_f32 v[166:167], v[166:167], v[182:183]
v_pk_add_f32 v[160:161], v[160:161], v[240:241]
v_pk_add_f32 v[162:163], v[162:163], v[242:243]
v_pk_add_f32 v[164:165], v[164:165], v[244:245]
v_pk_add_f32 v[166:167], v[166:167], v[246:247]
v_pk_mul_f32 v[160:161], v[160:161], v[54:55] op_sel:[0,1] op_sel_hi:[1,1]
v_pk_mul_f32 v[162:163], v[162:163], v[54:55] op_sel:[0,1] op_sel_hi:[1,1]
v_pk_mul_f32 v[164:165], v[164:165], v[54:55] op_sel:[0,1] op_sel_hi:[1,1]
v_pk_mul_f32 v[166:167], v[166:167], v[54:55] op_sel:[0,1] op_sel_hi:[1,1]
v_cvt_pk_bf16_f32 v160, v160, v161
v_cvt_pk_bf16_f32 v161, v162, v163
v_cvt_pk_bf16_f32 v162, v164, v165
v_cvt_pk_bf16_f32 v163, v166, v167
buffer_store_dwordx4 v[160:163], v13, s[52:55], 0 offen offset:1024 sc1
s_endpgm
.p2align 8
.fill 6144, 4, 0xbf800000
s_endpgm
.section .rodata,"a"
.p2align 6
.amdhsa_kernel gated_mix__sliding_local_dilated__glu_gated_glu__prompt_kernel
  .amdhsa_next_free_vgpr 512
  .amdhsa_next_free_sgpr 102
  .amdhsa_accum_offset 256
  .amdhsa_group_segment_fixed_size 0
  .amdhsa_kernarg_size 88
  .amdhsa_user_sgpr_count 2
  .amdhsa_user_sgpr_kernarg_segment_ptr 1
  .amdhsa_system_sgpr_workgroup_id_x 1
.end_amdhsa_kernel
```
